```python
import torch

def _softmax(x, axis=-1):
    return torch.softmax(x, dim=axis)
def _gelu(x):
    return torch.nn.functional.gelu(x, approximate="tanh")
def _silu(x):
    return torch.nn.functional.silu(x)
def _sigmoid(x):
    return torch.sigmoid(x)
def _layernorm(x, axis=-1, eps=1e-5):
    m = x.mean(dim=axis, keepdim=True)
    v = x.var(dim=axis, keepdim=True, unbiased=False)
    return (x - m) / torch.sqrt(v + eps)
def _scatter_add(tgt, idx, src, axis=0):
    return tgt.clone().index_add_(axis, idx, src)
def _segment_sum(src, seg, n):
    out = torch.zeros((n,) + src.shape[1:], dtype=src.dtype)
    return out.index_add_(0, seg, src)
def _pad(x, pw):
    flat = tuple(v for pair in reversed(pw) for v in pair)
    return torch.nn.functional.pad(x, flat)

kernel_name = 'standalone__mha_block_cached__near_ridge'

def setup_inputs():

    _w = (lambda a: (lambda t: t.to(torch.bfloat16) if t.is_floating_point() else t)(torch.as_tensor(a)))
    B, Sq, D = 8, 224, 576
    H, Sk, Dh = 32, 1024, 128
    return {
        "x": _w((lambda *s: torch.randn(*s, dtype=torch.bfloat16) * 0.8)(B, Sq, D)),
        "k_cache": _w((lambda *s: torch.randn(*s, dtype=torch.bfloat16) * 0.8)(B, H, Sk, Dh)),
        "v_cache": _w((lambda *s: torch.randn(*s, dtype=torch.bfloat16) * 0.05)(B, H, Sk, Dh)),
        "wq": _w((lambda *s: torch.randn(*s, dtype=torch.bfloat16) * 0.8)(D, H * Dh) * (D ** -0.5)),
        "wo": _w((lambda *s: torch.randn(*s, dtype=torch.bfloat16) * 0.05)(H * Dh, D) * ((H * Dh) ** -0.5)),
    }

def reference(x, k_cache, v_cache, wq, wo):
    B, Sq, D = x.shape
    H, Dh = 32, 128
    q = (lambda x, *d: x.permute(*d))((x @ wq).reshape(B, Sq, H, Dh), 0, 2, 1, 3)
    scores = torch.einsum("bhqd,bhkd->bhqk", q, k_cache) * (Dh ** -0.5)
    p = _softmax(scores, axis=-1)
    o = torch.einsum("bhqk,bhkd->bhqd", p, v_cache)
    return (lambda x, *d: x.permute(*d))(o, 0, 2, 1, 3).reshape(B, Sq, H * Dh) @ wo
```

```asm
; @launch grid=(256,1,1) block=(256,1,1) lds=163840
.amdgcn_target "amdgcn-amd-amdhsa--gfx950"
.text
.globl standalone__mha_block_cached__near_ridge_kernel
.p2align 8
.type standalone__mha_block_cached__near_ridge_kernel,@function
standalone__mha_block_cached__near_ridge_kernel:
    s_cmp_ge_u32 s2, 256
    s_cbranch_scc1 A_END
    s_load_dwordx8 s[4:11], s[0:1], 0
    s_load_dwordx2 s[12:13], s[0:1], 56
    v_mov_b32 v242, v0
    v_lshrrev_b32 v1, 6, v0
    s_and_b32 s3, s2, 7
    s_lshr_b32 s49, s2, 3
    v_readfirstlane_b32 s36, v1
    s_and_b32 s50, s3, 1
    s_lshl_b32 s50, s50, 2
    s_and_b32 s51, s49, 3
    s_add_u32 s45, s50, s51
    s_lshr_b32 s50, s3, 1
    s_lshl_b32 s50, s50, 3
    s_lshr_b32 s51, s49, 2
    s_add_u32 s46, s50, s51
    s_lshr_b32 s37, s36, 1
    s_and_b32 s38, s36, 1
    s_mul_i32 s39, s36, 7168
    s_lshl_b32 s44, s36, 12
    v_and_b32 v243, 63, v242
    v_and_b32 v244, 15, v243
    v_lshrrev_b32 v245, 4, v243
    v_lshrrev_b32 v248, 3, v243
    v_and_b32 v246, 7, v243
    v_xor_b32 v249, v245, v246
    v_lshlrev_b32 v249, 4, v249
    s_lshl_b32 s49, s38, 6
    v_xor_b32 v249, s49, v249
    v_mul_u32_u24 v248, 1152, v248
    s_mul_i32 s50, s36, 64512
    v_add_u32 v248, s50, v248
    v_xor_b32 v247, 64, v249
    v_add_u32 v144, v249, v248
    v_add_u32 v247, v247, v248
    v_add_u32 v145, 8192, v247
    v_add_u32 v146, 16384, v144
    v_add_u32 v147, 24576, v247
    v_add_u32 v148, 36864, v144
    v_add_u32 v149, 45056, v247
    v_add_u32 v150, 53248, v144
    v_lshlrev_b32 v248, 2, v245
    v_xor_b32 v248, v248, v244
    v_lshlrev_b32 v248, 4, v248
    v_lshlrev_b32 v249, 13, v245
    s_lshl_b32 s50, s36, 17
    v_add_u32 v249, s50, v249
    v_add_u32 v151, v248, v249
    v_add_u32 v152, 31744, v151
    v_add_u32 v153, 63488, v151
    v_add_u32 v154, 95232, v151
    s_mul_i32 s49, s45, 258048
    s_lshl_b32 s50, s46, 8
    s_mov_b32 s18, 258048
    s_mov_b32 s19, 0x00020000
    s_sub_u32 s22, 4718592, s50
    s_mov_b32 s23, 0x00020000
    s_lshr_b32 s49, s2, 5
    s_mul_i32 s49, s49, 1
    s_bfe_u32 s50, s2, 131075
    s_mul_i32 s50, s50, 1
    s_add_u32 s49, s49, s50
    s_lshr_b32 s49, s49, 0
    s_sub_u32 s50, s49, 9
    s_cmp_ge_u32 s49, 9
    s_cselect_b32 s49, s50, s49
    s_lshl_b32 s42, s49, 7
    s_mul_i32 s49, s45, 258048
    s_lshl_b32 s50, s46, 8
    s_waitcnt lgkmcnt(0)
    s_add_u32 s16, s4, s49
    s_addc_u32 s17, s5, 0
    s_add_u32 s20, s10, s50
    s_addc_u32 s21, s11, 0
    s_add_u32 m0, s39, 90112
    s_nop 0
    buffer_load_dwordx4 v144, s[16:19], s42 offen lds
    buffer_load_dwordx4 v145, s[16:19], s42 offen offset:1024 lds
    buffer_load_dwordx4 v146, s[16:19], s42 offen offset:2048 lds
    buffer_load_dwordx4 v147, s[16:19], s42 offen offset:3072 lds
    s_add_u32 m0, s39, 94208
    s_nop 0
    buffer_load_dwordx4 v148, s[16:19], s42 offen lds
    buffer_load_dwordx4 v149, s[16:19], s42 offen offset:1024 lds
    buffer_load_dwordx4 v150, s[16:19], s42 offen offset:2048 lds
    s_lshl_b32 s43, s42, 12
    s_add_u32 m0, s44, 118784
    s_nop 0
    buffer_load_dwordx4 v151, s[20:23], s43 offen lds
    buffer_load_dwordx4 v152, s[20:23], s43 offen offset:1024 lds
    buffer_load_dwordx4 v153, s[20:23], s43 offen offset:2048 lds
    buffer_load_dwordx4 v154, s[20:23], s43 offen offset:3072 lds
    s_add_u32 s42, s42, 128
    s_cmp_eq_u32 s42, 1152
    s_cselect_b32 s42, 0, s42
    s_add_u32 m0, s39, 45056
    s_nop 0
    buffer_load_dwordx4 v144, s[16:19], s42 offen lds
    buffer_load_dwordx4 v145, s[16:19], s42 offen offset:1024 lds
    buffer_load_dwordx4 v146, s[16:19], s42 offen offset:2048 lds
    buffer_load_dwordx4 v147, s[16:19], s42 offen offset:3072 lds
    s_add_u32 m0, s39, 49152
    s_nop 0
    buffer_load_dwordx4 v148, s[16:19], s42 offen lds
    buffer_load_dwordx4 v149, s[16:19], s42 offen offset:1024 lds
    buffer_load_dwordx4 v150, s[16:19], s42 offen offset:2048 lds
    s_lshl_b32 s43, s42, 12
    s_add_u32 m0, s44, 73728
    s_nop 0
    buffer_load_dwordx4 v151, s[20:23], s43 offen lds
    buffer_load_dwordx4 v152, s[20:23], s43 offen offset:1024 lds
    buffer_load_dwordx4 v153, s[20:23], s43 offen offset:2048 lds
    buffer_load_dwordx4 v154, s[20:23], s43 offen offset:3072 lds
    s_lshl_b32 s49, s45, 5
    s_add_u32 s49, s49, s46
    s_lshl_b32 s49, s49, 18
    s_add_u32 s24, s6, s49
    s_addc_u32 s25, s7, 0
    s_mov_b32 s26, 262144
    s_mov_b32 s27, 0x00020000
    s_add_u32 s28, s8, s49
    s_addc_u32 s29, s9, 0
    s_mov_b32 s30, 262144
    s_mov_b32 s31, 0x00020000
    s_mov_b32 s32, s12
    s_mov_b32 s33, s13
    s_mov_b32 s34, 14680064
    s_mov_b32 s35, 0x00020000
    s_load_dwordx4 s[4:7], s[0:1], 32
    s_load_dwordx2 s[8:9], s[0:1], 48
    v_and_b32 v243, 63, v242
    v_and_b32 v244, 15, v243
    v_lshrrev_b32 v245, 4, v243
    v_lshlrev_b32 v248, 1, v245
    v_xor_b32 v248, v248, v244
    v_lshlrev_b32 v248, 4, v248
    v_lshlrev_b32 v249, 8, v245
    v_add_u32 v249, s44, v249
    v_add_u32 v240, v248, v249
    v_xor_b32 v248, 128, v248
    v_add_u32 v241, v248, v249
    s_add_u32 m0, s44, 147456
    s_nop 0
    buffer_load_dwordx4 v240, s[24:27], 0 offen nt lds
    buffer_load_dwordx4 v241, s[24:27], 0 offen offset:1024 nt lds
    buffer_load_dwordx4 v240, s[24:27], 0 offen offset:2048 nt lds
    buffer_load_dwordx4 v241, s[24:27], 0 offen offset:3072 nt lds
    s_lshr_b32 s49, s36, 1
    s_cmp_eq_u32 s49, 0
    s_cselect_b32 s12, s24, s28
    s_cselect_b32 s13, s25, s29
    s_and_b32 s49, s36, 1
    s_lshl_b32 s49, s49, 13
    s_add_u32 s12, s12, s49
    s_addc_u32 s13, s13, 0
    s_sub_u32 s14, 262144, s49
    s_mov_b32 s15, 0x00020000
    v_lshlrev_b32 v112, 7, v243
    v_add_u32 v112, 16384, v112
    v_and_b32 v243, 63, v242
    v_and_b32 v244, 15, v243
    v_lshrrev_b32 v245, 4, v243
    v_bfe_u32 v246, v243, 2, 2
    v_and_b32 v247, 3, v243
    s_lshl_b32 s49, s38, 13
    s_add_u32 s50, s49, 147456
    v_and_b32 v248, 7, v244
    v_lshlrev_b32 v248, 1, v248
    v_xor_b32 v248, v248, v245
    v_lshlrev_b32 v248, 4, v248
    v_lshlrev_b32 v249, 8, v244
    v_add_u32 v249, s50, v249
    v_xor_b32 v228, 0, v248
    v_add_u32 v228, v228, v249
    v_xor_b32 v229, 64, v248
    v_add_u32 v229, v229, v249
    v_xor_b32 v230, 128, v248
    v_add_u32 v230, v230, v249
    v_xor_b32 v231, 192, v248
    v_add_u32 v231, v231, v249
    s_add_u32 s50, s49, 131072
    v_lshlrev_b32 v249, 2, v245
    v_add_u32 v249, v249, v246
    v_and_b32 v248, 7, v249
    s_lshl_b32 s51, s38, 2
    v_xor_b32 v248, s51, v248
    v_lshlrev_b32 v248, 5, v248
    v_lshlrev_b32 v249, 8, v249
    v_add_u32 v249, s50, v249
    v_lshlrev_b32 v247, 3, v247
    v_add_u32 v249, v249, v247
    v_xor_b32 v232, 0, v248
    v_add_u32 v232, v232, v249
    v_xor_b32 v233, 32, v248
    v_add_u32 v233, v233, v249
    v_xor_b32 v234, 64, v248
    v_add_u32 v234, v234, v249
    v_xor_b32 v235, 96, v248
    v_add_u32 v235, v235, v249
    v_xor_b32 v236, 128, v248
    v_add_u32 v236, v236, v249
    v_xor_b32 v237, 160, v248
    v_add_u32 v237, v237, v249
    v_xor_b32 v238, 192, v248
    v_add_u32 v238, v238, v249
    v_xor_b32 v239, 224, v248
    v_add_u32 v239, v239, v249
    s_mov_b32 s40, 0x3e0293ee
    s_mov_b32 s48, 0
    v_bfe_u32 v246, v243, 2, 2
    v_and_b32 v247, 3, v243
    v_lshrrev_b32 v248, 1, v244
    v_xor_b32 v248, v248, v245
    v_lshlrev_b32 v248, 4, v248
    v_lshlrev_b32 v249, 7, v244
    s_mul_i32 s49, s37, 14336
    v_add_u32 v249, s49, v249
    v_add_u32 v156, v248, v249
    v_xor_b32 v248, 64, v248
    v_add_u32 v157, v248, v249
    v_add_u32 v158, 90112, v156
    v_add_u32 v159, 90112, v157
    s_lshl_b32 s49, s38, 1
    v_xor_b32 v248, s49, v246
    v_lshlrev_b32 v248, 6, v248
    v_lshlrev_b32 v249, 3, v245
    v_add_u32 v249, v249, v246
    v_lshlrev_b32 v249, 8, v249
    v_lshlrev_b32 v247, 4, v247
    v_add_u32 v249, v249, v247
    v_add_u32 v249, 28672, v249
    v_add_u32 v160, v248, v249
    v_xor_b32 v248, 64, v248
    v_add_u32 v161, v248, v249
    v_add_u32 v162, 90112, v160
    v_add_u32 v163, 90112, v161
    v_lshlrev_b32 v248, 4, v243
    s_mul_i32 s49, s37, 28672
    v_add_u32 v254, s49, v248
    s_mul_i32 s50, s38, 14336
    v_add_u32 v253, s50, v254
    v_mov_b32 v200, 0
    v_mov_b32 v201, 0
    v_mov_b32 v202, 0
    v_mov_b32 v203, 0
    v_mov_b32 v204, 0
    v_mov_b32 v205, 0
    v_mov_b32 v206, 0
    v_mov_b32 v207, 0
    v_mov_b32 v208, 0
    v_mov_b32 v209, 0
    v_mov_b32 v210, 0
    v_mov_b32 v211, 0
    v_mov_b32 v212, 0
    v_mov_b32 v213, 0
    v_mov_b32 v214, 0
    v_mov_b32 v215, 0
    v_mov_b32 v216, 0
    v_mov_b32 v217, 0
    v_mov_b32 v218, 0
    v_mov_b32 v219, 0
    v_mov_b32 v220, 0
    v_mov_b32 v221, 0
    v_mov_b32 v222, 0
    v_mov_b32 v223, 0
    v_mov_b32 v224, 0
    v_mov_b32 v225, 0
    v_mov_b32 v226, 0
    v_mov_b32 v227, 0
    v_mov_b32 v248, 0x3f803f80
    v_accvgpr_write_b32 a252, v248
    v_accvgpr_write_b32 a253, v248
    v_accvgpr_write_b32 a254, v248
    v_accvgpr_write_b32 a255, v248
    v_mov_b32 v243, v112
    s_waitcnt vmcnt(15)
    s_barrier
    ds_read_b64_tr_b16 a[56:57], v162 offset:0
    ds_read_b64_tr_b16 a[58:59], v162 offset:1024
    ds_read_b64_tr_b16 a[60:61], v162 offset:8
    ds_read_b64_tr_b16 a[62:63], v162 offset:1032
    ds_read_b64_tr_b16 a[64:65], v163 offset:0
    ds_read_b64_tr_b16 a[66:67], v163 offset:1024
    ds_read_b64_tr_b16 a[68:69], v163 offset:8
    ds_read_b64_tr_b16 a[70:71], v163 offset:1032
    ds_read_b128 a[0:3], v158 offset:0
    ds_read_b128 a[4:7], v158 offset:2048
    ds_read_b128 a[8:11], v158 offset:4096
    ds_read_b128 a[12:15], v158 offset:6144
    ds_read_b128 a[16:19], v158 offset:8192
    ds_read_b128 a[20:23], v158 offset:10240
    ds_read_b128 a[24:27], v158 offset:12288
    ds_read_b64_tr_b16 a[72:73], v162 offset:8192
    ds_read_b64_tr_b16 a[74:75], v162 offset:9216
    ds_read_b64_tr_b16 a[76:77], v162 offset:8200
    ds_read_b64_tr_b16 a[78:79], v162 offset:9224
    ds_read_b64_tr_b16 a[80:81], v163 offset:8192
    ds_read_b64_tr_b16 a[82:83], v163 offset:9216
    ds_read_b64_tr_b16 a[84:85], v163 offset:8200
    ds_read_b64_tr_b16 a[86:87], v163 offset:9224
    ds_read_b128 a[28:31], v159 offset:0
    ds_read_b128 a[32:35], v159 offset:2048
    ds_read_b128 a[36:39], v159 offset:4096
    ds_read_b128 a[40:43], v159 offset:6144
    ds_read_b128 a[44:47], v159 offset:8192
    ds_read_b128 a[48:51], v159 offset:10240
    ds_read_b128 a[52:55], v159 offset:12288
    s_add_u32 s42, s42, 128
    s_cmp_eq_u32 s42, 1152
    s_cselect_b32 s42, 0, s42
    s_add_u32 m0, s39, 0
    s_nop 0
    buffer_load_dwordx4 v144, s[16:19], s42 offen lds
    buffer_load_dwordx4 v145, s[16:19], s42 offen offset:1024 lds
    buffer_load_dwordx4 v146, s[16:19], s42 offen offset:2048 lds
    buffer_load_dwordx4 v147, s[16:19], s42 offen offset:3072 lds
    s_add_u32 m0, s39, 4096
    s_nop 0
    buffer_load_dwordx4 v148, s[16:19], s42 offen lds
    buffer_load_dwordx4 v149, s[16:19], s42 offen offset:1024 lds
    buffer_load_dwordx4 v150, s[16:19], s42 offen offset:2048 lds
    s_lshl_b32 s43, s42, 12
    s_add_u32 m0, s44, 28672
    s_nop 0
    buffer_load_dwordx4 v151, s[20:23], s43 offen lds
    buffer_load_dwordx4 v152, s[20:23], s43 offen offset:1024 lds
    buffer_load_dwordx4 v153, s[20:23], s43 offen offset:2048 lds
    buffer_load_dwordx4 v154, s[20:23], s43 offen offset:3072 lds
    s_waitcnt vmcnt(15)
    s_waitcnt lgkmcnt(0)
    s_barrier
    v_mfma_f32_16x16x32_bf16 v[0:3], a[56:59], a[0:3], 0
    ds_read_b64_tr_b16 a[144:145], v160 offset:45056
    v_mfma_f32_16x16x32_bf16 v[4:7], a[56:59], a[4:7], 0
    ds_read_b64_tr_b16 a[146:147], v160 offset:46080
    s_add_u32 s42, s42, 128
    s_cmp_eq_u32 s42, 1152
    s_cselect_b32 s42, 0, s42
    s_add_u32 m0, s39, 90112
    v_mfma_f32_16x16x32_bf16 v[8:11], a[56:59], a[8:11], 0
    buffer_load_dwordx4 v144, s[16:19], s42 offen lds
    v_mfma_f32_16x16x32_bf16 v[12:15], a[56:59], a[12:15], 0
    ds_read_b64_tr_b16 a[148:149], v160 offset:45064
    v_mfma_f32_16x16x32_bf16 v[16:19], a[56:59], a[16:19], 0
    ds_read_b64_tr_b16 a[150:151], v160 offset:46088
    v_mfma_f32_16x16x32_bf16 v[20:23], a[56:59], a[20:23], 0
    ds_read_b64_tr_b16 a[152:153], v161 offset:45056
    v_mfma_f32_16x16x32_bf16 v[24:27], a[56:59], a[24:27], 0
    ds_read_b64_tr_b16 a[154:155], v161 offset:46080
    v_mfma_f32_16x16x32_bf16 v[28:31], a[60:63], a[0:3], 0
    buffer_load_dwordx4 v145, s[16:19], s42 offen offset:1024 lds
    v_mfma_f32_16x16x32_bf16 v[32:35], a[60:63], a[4:7], 0
    ds_read_b64_tr_b16 a[156:157], v161 offset:45064
    v_mfma_f32_16x16x32_bf16 v[36:39], a[60:63], a[8:11], 0
    ds_read_b64_tr_b16 a[158:159], v161 offset:46088
    v_mfma_f32_16x16x32_bf16 v[40:43], a[60:63], a[12:15], 0
    ds_read_b128 a[88:91], v156 offset:45056
    v_mfma_f32_16x16x32_bf16 v[44:47], a[60:63], a[16:19], 0
    ds_read_b128 a[92:95], v156 offset:47104
    v_mfma_f32_16x16x32_bf16 v[48:51], a[60:63], a[20:23], 0
    buffer_load_dwordx4 v146, s[16:19], s42 offen offset:2048 lds
    v_mfma_f32_16x16x32_bf16 v[52:55], a[60:63], a[24:27], 0
    ds_read_b128 a[96:99], v156 offset:49152
    v_mfma_f32_16x16x32_bf16 v[56:59], a[64:67], a[0:3], 0
    ds_read_b128 a[100:103], v156 offset:51200
    v_mfma_f32_16x16x32_bf16 v[60:63], a[64:67], a[4:7], 0
    ds_read_b128 a[104:107], v156 offset:53248
    v_mfma_f32_16x16x32_bf16 v[64:67], a[64:67], a[8:11], 0
    ds_read_b128 a[108:111], v156 offset:55296
    v_mfma_f32_16x16x32_bf16 v[68:71], a[64:67], a[12:15], 0
    buffer_load_dwordx4 v147, s[16:19], s42 offen offset:3072 lds
    v_mfma_f32_16x16x32_bf16 v[72:75], a[64:67], a[16:19], 0
    ds_read_b128 a[112:115], v156 offset:57344
    v_mfma_f32_16x16x32_bf16 v[76:79], a[64:67], a[20:23], 0
    ds_read_b64_tr_b16 a[160:161], v160 offset:53248
    v_mfma_f32_16x16x32_bf16 v[80:83], a[64:67], a[24:27], 0
    ds_read_b64_tr_b16 a[162:163], v160 offset:54272
    v_mfma_f32_16x16x32_bf16 v[84:87], a[68:71], a[0:3], 0
    ds_read_b64_tr_b16 a[164:165], v160 offset:53256
    s_add_u32 m0, s39, 94208
    v_mfma_f32_16x16x32_bf16 v[88:91], a[68:71], a[4:7], 0
    buffer_load_dwordx4 v148, s[16:19], s42 offen lds
    v_mfma_f32_16x16x32_bf16 v[92:95], a[68:71], a[8:11], 0
    ds_read_b64_tr_b16 a[166:167], v160 offset:54280
    v_mfma_f32_16x16x32_bf16 v[96:99], a[68:71], a[12:15], 0
    ds_read_b64_tr_b16 a[168:169], v161 offset:53248
    v_mfma_f32_16x16x32_bf16 v[100:103], a[68:71], a[16:19], 0
    ds_read_b64_tr_b16 a[170:171], v161 offset:54272
    v_mfma_f32_16x16x32_bf16 v[104:107], a[68:71], a[20:23], 0
    ds_read_b64_tr_b16 a[172:173], v161 offset:53256
    v_mfma_f32_16x16x32_bf16 v[108:111], a[68:71], a[24:27], 0
    buffer_load_dwordx4 v149, s[16:19], s42 offen offset:1024 lds
    v_mfma_f32_16x16x32_bf16 v[0:3], a[72:75], a[28:31], v[0:3]
    ds_read_b64_tr_b16 a[174:175], v161 offset:54280
    v_mfma_f32_16x16x32_bf16 v[4:7], a[72:75], a[32:35], v[4:7]
    ds_read_b128 a[116:119], v157 offset:45056
    v_mfma_f32_16x16x32_bf16 v[8:11], a[72:75], a[36:39], v[8:11]
    ds_read_b128 a[120:123], v157 offset:47104
    v_mfma_f32_16x16x32_bf16 v[12:15], a[72:75], a[40:43], v[12:15]
    ds_read_b128 a[124:127], v157 offset:49152
    v_mfma_f32_16x16x32_bf16 v[16:19], a[72:75], a[44:47], v[16:19]
    buffer_load_dwordx4 v150, s[16:19], s42 offen offset:2048 lds
    v_mfma_f32_16x16x32_bf16 v[20:23], a[72:75], a[48:51], v[20:23]
    ds_read_b128 a[128:131], v157 offset:51200
    v_mfma_f32_16x16x32_bf16 v[24:27], a[72:75], a[52:55], v[24:27]
    ds_read_b128 a[132:135], v157 offset:53248
    v_mfma_f32_16x16x32_bf16 v[28:31], a[76:79], a[28:31], v[28:31]
    ds_read_b128 a[136:139], v157 offset:55296
    v_mfma_f32_16x16x32_bf16 v[32:35], a[76:79], a[32:35], v[32:35]
    ds_read_b128 a[140:143], v157 offset:57344
    s_lshl_b32 s43, s42, 12
    s_add_u32 m0, s44, 118784
    v_mfma_f32_16x16x32_bf16 v[36:39], a[76:79], a[36:39], v[36:39]
    buffer_load_dwordx4 v151, s[20:23], s43 offen lds
    v_mfma_f32_16x16x32_bf16 v[40:43], a[76:79], a[40:43], v[40:43]
    v_mfma_f32_16x16x32_bf16 v[44:47], a[76:79], a[44:47], v[44:47]
    v_mfma_f32_16x16x32_bf16 v[48:51], a[76:79], a[48:51], v[48:51]
    v_mfma_f32_16x16x32_bf16 v[52:55], a[76:79], a[52:55], v[52:55]
    v_mfma_f32_16x16x32_bf16 v[56:59], a[80:83], a[28:31], v[56:59]
    buffer_load_dwordx4 v152, s[20:23], s43 offen offset:1024 lds
    v_mfma_f32_16x16x32_bf16 v[60:63], a[80:83], a[32:35], v[60:63]
    v_mfma_f32_16x16x32_bf16 v[64:67], a[80:83], a[36:39], v[64:67]
    v_mfma_f32_16x16x32_bf16 v[68:71], a[80:83], a[40:43], v[68:71]
    v_mfma_f32_16x16x32_bf16 v[72:75], a[80:83], a[44:47], v[72:75]
    v_mfma_f32_16x16x32_bf16 v[76:79], a[80:83], a[48:51], v[76:79]
    buffer_load_dwordx4 v153, s[20:23], s43 offen offset:2048 lds
    v_mfma_f32_16x16x32_bf16 v[80:83], a[80:83], a[52:55], v[80:83]
    v_mfma_f32_16x16x32_bf16 v[84:87], a[84:87], a[28:31], v[84:87]
    v_mfma_f32_16x16x32_bf16 v[88:91], a[84:87], a[32:35], v[88:91]
    v_mfma_f32_16x16x32_bf16 v[92:95], a[84:87], a[36:39], v[92:95]
    v_mfma_f32_16x16x32_bf16 v[96:99], a[84:87], a[40:43], v[96:99]
    buffer_load_dwordx4 v154, s[20:23], s43 offen offset:3072 lds
    v_mfma_f32_16x16x32_bf16 v[100:103], a[84:87], a[44:47], v[100:103]
    v_mfma_f32_16x16x32_bf16 v[104:107], a[84:87], a[48:51], v[104:107]
    v_mfma_f32_16x16x32_bf16 v[108:111], a[84:87], a[52:55], v[108:111]
    s_waitcnt vmcnt(11)
    s_waitcnt lgkmcnt(0)
    s_barrier
    v_mfma_f32_16x16x32_bf16 v[0:3], a[144:147], a[88:91], v[0:3]
    ds_read_b64_tr_b16 a[56:57], v160 offset:0
    v_mfma_f32_16x16x32_bf16 v[4:7], a[144:147], a[92:95], v[4:7]
    ds_read_b64_tr_b16 a[58:59], v160 offset:1024
    s_add_u32 s42, s42, 128
    s_cmp_eq_u32 s42, 1152
    s_cselect_b32 s42, 0, s42
    s_add_u32 m0, s39, 45056
    v_mfma_f32_16x16x32_bf16 v[8:11], a[144:147], a[96:99], v[8:11]
    buffer_load_dwordx4 v144, s[16:19], s42 offen lds
    v_mfma_f32_16x16x32_bf16 v[12:15], a[144:147], a[100:103], v[12:15]
    ds_read_b64_tr_b16 a[60:61], v160 offset:8
    v_mfma_f32_16x16x32_bf16 v[16:19], a[144:147], a[104:107], v[16:19]
    ds_read_b64_tr_b16 a[62:63], v160 offset:1032
    v_mfma_f32_16x16x32_bf16 v[20:23], a[144:147], a[108:111], v[20:23]
    ds_read_b64_tr_b16 a[64:65], v161 offset:0
    v_mfma_f32_16x16x32_bf16 v[24:27], a[144:147], a[112:115], v[24:27]
    ds_read_b64_tr_b16 a[66:67], v161 offset:1024
    v_mfma_f32_16x16x32_bf16 v[28:31], a[148:151], a[88:91], v[28:31]
    buffer_load_dwordx4 v145, s[16:19], s42 offen offset:1024 lds
    v_mfma_f32_16x16x32_bf16 v[32:35], a[148:151], a[92:95], v[32:35]
    ds_read_b64_tr_b16 a[68:69], v161 offset:8
    v_mfma_f32_16x16x32_bf16 v[36:39], a[148:151], a[96:99], v[36:39]
    ds_read_b64_tr_b16 a[70:71], v161 offset:1032
    v_mfma_f32_16x16x32_bf16 v[40:43], a[148:151], a[100:103], v[40:43]
    ds_read_b128 a[0:3], v156 offset:0
    v_mfma_f32_16x16x32_bf16 v[44:47], a[148:151], a[104:107], v[44:47]
    ds_read_b128 a[4:7], v156 offset:2048
    v_mfma_f32_16x16x32_bf16 v[48:51], a[148:151], a[108:111], v[48:51]
    buffer_load_dwordx4 v146, s[16:19], s42 offen offset:2048 lds
    v_mfma_f32_16x16x32_bf16 v[52:55], a[148:151], a[112:115], v[52:55]
    ds_read_b128 a[8:11], v156 offset:4096
    v_mfma_f32_16x16x32_bf16 v[56:59], a[152:155], a[88:91], v[56:59]
    ds_read_b128 a[12:15], v156 offset:6144
    v_mfma_f32_16x16x32_bf16 v[60:63], a[152:155], a[92:95], v[60:63]
    ds_read_b128 a[16:19], v156 offset:8192
    v_mfma_f32_16x16x32_bf16 v[64:67], a[152:155], a[96:99], v[64:67]
    ds_read_b128 a[20:23], v156 offset:10240
    v_mfma_f32_16x16x32_bf16 v[68:71], a[152:155], a[100:103], v[68:71]
    buffer_load_dwordx4 v147, s[16:19], s42 offen offset:3072 lds
    v_mfma_f32_16x16x32_bf16 v[72:75], a[152:155], a[104:107], v[72:75]
    ds_read_b128 a[24:27], v156 offset:12288
    v_mfma_f32_16x16x32_bf16 v[76:79], a[152:155], a[108:111], v[76:79]
    ds_read_b64_tr_b16 a[72:73], v160 offset:8192
    v_mfma_f32_16x16x32_bf16 v[80:83], a[152:155], a[112:115], v[80:83]
    ds_read_b64_tr_b16 a[74:75], v160 offset:9216
    v_mfma_f32_16x16x32_bf16 v[84:87], a[156:159], a[88:91], v[84:87]
    ds_read_b64_tr_b16 a[76:77], v160 offset:8200
    s_add_u32 m0, s39, 49152
    v_mfma_f32_16x16x32_bf16 v[88:91], a[156:159], a[92:95], v[88:91]
    buffer_load_dwordx4 v148, s[16:19], s42 offen lds
    v_mfma_f32_16x16x32_bf16 v[92:95], a[156:159], a[96:99], v[92:95]
    ds_read_b64_tr_b16 a[78:79], v160 offset:9224
    v_mfma_f32_16x16x32_bf16 v[96:99], a[156:159], a[100:103], v[96:99]
    ds_read_b64_tr_b16 a[80:81], v161 offset:8192
    v_mfma_f32_16x16x32_bf16 v[100:103], a[156:159], a[104:107], v[100:103]
    ds_read_b64_tr_b16 a[82:83], v161 offset:9216
    v_mfma_f32_16x16x32_bf16 v[104:107], a[156:159], a[108:111], v[104:107]
    ds_read_b64_tr_b16 a[84:85], v161 offset:8200
    v_mfma_f32_16x16x32_bf16 v[108:111], a[156:159], a[112:115], v[108:111]
    buffer_load_dwordx4 v149, s[16:19], s42 offen offset:1024 lds
    v_mfma_f32_16x16x32_bf16 v[0:3], a[160:163], a[116:119], v[0:3]
    ds_read_b64_tr_b16 a[86:87], v161 offset:9224
    v_mfma_f32_16x16x32_bf16 v[4:7], a[160:163], a[120:123], v[4:7]
    ds_read_b128 a[28:31], v157 offset:0
    v_mfma_f32_16x16x32_bf16 v[8:11], a[160:163], a[124:127], v[8:11]
    ds_read_b128 a[32:35], v157 offset:2048
    v_mfma_f32_16x16x32_bf16 v[12:15], a[160:163], a[128:131], v[12:15]
    ds_read_b128 a[36:39], v157 offset:4096
    v_mfma_f32_16x16x32_bf16 v[16:19], a[160:163], a[132:135], v[16:19]
    buffer_load_dwordx4 v150, s[16:19], s42 offen offset:2048 lds
    v_mfma_f32_16x16x32_bf16 v[20:23], a[160:163], a[136:139], v[20:23]
    ds_read_b128 a[40:43], v157 offset:6144
    v_mfma_f32_16x16x32_bf16 v[24:27], a[160:163], a[140:143], v[24:27]
    ds_read_b128 a[44:47], v157 offset:8192
    v_mfma_f32_16x16x32_bf16 v[28:31], a[164:167], a[116:119], v[28:31]
    ds_read_b128 a[48:51], v157 offset:10240
    v_mfma_f32_16x16x32_bf16 v[32:35], a[164:167], a[120:123], v[32:35]
    ds_read_b128 a[52:55], v157 offset:12288
    s_lshl_b32 s43, s42, 12
    s_add_u32 m0, s44, 73728
    v_mfma_f32_16x16x32_bf16 v[36:39], a[164:167], a[124:127], v[36:39]
    buffer_load_dwordx4 v151, s[20:23], s43 offen lds
    v_mfma_f32_16x16x32_bf16 v[40:43], a[164:167], a[128:131], v[40:43]
    v_mfma_f32_16x16x32_bf16 v[44:47], a[164:167], a[132:135], v[44:47]
    v_mfma_f32_16x16x32_bf16 v[48:51], a[164:167], a[136:139], v[48:51]
    v_mfma_f32_16x16x32_bf16 v[52:55], a[164:167], a[140:143], v[52:55]
    v_mfma_f32_16x16x32_bf16 v[56:59], a[168:171], a[116:119], v[56:59]
    buffer_load_dwordx4 v152, s[20:23], s43 offen offset:1024 lds
    v_mfma_f32_16x16x32_bf16 v[60:63], a[168:171], a[120:123], v[60:63]
    v_mfma_f32_16x16x32_bf16 v[64:67], a[168:171], a[124:127], v[64:67]
    v_mfma_f32_16x16x32_bf16 v[68:71], a[168:171], a[128:131], v[68:71]
    v_mfma_f32_16x16x32_bf16 v[72:75], a[168:171], a[132:135], v[72:75]
    v_mfma_f32_16x16x32_bf16 v[76:79], a[168:171], a[136:139], v[76:79]
    buffer_load_dwordx4 v153, s[20:23], s43 offen offset:2048 lds
    v_mfma_f32_16x16x32_bf16 v[80:83], a[168:171], a[140:143], v[80:83]
    v_mfma_f32_16x16x32_bf16 v[84:87], a[172:175], a[116:119], v[84:87]
    v_mfma_f32_16x16x32_bf16 v[88:91], a[172:175], a[120:123], v[88:91]
    v_mfma_f32_16x16x32_bf16 v[92:95], a[172:175], a[124:127], v[92:95]
    v_mfma_f32_16x16x32_bf16 v[96:99], a[172:175], a[128:131], v[96:99]
    buffer_load_dwordx4 v154, s[20:23], s43 offen offset:3072 lds
    v_mfma_f32_16x16x32_bf16 v[100:103], a[172:175], a[132:135], v[100:103]
    v_mfma_f32_16x16x32_bf16 v[104:107], a[172:175], a[136:139], v[104:107]
    v_mfma_f32_16x16x32_bf16 v[108:111], a[172:175], a[140:143], v[108:111]
    s_waitcnt vmcnt(11)
    s_waitcnt lgkmcnt(0)
    s_barrier
    v_mfma_f32_16x16x32_bf16 v[0:3], a[56:59], a[0:3], v[0:3]
    ds_read_b64_tr_b16 a[144:145], v162 offset:0
    v_mfma_f32_16x16x32_bf16 v[4:7], a[56:59], a[4:7], v[4:7]
    ds_read_b64_tr_b16 a[146:147], v162 offset:1024
    s_add_u32 s42, s42, 128
    s_cmp_eq_u32 s42, 1152
    s_cselect_b32 s42, 0, s42
    s_add_u32 m0, s39, 0
    v_mfma_f32_16x16x32_bf16 v[8:11], a[56:59], a[8:11], v[8:11]
    buffer_load_dwordx4 v144, s[16:19], s42 offen lds
    v_mfma_f32_16x16x32_bf16 v[12:15], a[56:59], a[12:15], v[12:15]
    ds_read_b64_tr_b16 a[148:149], v162 offset:8
    v_mfma_f32_16x16x32_bf16 v[16:19], a[56:59], a[16:19], v[16:19]
    ds_read_b64_tr_b16 a[150:151], v162 offset:1032
    v_mfma_f32_16x16x32_bf16 v[20:23], a[56:59], a[20:23], v[20:23]
    ds_read_b64_tr_b16 a[152:153], v163 offset:0
    v_mfma_f32_16x16x32_bf16 v[24:27], a[56:59], a[24:27], v[24:27]
    ds_read_b64_tr_b16 a[154:155], v163 offset:1024
    buffer_load_dwordx4 v145, s[16:19], s42 offen offset:1024 lds
    v_mfma_f32_16x16x32_bf16 v[28:31], a[60:63], a[0:3], v[28:31]
    v_mfma_f32_16x16x32_bf16 v[32:35], a[60:63], a[4:7], v[32:35]
    ds_read_b64_tr_b16 a[156:157], v163 offset:8
    v_mfma_f32_16x16x32_bf16 v[36:39], a[60:63], a[8:11], v[36:39]
    ds_read_b64_tr_b16 a[158:159], v163 offset:1032
    v_mfma_f32_16x16x32_bf16 v[40:43], a[60:63], a[12:15], v[40:43]
    ds_read_b128 a[88:91], v158 offset:0
    v_mfma_f32_16x16x32_bf16 v[44:47], a[60:63], a[16:19], v[44:47]
    ds_read_b128 a[92:95], v158 offset:2048
    buffer_load_dwordx4 v146, s[16:19], s42 offen offset:2048 lds
    v_mfma_f32_16x16x32_bf16 v[48:51], a[60:63], a[20:23], v[48:51]
    v_mfma_f32_16x16x32_bf16 v[52:55], a[60:63], a[24:27], v[52:55]
    ds_read_b128 a[96:99], v158 offset:4096
    v_mfma_f32_16x16x32_bf16 v[56:59], a[64:67], a[0:3], v[56:59]
    ds_read_b128 a[100:103], v158 offset:6144
    v_mfma_f32_16x16x32_bf16 v[60:63], a[64:67], a[4:7], v[60:63]
    ds_read_b128 a[104:107], v158 offset:8192
    v_mfma_f32_16x16x32_bf16 v[64:67], a[64:67], a[8:11], v[64:67]
    ds_read_b128 a[108:111], v158 offset:10240
    buffer_load_dwordx4 v147, s[16:19], s42 offen offset:3072 lds
    v_mfma_f32_16x16x32_bf16 v[68:71], a[64:67], a[12:15], v[68:71]
    v_mfma_f32_16x16x32_bf16 v[72:75], a[64:67], a[16:19], v[72:75]
    ds_read_b128 a[112:115], v158 offset:12288
    v_mfma_f32_16x16x32_bf16 v[76:79], a[64:67], a[20:23], v[76:79]
    ds_read_b64_tr_b16 a[160:161], v162 offset:8192
    s_add_u32 m0, s39, 4096
    v_mfma_f32_16x16x32_bf16 v[80:83], a[64:67], a[24:27], v[80:83]
    ds_read_b64_tr_b16 a[162:163], v162 offset:9216
    buffer_load_dwordx4 v148, s[16:19], s42 offen lds
    v_mfma_f32_16x16x32_bf16 v[84:87], a[68:71], a[0:3], v[84:87]
    ds_read_b64_tr_b16 a[164:165], v162 offset:8200
    v_mfma_f32_16x16x32_bf16 v[88:91], a[68:71], a[4:7], v[88:91]
    v_mfma_f32_16x16x32_bf16 v[92:95], a[68:71], a[8:11], v[92:95]
    ds_read_b64_tr_b16 a[166:167], v162 offset:9224
    v_mfma_f32_16x16x32_bf16 v[96:99], a[68:71], a[12:15], v[96:99]
    ds_read_b64_tr_b16 a[168:169], v163 offset:8192
    v_mfma_f32_16x16x32_bf16 v[100:103], a[68:71], a[16:19], v[100:103]
    ds_read_b64_tr_b16 a[170:171], v163 offset:9216
    buffer_load_dwordx4 v149, s[16:19], s42 offen offset:1024 lds
    v_mfma_f32_16x16x32_bf16 v[104:107], a[68:71], a[20:23], v[104:107]
    ds_read_b64_tr_b16 a[172:173], v163 offset:8200
    v_mfma_f32_16x16x32_bf16 v[108:111], a[68:71], a[24:27], v[108:111]
    v_mfma_f32_16x16x32_bf16 v[0:3], a[72:75], a[28:31], v[0:3]
    ds_read_b64_tr_b16 a[174:175], v163 offset:9224
    v_mfma_f32_16x16x32_bf16 v[4:7], a[72:75], a[32:35], v[4:7]
    ds_read_b128 a[116:119], v159 offset:0
    v_mfma_f32_16x16x32_bf16 v[8:11], a[72:75], a[36:39], v[8:11]
    ds_read_b128 a[120:123], v159 offset:2048
    buffer_load_dwordx4 v150, s[16:19], s42 offen offset:2048 lds
    v_mfma_f32_16x16x32_bf16 v[12:15], a[72:75], a[40:43], v[12:15]
    ds_read_b128 a[124:127], v159 offset:4096
    v_mfma_f32_16x16x32_bf16 v[16:19], a[72:75], a[44:47], v[16:19]
    v_mfma_f32_16x16x32_bf16 v[20:23], a[72:75], a[48:51], v[20:23]
    ds_read_b128 a[128:131], v159 offset:6144
    s_lshl_b32 s43, s42, 12
    s_add_u32 m0, s44, 28672
    v_mfma_f32_16x16x32_bf16 v[24:27], a[72:75], a[52:55], v[24:27]
    ds_read_b128 a[132:135], v159 offset:8192
    buffer_load_dwordx4 v151, s[20:23], s43 offen lds
    v_mfma_f32_16x16x32_bf16 v[28:31], a[76:79], a[28:31], v[28:31]
    ds_read_b128 a[136:139], v159 offset:10240
    v_mfma_f32_16x16x32_bf16 v[32:35], a[76:79], a[32:35], v[32:35]
    ds_read_b128 a[140:143], v159 offset:12288
    v_mfma_f32_16x16x32_bf16 v[36:39], a[76:79], a[36:39], v[36:39]
    v_mfma_f32_16x16x32_bf16 v[40:43], a[76:79], a[40:43], v[40:43]
    s_mul_i32 s100, s36, 40960
    s_and_b32 s49, s2, 7
    v_mfma_f32_16x16x32_bf16 v[44:47], a[76:79], a[44:47], v[44:47]
    buffer_load_dwordx4 v152, s[20:23], s43 offen offset:1024 lds
    s_lshr_b32 s50, s2, 3
    s_and_b32 s51, s49, 1
    v_mfma_f32_16x16x32_bf16 v[48:51], a[76:79], a[48:51], v[48:51]
    s_lshl_b32 s51, s51, 5
    s_add_u32 s50, s50, s51
    v_mfma_f32_16x16x32_bf16 v[52:55], a[76:79], a[52:55], v[52:55]
    s_lshr_b32 s49, s49, 1
    s_mul_i32 s49, s49, 7
    v_mfma_f32_16x16x32_bf16 v[56:59], a[80:83], a[28:31], v[56:59]
    s_mul_i32 s58, s50, 37
    v_mfma_f32_16x16x32_bf16 v[60:63], a[80:83], a[32:35], v[60:63]
    s_lshr_b32 s58, s58, 8
    s_mul_i32 s51, s58, 7
    v_mfma_f32_16x16x32_bf16 v[64:67], a[80:83], a[36:39], v[64:67]
    buffer_load_dwordx4 v153, s[20:23], s43 offen offset:2048 lds
    s_sub_u32 s51, s50, s51
    s_add_u32 s57, s51, s49
    v_mfma_f32_16x16x32_bf16 v[68:71], a[80:83], a[40:43], v[68:71]
    s_cmp_ge_u32 s50, 63
    s_cselect_b32 s58, 15, s58
    v_mfma_f32_16x16x32_bf16 v[72:75], a[80:83], a[44:47], v[72:75]
    s_cselect_b32 s57, 0, s57
    v_mfma_f32_16x16x32_bf16 v[76:79], a[80:83], a[48:51], v[76:79]
    s_mul_i32 s49, s36, 1179648
    s_lshl_b32 s50, s58, 7
    v_mfma_f32_16x16x32_bf16 v[80:83], a[80:83], a[52:55], v[80:83]
    buffer_load_dwordx4 v154, s[20:23], s43 offen offset:3072 lds
    s_add_u32 s59, s49, s50
    s_mul_i32 s49, s57, 524288
    v_mfma_f32_16x16x32_bf16 v[84:87], a[84:87], a[28:31], v[84:87]
    s_lshl_b32 s50, s36, 15
    s_add_u32 s10, s49, s50
    v_mfma_f32_16x16x32_bf16 v[88:91], a[84:87], a[32:35], v[88:91]
    s_lshl_b32 s49, s57, 2
    v_mfma_f32_16x16x32_bf16 v[92:95], a[84:87], a[36:39], v[92:95]
    s_mul_i32 s50, s49, 147
    s_lshr_b32 s50, s50, 11
    v_mfma_f32_16x16x32_bf16 v[96:99], a[84:87], a[40:43], v[96:99]
    s_lshl_b32 s11, s50, 3
    s_add_u32 s49, s49, 3
    v_mfma_f32_16x16x32_bf16 v[100:103], a[84:87], a[44:47], v[100:103]
    buffer_load_dword v255, v243, s[12:15], 0 offen
    s_mul_i32 s50, s49, 147
    s_lshr_b32 s50, s50, 11
    v_mfma_f32_16x16x32_bf16 v[104:107], a[84:87], a[48:51], v[104:107]
    s_lshl_b32 s3, s50, 3
    v_mfma_f32_16x16x32_bf16 v[108:111], a[84:87], a[52:55], v[108:111]
    v_add_u32 v243, 16384, v243
    s_waitcnt vmcnt(12)
    s_waitcnt lgkmcnt(0)
    s_barrier
    v_mfma_f32_16x16x32_bf16 v[0:3], a[144:147], a[88:91], v[0:3]
    ds_read_b64_tr_b16 a[56:57], v160 offset:45056
    v_mfma_f32_16x16x32_bf16 v[4:7], a[144:147], a[92:95], v[4:7]
    ds_read_b64_tr_b16 a[58:59], v160 offset:46080
    s_add_u32 s42, s42, 128
    s_cmp_eq_u32 s42, 1152
    s_cselect_b32 s42, 0, s42
    s_add_u32 m0, s39, 90112
    v_mfma_f32_16x16x32_bf16 v[8:11], a[144:147], a[96:99], v[8:11]
    buffer_load_dwordx4 v144, s[16:19], s42 offen lds
    v_mfma_f32_16x16x32_bf16 v[12:15], a[144:147], a[100:103], v[12:15]
    ds_read_b64_tr_b16 a[60:61], v160 offset:45064
    v_mfma_f32_16x16x32_bf16 v[16:19], a[144:147], a[104:107], v[16:19]
    ds_read_b64_tr_b16 a[62:63], v160 offset:46088
    v_mfma_f32_16x16x32_bf16 v[20:23], a[144:147], a[108:111], v[20:23]
    ds_read_b64_tr_b16 a[64:65], v161 offset:45056
    v_mfma_f32_16x16x32_bf16 v[24:27], a[144:147], a[112:115], v[24:27]
    ds_read_b64_tr_b16 a[66:67], v161 offset:46080
    v_mfma_f32_16x16x32_bf16 v[28:31], a[148:151], a[88:91], v[28:31]
    buffer_load_dwordx4 v145, s[16:19], s42 offen offset:1024 lds
    v_mfma_f32_16x16x32_bf16 v[32:35], a[148:151], a[92:95], v[32:35]
    ds_read_b64_tr_b16 a[68:69], v161 offset:45064
    v_mfma_f32_16x16x32_bf16 v[36:39], a[148:151], a[96:99], v[36:39]
    ds_read_b64_tr_b16 a[70:71], v161 offset:46088
    v_mfma_f32_16x16x32_bf16 v[40:43], a[148:151], a[100:103], v[40:43]
    ds_read_b128 a[0:3], v156 offset:45056
    v_mfma_f32_16x16x32_bf16 v[44:47], a[148:151], a[104:107], v[44:47]
    ds_read_b128 a[4:7], v156 offset:47104
    v_mfma_f32_16x16x32_bf16 v[48:51], a[148:151], a[108:111], v[48:51]
    buffer_load_dwordx4 v146, s[16:19], s42 offen offset:2048 lds
    v_mfma_f32_16x16x32_bf16 v[52:55], a[148:151], a[112:115], v[52:55]
    ds_read_b128 a[8:11], v156 offset:49152
    v_mfma_f32_16x16x32_bf16 v[56:59], a[152:155], a[88:91], v[56:59]
    ds_read_b128 a[12:15], v156 offset:51200
    v_mfma_f32_16x16x32_bf16 v[60:63], a[152:155], a[92:95], v[60:63]
    ds_read_b128 a[16:19], v156 offset:53248
    v_mfma_f32_16x16x32_bf16 v[64:67], a[152:155], a[96:99], v[64:67]
    ds_read_b128 a[20:23], v156 offset:55296
    v_mfma_f32_16x16x32_bf16 v[68:71], a[152:155], a[100:103], v[68:71]
    buffer_load_dwordx4 v147, s[16:19], s42 offen offset:3072 lds
    v_mfma_f32_16x16x32_bf16 v[72:75], a[152:155], a[104:107], v[72:75]
    ds_read_b128 a[24:27], v156 offset:57344
    v_mfma_f32_16x16x32_bf16 v[76:79], a[152:155], a[108:111], v[76:79]
    ds_read_b64_tr_b16 a[72:73], v160 offset:53248
    v_mfma_f32_16x16x32_bf16 v[80:83], a[152:155], a[112:115], v[80:83]
    ds_read_b64_tr_b16 a[74:75], v160 offset:54272
    v_mfma_f32_16x16x32_bf16 v[84:87], a[156:159], a[88:91], v[84:87]
    ds_read_b64_tr_b16 a[76:77], v160 offset:53256
    s_add_u32 m0, s39, 94208
    v_mfma_f32_16x16x32_bf16 v[88:91], a[156:159], a[92:95], v[88:91]
    buffer_load_dwordx4 v148, s[16:19], s42 offen lds
    v_mfma_f32_16x16x32_bf16 v[92:95], a[156:159], a[96:99], v[92:95]
    ds_read_b64_tr_b16 a[78:79], v160 offset:54280
    v_mfma_f32_16x16x32_bf16 v[96:99], a[156:159], a[100:103], v[96:99]
    ds_read_b64_tr_b16 a[80:81], v161 offset:53248
    v_mfma_f32_16x16x32_bf16 v[100:103], a[156:159], a[104:107], v[100:103]
    ds_read_b64_tr_b16 a[82:83], v161 offset:54272
    v_mfma_f32_16x16x32_bf16 v[104:107], a[156:159], a[108:111], v[104:107]
    ds_read_b64_tr_b16 a[84:85], v161 offset:53256
    v_mfma_f32_16x16x32_bf16 v[108:111], a[156:159], a[112:115], v[108:111]
    buffer_load_dwordx4 v149, s[16:19], s42 offen offset:1024 lds
    v_mfma_f32_16x16x32_bf16 v[0:3], a[160:163], a[116:119], v[0:3]
    ds_read_b64_tr_b16 a[86:87], v161 offset:54280
    v_mfma_f32_16x16x32_bf16 v[4:7], a[160:163], a[120:123], v[4:7]
    ds_read_b128 a[28:31], v157 offset:45056
    v_mfma_f32_16x16x32_bf16 v[8:11], a[160:163], a[124:127], v[8:11]
    ds_read_b128 a[32:35], v157 offset:47104
    v_mfma_f32_16x16x32_bf16 v[12:15], a[160:163], a[128:131], v[12:15]
    ds_read_b128 a[36:39], v157 offset:49152
    v_mfma_f32_16x16x32_bf16 v[16:19], a[160:163], a[132:135], v[16:19]
    buffer_load_dwordx4 v150, s[16:19], s42 offen offset:2048 lds
    v_mfma_f32_16x16x32_bf16 v[20:23], a[160:163], a[136:139], v[20:23]
    ds_read_b128 a[40:43], v157 offset:51200
    v_mfma_f32_16x16x32_bf16 v[24:27], a[160:163], a[140:143], v[24:27]
    ds_read_b128 a[44:47], v157 offset:53248
    v_mfma_f32_16x16x32_bf16 v[28:31], a[164:167], a[116:119], v[28:31]
    ds_read_b128 a[48:51], v157 offset:55296
    v_mfma_f32_16x16x32_bf16 v[32:35], a[164:167], a[120:123], v[32:35]
    ds_read_b128 a[52:55], v157 offset:57344
    s_lshl_b32 s43, s42, 12
    s_add_u32 m0, s44, 118784
    v_mfma_f32_16x16x32_bf16 v[36:39], a[164:167], a[124:127], v[36:39]
    buffer_load_dwordx4 v151, s[20:23], s43 offen lds
    v_mfma_f32_16x16x32_bf16 v[40:43], a[164:167], a[128:131], v[40:43]
    v_and_b32 v184, 63, v242
    v_lshrrev_b32 v185, 3, v184
    v_mfma_f32_16x16x32_bf16 v[44:47], a[164:167], a[132:135], v[44:47]
    v_and_b32 v186, 7, v184
    v_bfe_u32 v187, v184, 4, 2
    v_mfma_f32_16x16x32_bf16 v[48:51], a[164:167], a[136:139], v[48:51]
    v_lshlrev_b32 v187, 1, v187
    v_mfma_f32_16x16x32_bf16 v[52:55], a[164:167], a[140:143], v[52:55]
    v_xor_b32 v186, v186, v187
    v_lshlrev_b32 v186, 4, v186
    v_mfma_f32_16x16x32_bf16 v[56:59], a[168:171], a[116:119], v[56:59]
    buffer_load_dwordx4 v152, s[20:23], s43 offen offset:1024 lds
    v_mul_u32_u24 v185, 1152, v185
    v_add_u32 v245, v185, v186
    v_mfma_f32_16x16x32_bf16 v[60:63], a[168:171], a[120:123], v[60:63]
    v_add_u32 v246, 8192, v245
    v_mfma_f32_16x16x32_bf16 v[64:67], a[168:171], a[124:127], v[64:67]
    v_add_u32 v247, 16384, v245
    v_add_u32 v248, 24576, v245
    v_mfma_f32_16x16x32_bf16 v[68:71], a[168:171], a[128:131], v[68:71]
    v_lshrrev_b32 v185, 2, v184
    v_bfe_u32 v186, v184, 3, 2
    v_mfma_f32_16x16x32_bf16 v[72:75], a[168:171], a[132:135], v[72:75]
    v_lshlrev_b32 v186, 5, v186
    v_mfma_f32_16x16x32_bf16 v[76:79], a[168:171], a[136:139], v[76:79]
    buffer_load_dwordx4 v153, s[20:23], s43 offen offset:2048 lds
    v_lshlrev_b32 v185, 7, v185
    v_and_b32 v187, 3, v184
    v_mfma_f32_16x16x32_bf16 v[80:83], a[168:171], a[140:143], v[80:83]
    v_lshlrev_b32 v187, 3, v187
    v_add_u32 v185, v185, v187
    v_mfma_f32_16x16x32_bf16 v[84:87], a[172:175], a[116:119], v[84:87]
    v_add_u32 v185, s100, v185
    v_mfma_f32_16x16x32_bf16 v[88:91], a[172:175], a[120:123], v[88:91]
    v_xor_b32 v249, 0, v186
    v_add_u32 v249, v249, v185
    v_mfma_f32_16x16x32_bf16 v[92:95], a[172:175], a[124:127], v[92:95]
    v_xor_b32 v250, 32, v186
    v_add_u32 v250, v250, v185
    v_mfma_f32_16x16x32_bf16 v[96:99], a[172:175], a[128:131], v[96:99]
    buffer_load_dwordx4 v154, s[20:23], s43 offen offset:3072 lds
    v_xor_b32 v251, 64, v186
    v_mfma_f32_16x16x32_bf16 v[100:103], a[172:175], a[132:135], v[100:103]
    v_add_u32 v251, v251, v185
    v_xor_b32 v252, 96, v186
    v_mfma_f32_16x16x32_bf16 v[104:107], a[172:175], a[136:139], v[104:107]
    v_add_u32 v252, v252, v185
    v_mfma_f32_16x16x32_bf16 v[108:111], a[172:175], a[140:143], v[108:111]
    s_waitcnt vmcnt(12)
    s_waitcnt lgkmcnt(0)
    s_barrier
    v_mfma_f32_16x16x32_bf16 v[0:3], a[56:59], a[0:3], v[0:3]
    ds_read_b64_tr_b16 a[144:145], v160 offset:0
    v_mfma_f32_16x16x32_bf16 v[4:7], a[56:59], a[4:7], v[4:7]
    ds_read_b64_tr_b16 a[146:147], v160 offset:1024
    s_add_u32 s42, s42, 128
    s_cmp_eq_u32 s42, 1152
    s_cselect_b32 s42, 0, s42
    s_add_u32 m0, s39, 45056
    v_mfma_f32_16x16x32_bf16 v[8:11], a[56:59], a[8:11], v[8:11]
    buffer_load_dwordx4 v144, s[16:19], s42 offen lds
    v_mfma_f32_16x16x32_bf16 v[12:15], a[56:59], a[12:15], v[12:15]
    ds_read_b64_tr_b16 a[148:149], v160 offset:8
    v_mfma_f32_16x16x32_bf16 v[16:19], a[56:59], a[16:19], v[16:19]
    ds_read_b64_tr_b16 a[150:151], v160 offset:1032
    v_mfma_f32_16x16x32_bf16 v[20:23], a[56:59], a[20:23], v[20:23]
    ds_read_b64_tr_b16 a[152:153], v161 offset:0
    v_mfma_f32_16x16x32_bf16 v[24:27], a[56:59], a[24:27], v[24:27]
    ds_read_b64_tr_b16 a[154:155], v161 offset:1024
    buffer_load_dwordx4 v145, s[16:19], s42 offen offset:1024 lds
    v_mfma_f32_16x16x32_bf16 v[28:31], a[60:63], a[0:3], v[28:31]
    v_mfma_f32_16x16x32_bf16 v[32:35], a[60:63], a[4:7], v[32:35]
    ds_read_b64_tr_b16 a[156:157], v161 offset:8
    v_mfma_f32_16x16x32_bf16 v[36:39], a[60:63], a[8:11], v[36:39]
    ds_read_b64_tr_b16 a[158:159], v161 offset:1032
    v_mfma_f32_16x16x32_bf16 v[40:43], a[60:63], a[12:15], v[40:43]
    ds_read_b128 a[88:91], v156 offset:0
    v_mfma_f32_16x16x32_bf16 v[44:47], a[60:63], a[16:19], v[44:47]
    ds_read_b128 a[92:95], v156 offset:2048
    buffer_load_dwordx4 v146, s[16:19], s42 offen offset:2048 lds
    v_mfma_f32_16x16x32_bf16 v[48:51], a[60:63], a[20:23], v[48:51]
    v_mfma_f32_16x16x32_bf16 v[52:55], a[60:63], a[24:27], v[52:55]
    ds_read_b128 a[96:99], v156 offset:4096
    v_mfma_f32_16x16x32_bf16 v[56:59], a[64:67], a[0:3], v[56:59]
    ds_read_b128 a[100:103], v156 offset:6144
    v_mfma_f32_16x16x32_bf16 v[60:63], a[64:67], a[4:7], v[60:63]
    ds_read_b128 a[104:107], v156 offset:8192
    v_mfma_f32_16x16x32_bf16 v[64:67], a[64:67], a[8:11], v[64:67]
    ds_read_b128 a[108:111], v156 offset:10240
    buffer_load_dwordx4 v147, s[16:19], s42 offen offset:3072 lds
    v_mfma_f32_16x16x32_bf16 v[68:71], a[64:67], a[12:15], v[68:71]
    v_mfma_f32_16x16x32_bf16 v[72:75], a[64:67], a[16:19], v[72:75]
    ds_read_b128 a[112:115], v156 offset:12288
    v_mfma_f32_16x16x32_bf16 v[76:79], a[64:67], a[20:23], v[76:79]
    ds_read_b64_tr_b16 a[160:161], v160 offset:8192
    s_add_u32 m0, s39, 49152
    v_mfma_f32_16x16x32_bf16 v[80:83], a[64:67], a[24:27], v[80:83]
    ds_read_b64_tr_b16 a[162:163], v160 offset:9216
    buffer_load_dwordx4 v148, s[16:19], s42 offen lds
    v_mfma_f32_16x16x32_bf16 v[84:87], a[68:71], a[0:3], v[84:87]
    ds_read_b64_tr_b16 a[164:165], v160 offset:8200
    v_mfma_f32_16x16x32_bf16 v[88:91], a[68:71], a[4:7], v[88:91]
    v_mfma_f32_16x16x32_bf16 v[92:95], a[68:71], a[8:11], v[92:95]
    ds_read_b64_tr_b16 a[166:167], v160 offset:9224
    v_mfma_f32_16x16x32_bf16 v[96:99], a[68:71], a[12:15], v[96:99]
    ds_read_b64_tr_b16 a[168:169], v161 offset:8192
    v_mfma_f32_16x16x32_bf16 v[100:103], a[68:71], a[16:19], v[100:103]
    ds_read_b64_tr_b16 a[170:171], v161 offset:9216
    buffer_load_dwordx4 v149, s[16:19], s42 offen offset:1024 lds
    v_mfma_f32_16x16x32_bf16 v[104:107], a[68:71], a[20:23], v[104:107]
    ds_read_b64_tr_b16 a[172:173], v161 offset:8200
    v_mfma_f32_16x16x32_bf16 v[108:111], a[68:71], a[24:27], v[108:111]
    v_mfma_f32_16x16x32_bf16 v[0:3], a[72:75], a[28:31], v[0:3]
    ds_read_b64_tr_b16 a[174:175], v161 offset:9224
    v_mfma_f32_16x16x32_bf16 v[4:7], a[72:75], a[32:35], v[4:7]
    ds_read_b128 a[116:119], v157 offset:0
    v_mfma_f32_16x16x32_bf16 v[8:11], a[72:75], a[36:39], v[8:11]
    ds_read_b128 a[120:123], v157 offset:2048
    buffer_load_dwordx4 v150, s[16:19], s42 offen offset:2048 lds
    v_mfma_f32_16x16x32_bf16 v[12:15], a[72:75], a[40:43], v[12:15]
    ds_read_b128 a[124:127], v157 offset:4096
    v_mfma_f32_16x16x32_bf16 v[16:19], a[72:75], a[44:47], v[16:19]
    v_mfma_f32_16x16x32_bf16 v[20:23], a[72:75], a[48:51], v[20:23]
    ds_read_b128 a[128:131], v157 offset:6144
    s_lshl_b32 s43, s42, 12
    s_add_u32 m0, s44, 73728
    v_mfma_f32_16x16x32_bf16 v[24:27], a[72:75], a[52:55], v[24:27]
    ds_read_b128 a[132:135], v157 offset:8192
    buffer_load_dwordx4 v151, s[20:23], s43 offen lds
    v_mfma_f32_16x16x32_bf16 v[28:31], a[76:79], a[28:31], v[28:31]
    ds_read_b128 a[136:139], v157 offset:10240
    v_mfma_f32_16x16x32_bf16 v[32:35], a[76:79], a[32:35], v[32:35]
    ds_read_b128 a[140:143], v157 offset:12288
    v_mfma_f32_16x16x32_bf16 v[36:39], a[76:79], a[36:39], v[36:39]
    v_mfma_f32_16x16x32_bf16 v[40:43], a[76:79], a[40:43], v[40:43]
    v_mfma_f32_16x16x32_bf16 v[44:47], a[76:79], a[44:47], v[44:47]
    buffer_load_dwordx4 v152, s[20:23], s43 offen offset:1024 lds
    v_mfma_f32_16x16x32_bf16 v[48:51], a[76:79], a[48:51], v[48:51]
    v_mfma_f32_16x16x32_bf16 v[52:55], a[76:79], a[52:55], v[52:55]
    v_mfma_f32_16x16x32_bf16 v[56:59], a[80:83], a[28:31], v[56:59]
    v_mfma_f32_16x16x32_bf16 v[60:63], a[80:83], a[32:35], v[60:63]
    v_mfma_f32_16x16x32_bf16 v[64:67], a[80:83], a[36:39], v[64:67]
    buffer_load_dwordx4 v153, s[20:23], s43 offen offset:2048 lds
    v_mfma_f32_16x16x32_bf16 v[68:71], a[80:83], a[40:43], v[68:71]
    v_mfma_f32_16x16x32_bf16 v[72:75], a[80:83], a[44:47], v[72:75]
    v_mfma_f32_16x16x32_bf16 v[76:79], a[80:83], a[48:51], v[76:79]
    v_mfma_f32_16x16x32_bf16 v[80:83], a[80:83], a[52:55], v[80:83]
    buffer_load_dwordx4 v154, s[20:23], s43 offen offset:3072 lds
    v_mfma_f32_16x16x32_bf16 v[84:87], a[84:87], a[28:31], v[84:87]
    v_mfma_f32_16x16x32_bf16 v[88:91], a[84:87], a[32:35], v[88:91]
    v_mfma_f32_16x16x32_bf16 v[92:95], a[84:87], a[36:39], v[92:95]
    v_mfma_f32_16x16x32_bf16 v[96:99], a[84:87], a[40:43], v[96:99]
    v_mfma_f32_16x16x32_bf16 v[100:103], a[84:87], a[44:47], v[100:103]
    buffer_load_dword v255, v243, s[12:15], 0 offen
    v_mfma_f32_16x16x32_bf16 v[104:107], a[84:87], a[48:51], v[104:107]
    v_mfma_f32_16x16x32_bf16 v[108:111], a[84:87], a[52:55], v[108:111]
    v_add_u32 v243, 16384, v243
    s_waitcnt vmcnt(12)
    s_waitcnt lgkmcnt(0)
    s_barrier
    v_mfma_f32_16x16x32_bf16 v[0:3], a[144:147], a[88:91], v[0:3]
    ds_read_b64_tr_b16 a[56:57], v162 offset:0
    v_mfma_f32_16x16x32_bf16 v[4:7], a[144:147], a[92:95], v[4:7]
    ds_read_b64_tr_b16 a[58:59], v162 offset:1024
    s_add_u32 s42, s42, 128
    s_cmp_eq_u32 s42, 1152
    s_cselect_b32 s42, 0, s42
    s_add_u32 m0, s39, 0
    v_mfma_f32_16x16x32_bf16 v[8:11], a[144:147], a[96:99], v[8:11]
    buffer_load_dwordx4 v144, s[16:19], s42 offen lds
    v_mfma_f32_16x16x32_bf16 v[12:15], a[144:147], a[100:103], v[12:15]
    ds_read_b64_tr_b16 a[60:61], v162 offset:8
    v_mfma_f32_16x16x32_bf16 v[16:19], a[144:147], a[104:107], v[16:19]
    ds_read_b64_tr_b16 a[62:63], v162 offset:1032
    v_mfma_f32_16x16x32_bf16 v[20:23], a[144:147], a[108:111], v[20:23]
    ds_read_b64_tr_b16 a[64:65], v163 offset:0
    v_mfma_f32_16x16x32_bf16 v[24:27], a[144:147], a[112:115], v[24:27]
    ds_read_b64_tr_b16 a[66:67], v163 offset:1024
    v_mfma_f32_16x16x32_bf16 v[28:31], a[148:151], a[88:91], v[28:31]
    buffer_load_dwordx4 v145, s[16:19], s42 offen offset:1024 lds
    v_mfma_f32_16x16x32_bf16 v[32:35], a[148:151], a[92:95], v[32:35]
    ds_read_b64_tr_b16 a[68:69], v163 offset:8
    v_mfma_f32_16x16x32_bf16 v[36:39], a[148:151], a[96:99], v[36:39]
    ds_read_b64_tr_b16 a[70:71], v163 offset:1032
    v_mfma_f32_16x16x32_bf16 v[40:43], a[148:151], a[100:103], v[40:43]
    ds_read_b128 a[0:3], v158 offset:0
    v_mfma_f32_16x16x32_bf16 v[44:47], a[148:151], a[104:107], v[44:47]
    ds_read_b128 a[4:7], v158 offset:2048
    v_mfma_f32_16x16x32_bf16 v[48:51], a[148:151], a[108:111], v[48:51]
    buffer_load_dwordx4 v146, s[16:19], s42 offen offset:2048 lds
    v_mfma_f32_16x16x32_bf16 v[52:55], a[148:151], a[112:115], v[52:55]
    ds_read_b128 a[8:11], v158 offset:4096
    v_mfma_f32_16x16x32_bf16 v[56:59], a[152:155], a[88:91], v[56:59]
    ds_read_b128 a[12:15], v158 offset:6144
    v_mfma_f32_16x16x32_bf16 v[60:63], a[152:155], a[92:95], v[60:63]
    ds_read_b128 a[16:19], v158 offset:8192
    v_mfma_f32_16x16x32_bf16 v[64:67], a[152:155], a[96:99], v[64:67]
    ds_read_b128 a[20:23], v158 offset:10240
    v_mfma_f32_16x16x32_bf16 v[68:71], a[152:155], a[100:103], v[68:71]
    buffer_load_dwordx4 v147, s[16:19], s42 offen offset:3072 lds
    v_mfma_f32_16x16x32_bf16 v[72:75], a[152:155], a[104:107], v[72:75]
    ds_read_b128 a[24:27], v158 offset:12288
    v_mfma_f32_16x16x32_bf16 v[76:79], a[152:155], a[108:111], v[76:79]
    ds_read_b64_tr_b16 a[72:73], v162 offset:8192
    v_mfma_f32_16x16x32_bf16 v[80:83], a[152:155], a[112:115], v[80:83]
    ds_read_b64_tr_b16 a[74:75], v162 offset:9216
    v_mfma_f32_16x16x32_bf16 v[84:87], a[156:159], a[88:91], v[84:87]
    ds_read_b64_tr_b16 a[76:77], v162 offset:8200
    s_add_u32 m0, s39, 4096
    v_mfma_f32_16x16x32_bf16 v[88:91], a[156:159], a[92:95], v[88:91]
    buffer_load_dwordx4 v148, s[16:19], s42 offen lds
    v_mfma_f32_16x16x32_bf16 v[92:95], a[156:159], a[96:99], v[92:95]
    ds_read_b64_tr_b16 a[78:79], v162 offset:9224
    v_mfma_f32_16x16x32_bf16 v[96:99], a[156:159], a[100:103], v[96:99]
    ds_read_b64_tr_b16 a[80:81], v163 offset:8192
    v_mfma_f32_16x16x32_bf16 v[100:103], a[156:159], a[104:107], v[100:103]
    ds_read_b64_tr_b16 a[82:83], v163 offset:9216
    v_mfma_f32_16x16x32_bf16 v[104:107], a[156:159], a[108:111], v[104:107]
    ds_read_b64_tr_b16 a[84:85], v163 offset:8200
    v_mfma_f32_16x16x32_bf16 v[108:111], a[156:159], a[112:115], v[108:111]
    buffer_load_dwordx4 v149, s[16:19], s42 offen offset:1024 lds
    v_mfma_f32_16x16x32_bf16 v[0:3], a[160:163], a[116:119], v[0:3]
    ds_read_b64_tr_b16 a[86:87], v163 offset:9224
    v_mfma_f32_16x16x32_bf16 v[4:7], a[160:163], a[120:123], v[4:7]
    ds_read_b128 a[28:31], v159 offset:0
    v_mfma_f32_16x16x32_bf16 v[8:11], a[160:163], a[124:127], v[8:11]
    ds_read_b128 a[32:35], v159 offset:2048
    v_mfma_f32_16x16x32_bf16 v[12:15], a[160:163], a[128:131], v[12:15]
    ds_read_b128 a[36:39], v159 offset:4096
    v_mfma_f32_16x16x32_bf16 v[16:19], a[160:163], a[132:135], v[16:19]
    buffer_load_dwordx4 v150, s[16:19], s42 offen offset:2048 lds
    v_mfma_f32_16x16x32_bf16 v[20:23], a[160:163], a[136:139], v[20:23]
    ds_read_b128 a[40:43], v159 offset:6144
    v_mfma_f32_16x16x32_bf16 v[24:27], a[160:163], a[140:143], v[24:27]
    ds_read_b128 a[44:47], v159 offset:8192
    v_mfma_f32_16x16x32_bf16 v[28:31], a[164:167], a[116:119], v[28:31]
    ds_read_b128 a[48:51], v159 offset:10240
    v_mfma_f32_16x16x32_bf16 v[32:35], a[164:167], a[120:123], v[32:35]
    ds_read_b128 a[52:55], v159 offset:12288
    s_lshl_b32 s43, s42, 12
    s_add_u32 m0, s44, 28672
    v_mfma_f32_16x16x32_bf16 v[36:39], a[164:167], a[124:127], v[36:39]
    buffer_load_dwordx4 v151, s[20:23], s43 offen lds
    v_mfma_f32_16x16x32_bf16 v[40:43], a[164:167], a[128:131], v[40:43]
    v_mfma_f32_16x16x32_bf16 v[44:47], a[164:167], a[132:135], v[44:47]
    v_mfma_f32_16x16x32_bf16 v[48:51], a[164:167], a[136:139], v[48:51]
    v_mfma_f32_16x16x32_bf16 v[52:55], a[164:167], a[140:143], v[52:55]
    v_mfma_f32_16x16x32_bf16 v[56:59], a[168:171], a[116:119], v[56:59]
    buffer_load_dwordx4 v152, s[20:23], s43 offen offset:1024 lds
    v_mfma_f32_16x16x32_bf16 v[60:63], a[168:171], a[120:123], v[60:63]
    v_mfma_f32_16x16x32_bf16 v[64:67], a[168:171], a[124:127], v[64:67]
    v_mfma_f32_16x16x32_bf16 v[68:71], a[168:171], a[128:131], v[68:71]
    v_mfma_f32_16x16x32_bf16 v[72:75], a[168:171], a[132:135], v[72:75]
    v_mfma_f32_16x16x32_bf16 v[76:79], a[168:171], a[136:139], v[76:79]
    buffer_load_dwordx4 v153, s[20:23], s43 offen offset:2048 lds
    v_mfma_f32_16x16x32_bf16 v[80:83], a[168:171], a[140:143], v[80:83]
    v_mfma_f32_16x16x32_bf16 v[84:87], a[172:175], a[116:119], v[84:87]
    v_mfma_f32_16x16x32_bf16 v[88:91], a[172:175], a[120:123], v[88:91]
    v_mfma_f32_16x16x32_bf16 v[92:95], a[172:175], a[124:127], v[92:95]
    v_mfma_f32_16x16x32_bf16 v[96:99], a[172:175], a[128:131], v[96:99]
    buffer_load_dwordx4 v154, s[20:23], s43 offen offset:3072 lds
    v_mfma_f32_16x16x32_bf16 v[100:103], a[172:175], a[132:135], v[100:103]
    v_mfma_f32_16x16x32_bf16 v[104:107], a[172:175], a[136:139], v[104:107]
    v_mfma_f32_16x16x32_bf16 v[108:111], a[172:175], a[140:143], v[108:111]
    s_waitcnt vmcnt(12)
    s_waitcnt lgkmcnt(0)
    s_barrier
    v_mfma_f32_16x16x32_bf16 v[0:3], a[56:59], a[0:3], v[0:3]
    ds_read_b64_tr_b16 a[144:145], v160 offset:45056
    v_mfma_f32_16x16x32_bf16 v[4:7], a[56:59], a[4:7], v[4:7]
    ds_read_b64_tr_b16 a[146:147], v160 offset:46080
    s_add_u32 m0, s44, 131072
    v_mfma_f32_16x16x32_bf16 v[8:11], a[56:59], a[8:11], v[8:11]
    buffer_load_dwordx4 v240, s[28:31], 0 offen nt lds
    v_mfma_f32_16x16x32_bf16 v[12:15], a[56:59], a[12:15], v[12:15]
    ds_read_b64_tr_b16 a[148:149], v160 offset:45064
    v_mfma_f32_16x16x32_bf16 v[16:19], a[56:59], a[16:19], v[16:19]
    ds_read_b64_tr_b16 a[150:151], v160 offset:46088
    v_mfma_f32_16x16x32_bf16 v[20:23], a[56:59], a[20:23], v[20:23]
    ds_read_b64_tr_b16 a[152:153], v161 offset:45056
    v_mfma_f32_16x16x32_bf16 v[24:27], a[56:59], a[24:27], v[24:27]
    ds_read_b64_tr_b16 a[154:155], v161 offset:46080
    buffer_load_dwordx4 v241, s[28:31], 0 offen offset:1024 nt lds
    v_mfma_f32_16x16x32_bf16 v[28:31], a[60:63], a[0:3], v[28:31]
    v_mfma_f32_16x16x32_bf16 v[32:35], a[60:63], a[4:7], v[32:35]
    ds_read_b64_tr_b16 a[156:157], v161 offset:45064
    v_mfma_f32_16x16x32_bf16 v[36:39], a[60:63], a[8:11], v[36:39]
    ds_read_b64_tr_b16 a[158:159], v161 offset:46088
    v_mfma_f32_16x16x32_bf16 v[40:43], a[60:63], a[12:15], v[40:43]
    ds_read_b128 a[88:91], v156 offset:45056
    buffer_load_dwordx4 v240, s[28:31], 0 offen offset:2048 nt lds
    v_mfma_f32_16x16x32_bf16 v[44:47], a[60:63], a[16:19], v[44:47]
    ds_read_b128 a[92:95], v156 offset:47104
    v_mfma_f32_16x16x32_bf16 v[48:51], a[60:63], a[20:23], v[48:51]
    v_mfma_f32_16x16x32_bf16 v[52:55], a[60:63], a[24:27], v[52:55]
    ds_read_b128 a[96:99], v156 offset:49152
    v_mfma_f32_16x16x32_bf16 v[56:59], a[64:67], a[0:3], v[56:59]
    ds_read_b128 a[100:103], v156 offset:51200
    buffer_load_dwordx4 v241, s[28:31], 0 offen offset:3072 nt lds
    v_mfma_f32_16x16x32_bf16 v[60:63], a[64:67], a[4:7], v[60:63]
    ds_read_b128 a[104:107], v156 offset:53248
    v_mfma_f32_16x16x32_bf16 v[64:67], a[64:67], a[8:11], v[64:67]
    ds_read_b128 a[108:111], v156 offset:55296
    v_mfma_f32_16x16x32_bf16 v[68:71], a[64:67], a[12:15], v[68:71]
    v_mfma_f32_16x16x32_bf16 v[72:75], a[64:67], a[16:19], v[72:75]
    ds_read_b128 a[112:115], v156 offset:57344
    s_mov_b32 s56, 16384
    s_add_u32 m0, s44, 114688
    v_mfma_f32_16x16x32_bf16 v[76:79], a[64:67], a[20:23], v[76:79]
    ds_read_b64_tr_b16 a[160:161], v160 offset:53248
    buffer_load_dwordx4 v240, s[24:27], s56 offen nt lds
    v_mfma_f32_16x16x32_bf16 v[80:83], a[64:67], a[24:27], v[80:83]
    ds_read_b64_tr_b16 a[162:163], v160 offset:54272
    v_mfma_f32_16x16x32_bf16 v[84:87], a[68:71], a[0:3], v[84:87]
    ds_read_b64_tr_b16 a[164:165], v160 offset:53256
    v_mfma_f32_16x16x32_bf16 v[88:91], a[68:71], a[4:7], v[88:91]
    v_mfma_f32_16x16x32_bf16 v[92:95], a[68:71], a[8:11], v[92:95]
    ds_read_b64_tr_b16 a[166:167], v160 offset:54280
    buffer_load_dwordx4 v241, s[24:27], s56 offen offset:1024 nt lds
    v_mfma_f32_16x16x32_bf16 v[96:99], a[68:71], a[12:15], v[96:99]
    ds_read_b64_tr_b16 a[168:169], v161 offset:53248
    v_mfma_f32_16x16x32_bf16 v[100:103], a[68:71], a[16:19], v[100:103]
    ds_read_b64_tr_b16 a[170:171], v161 offset:54272
    v_mfma_f32_16x16x32_bf16 v[104:107], a[68:71], a[20:23], v[104:107]
    ds_read_b64_tr_b16 a[172:173], v161 offset:53256
    v_mfma_f32_16x16x32_bf16 v[108:111], a[68:71], a[24:27], v[108:111]
    buffer_load_dwordx4 v240, s[24:27], s56 offen offset:2048 nt lds
    v_mfma_f32_16x16x32_bf16 v[0:3], a[72:75], a[28:31], v[0:3]
    ds_read_b64_tr_b16 a[174:175], v161 offset:54280
    v_mfma_f32_16x16x32_bf16 v[4:7], a[72:75], a[32:35], v[4:7]
    ds_read_b128 a[116:119], v157 offset:45056
    v_mfma_f32_16x16x32_bf16 v[8:11], a[72:75], a[36:39], v[8:11]
    ds_read_b128 a[120:123], v157 offset:47104
    v_mfma_f32_16x16x32_bf16 v[12:15], a[72:75], a[40:43], v[12:15]
    ds_read_b128 a[124:127], v157 offset:49152
    v_mfma_f32_16x16x32_bf16 v[16:19], a[72:75], a[44:47], v[16:19]
    buffer_load_dwordx4 v241, s[24:27], s56 offen offset:3072 nt lds
    v_mfma_f32_16x16x32_bf16 v[20:23], a[72:75], a[48:51], v[20:23]
    ds_read_b128 a[128:131], v157 offset:51200
    v_mfma_f32_16x16x32_bf16 v[24:27], a[72:75], a[52:55], v[24:27]
    ds_read_b128 a[132:135], v157 offset:53248
    v_mfma_f32_16x16x32_bf16 v[28:31], a[76:79], a[28:31], v[28:31]
    ds_read_b128 a[136:139], v157 offset:55296
    s_add_u32 m0, s44, 98304
    v_mfma_f32_16x16x32_bf16 v[32:35], a[76:79], a[32:35], v[32:35]
    ds_read_b128 a[140:143], v157 offset:57344
    buffer_load_dwordx4 v240, s[28:31], s56 offen nt lds
    v_mfma_f32_16x16x32_bf16 v[36:39], a[76:79], a[36:39], v[36:39]
    v_mfma_f32_16x16x32_bf16 v[40:43], a[76:79], a[40:43], v[40:43]
    v_mfma_f32_16x16x32_bf16 v[44:47], a[76:79], a[44:47], v[44:47]
    v_mfma_f32_16x16x32_bf16 v[48:51], a[76:79], a[48:51], v[48:51]
    buffer_load_dwordx4 v241, s[28:31], s56 offen offset:1024 nt lds
    v_mfma_f32_16x16x32_bf16 v[52:55], a[76:79], a[52:55], v[52:55]
    v_mfma_f32_16x16x32_bf16 v[56:59], a[80:83], a[28:31], v[56:59]
    v_mfma_f32_16x16x32_bf16 v[60:63], a[80:83], a[32:35], v[60:63]
    v_mfma_f32_16x16x32_bf16 v[64:67], a[80:83], a[36:39], v[64:67]
    v_mfma_f32_16x16x32_bf16 v[68:71], a[80:83], a[40:43], v[68:71]
    buffer_load_dwordx4 v240, s[28:31], s56 offen offset:2048 nt lds
    v_mfma_f32_16x16x32_bf16 v[72:75], a[80:83], a[44:47], v[72:75]
    v_mfma_f32_16x16x32_bf16 v[76:79], a[80:83], a[48:51], v[76:79]
    v_mfma_f32_16x16x32_bf16 v[80:83], a[80:83], a[52:55], v[80:83]
    v_mfma_f32_16x16x32_bf16 v[84:87], a[84:87], a[28:31], v[84:87]
    buffer_load_dwordx4 v241, s[28:31], s56 offen offset:3072 nt lds
    v_mfma_f32_16x16x32_bf16 v[88:91], a[84:87], a[32:35], v[88:91]
    v_mfma_f32_16x16x32_bf16 v[92:95], a[84:87], a[36:39], v[92:95]
    v_mfma_f32_16x16x32_bf16 v[96:99], a[84:87], a[40:43], v[96:99]
    v_mfma_f32_16x16x32_bf16 v[100:103], a[84:87], a[44:47], v[100:103]
    buffer_load_dword v255, v243, s[12:15], 0 offen
    v_mfma_f32_16x16x32_bf16 v[104:107], a[84:87], a[48:51], v[104:107]
    v_mfma_f32_16x16x32_bf16 v[108:111], a[84:87], a[52:55], v[108:111]
    v_add_u32 v243, 16384, v243
    s_waitcnt vmcnt(13)
    s_waitcnt lgkmcnt(0)
    s_barrier
    v_mfma_f32_16x16x32_bf16 v[0:3], a[144:147], a[88:91], v[0:3]
    ds_read_b64_tr_b16 a[56:57], v160 offset:0
    v_mfma_f32_16x16x32_bf16 v[4:7], a[144:147], a[92:95], v[4:7]
    ds_read_b64_tr_b16 a[58:59], v160 offset:1024
    v_mfma_f32_16x16x32_bf16 v[8:11], a[144:147], a[96:99], v[8:11]
    buffer_load_dword v255, v243, s[12:15], 0 offen
    v_mfma_f32_16x16x32_bf16 v[12:15], a[144:147], a[100:103], v[12:15]
    ds_read_b64_tr_b16 a[60:61], v160 offset:8
    v_mfma_f32_16x16x32_bf16 v[16:19], a[144:147], a[104:107], v[16:19]
    ds_read_b64_tr_b16 a[62:63], v160 offset:1032
    v_mfma_f32_16x16x32_bf16 v[20:23], a[144:147], a[108:111], v[20:23]
    ds_read_b64_tr_b16 a[64:65], v161 offset:0
    v_mfma_f32_16x16x32_bf16 v[24:27], a[144:147], a[112:115], v[24:27]
    ds_read_b64_tr_b16 a[66:67], v161 offset:1024
    v_mfma_f32_16x16x32_bf16 v[28:31], a[148:151], a[88:91], v[28:31]
    v_mfma_f32_16x16x32_bf16 v[32:35], a[148:151], a[92:95], v[32:35]
    ds_read_b64_tr_b16 a[68:69], v161 offset:8
    v_mfma_f32_16x16x32_bf16 v[36:39], a[148:151], a[96:99], v[36:39]
    ds_read_b64_tr_b16 a[70:71], v161 offset:1032
    v_mfma_f32_16x16x32_bf16 v[40:43], a[148:151], a[100:103], v[40:43]
    ds_read_b128 a[0:3], v156 offset:0
    v_mfma_f32_16x16x32_bf16 v[44:47], a[148:151], a[104:107], v[44:47]
    ds_read_b128 a[4:7], v156 offset:2048
    v_mfma_f32_16x16x32_bf16 v[48:51], a[148:151], a[108:111], v[48:51]
    v_mfma_f32_16x16x32_bf16 v[52:55], a[148:151], a[112:115], v[52:55]
    ds_read_b128 a[8:11], v156 offset:4096
    v_mfma_f32_16x16x32_bf16 v[56:59], a[152:155], a[88:91], v[56:59]
    ds_read_b128 a[12:15], v156 offset:6144
    v_mfma_f32_16x16x32_bf16 v[60:63], a[152:155], a[92:95], v[60:63]
    ds_read_b128 a[16:19], v156 offset:8192
    v_mfma_f32_16x16x32_bf16 v[64:67], a[152:155], a[96:99], v[64:67]
    ds_read_b128 a[20:23], v156 offset:10240
    v_mfma_f32_16x16x32_bf16 v[68:71], a[152:155], a[100:103], v[68:71]
    v_mfma_f32_16x16x32_bf16 v[72:75], a[152:155], a[104:107], v[72:75]
    ds_read_b128 a[24:27], v156 offset:12288
    v_mfma_f32_16x16x32_bf16 v[76:79], a[152:155], a[108:111], v[76:79]
    ds_read_b64_tr_b16 a[72:73], v160 offset:8192
    v_mfma_f32_16x16x32_bf16 v[80:83], a[152:155], a[112:115], v[80:83]
    ds_read_b64_tr_b16 a[74:75], v160 offset:9216
    v_mfma_f32_16x16x32_bf16 v[84:87], a[156:159], a[88:91], v[84:87]
    ds_read_b64_tr_b16 a[76:77], v160 offset:8200
    v_mfma_f32_16x16x32_bf16 v[88:91], a[156:159], a[92:95], v[88:91]
    v_mfma_f32_16x16x32_bf16 v[92:95], a[156:159], a[96:99], v[92:95]
    ds_read_b64_tr_b16 a[78:79], v160 offset:9224
    v_mfma_f32_16x16x32_bf16 v[96:99], a[156:159], a[100:103], v[96:99]
    ds_read_b64_tr_b16 a[80:81], v161 offset:8192
    v_mfma_f32_16x16x32_bf16 v[100:103], a[156:159], a[104:107], v[100:103]
    ds_read_b64_tr_b16 a[82:83], v161 offset:9216
    v_mfma_f32_16x16x32_bf16 v[104:107], a[156:159], a[108:111], v[104:107]
    ds_read_b64_tr_b16 a[84:85], v161 offset:8200
    v_mfma_f32_16x16x32_bf16 v[108:111], a[156:159], a[112:115], v[108:111]
    v_mfma_f32_16x16x32_bf16 v[0:3], a[160:163], a[116:119], v[0:3]
    ds_read_b64_tr_b16 a[86:87], v161 offset:9224
    v_mfma_f32_16x16x32_bf16 v[4:7], a[160:163], a[120:123], v[4:7]
    ds_read_b128 a[28:31], v157 offset:0
    v_mfma_f32_16x16x32_bf16 v[8:11], a[160:163], a[124:127], v[8:11]
    ds_read_b128 a[32:35], v157 offset:2048
    v_mfma_f32_16x16x32_bf16 v[12:15], a[160:163], a[128:131], v[12:15]
    ds_read_b128 a[36:39], v157 offset:4096
    v_mfma_f32_16x16x32_bf16 v[16:19], a[160:163], a[132:135], v[16:19]
    v_mfma_f32_16x16x32_bf16 v[20:23], a[160:163], a[136:139], v[20:23]
    ds_read_b128 a[40:43], v157 offset:6144
    v_mfma_f32_16x16x32_bf16 v[24:27], a[160:163], a[140:143], v[24:27]
    ds_read_b128 a[44:47], v157 offset:8192
    v_mfma_f32_16x16x32_bf16 v[28:31], a[164:167], a[116:119], v[28:31]
    ds_read_b128 a[48:51], v157 offset:10240
    v_mfma_f32_16x16x32_bf16 v[32:35], a[164:167], a[120:123], v[32:35]
    ds_read_b128 a[52:55], v157 offset:12288
    v_mfma_f32_16x16x32_bf16 v[36:39], a[164:167], a[124:127], v[36:39]
    v_mfma_f32_16x16x32_bf16 v[40:43], a[164:167], a[128:131], v[40:43]
    s_mov_b32 s16, s4
    v_mfma_f32_16x16x32_bf16 v[44:47], a[164:167], a[132:135], v[44:47]
    v_mfma_f32_16x16x32_bf16 v[48:51], a[164:167], a[136:139], v[48:51]
    s_mov_b32 s17, s5
    v_mfma_f32_16x16x32_bf16 v[52:55], a[164:167], a[140:143], v[52:55]
    v_mfma_f32_16x16x32_bf16 v[56:59], a[168:171], a[116:119], v[56:59]
    s_mov_b32 s18, 4718592
    v_mfma_f32_16x16x32_bf16 v[60:63], a[168:171], a[120:123], v[60:63]
    v_mfma_f32_16x16x32_bf16 v[64:67], a[168:171], a[124:127], v[64:67]
    s_mov_b32 s19, 0x00020000
    v_mfma_f32_16x16x32_bf16 v[68:71], a[168:171], a[128:131], v[68:71]
    v_mfma_f32_16x16x32_bf16 v[72:75], a[168:171], a[132:135], v[72:75]
    s_mov_b32 s20, s6
    v_mfma_f32_16x16x32_bf16 v[76:79], a[168:171], a[136:139], v[76:79]
    v_mfma_f32_16x16x32_bf16 v[80:83], a[168:171], a[140:143], v[80:83]
    s_mov_b32 s21, s7
    v_mfma_f32_16x16x32_bf16 v[84:87], a[172:175], a[116:119], v[84:87]
    v_mfma_f32_16x16x32_bf16 v[88:91], a[172:175], a[120:123], v[88:91]
    s_mov_b32 s22, 2064384
    v_mfma_f32_16x16x32_bf16 v[92:95], a[172:175], a[124:127], v[92:95]
    v_mfma_f32_16x16x32_bf16 v[96:99], a[172:175], a[128:131], v[96:99]
    s_mov_b32 s23, 0x00020000
    v_mfma_f32_16x16x32_bf16 v[100:103], a[172:175], a[132:135], v[100:103]
    v_mfma_f32_16x16x32_bf16 v[104:107], a[172:175], a[136:139], v[104:107]
    v_mfma_f32_16x16x32_bf16 v[108:111], a[172:175], a[140:143], v[108:111]
    v_add_u32 v243, 16384, v243
    s_waitcnt lgkmcnt(0)
    s_barrier
    v_mfma_f32_16x16x32_bf16 v[0:3], a[56:59], a[0:3], v[0:3]
    ds_read_b128 v[112:115], v228
    v_mfma_f32_16x16x32_bf16 v[28:31], a[60:63], a[0:3], v[28:31]
    ds_read_b128 v[116:119], v229
    v_mfma_f32_16x16x32_bf16 v[0:3], a[72:75], a[28:31], v[0:3]
    ds_read_b128 v[120:123], v230
    v_mfma_f32_16x16x32_bf16 v[28:31], a[76:79], a[28:31], v[28:31]
    ds_read_b128 v[124:127], v231
    v_mfma_f32_16x16x32_bf16 v[4:7], a[56:59], a[4:7], v[4:7]
    ds_read_b128 v[128:131], v228 offset:4096
    v_mfma_f32_16x16x32_bf16 v[32:35], a[60:63], a[4:7], v[32:35]
    v_mul_f32 v0, s40, v0
    v_mul_f32 v1, s40, v1
    v_mul_f32 v2, s40, v2
    v_mul_f32 v3, s40, v3
    ds_read_b128 v[132:135], v229 offset:4096
    v_mfma_f32_16x16x32_bf16 v[4:7], a[72:75], a[32:35], v[4:7]
    v_mul_f32 v28, s40, v28
    v_mul_f32 v29, s40, v29
    v_mul_f32 v30, s40, v30
    v_mul_f32 v31, s40, v31
    ds_read_b128 v[136:139], v230 offset:4096
    v_mfma_f32_16x16x32_bf16 v[32:35], a[76:79], a[32:35], v[32:35]
    v_cvt_pk_bf16_f32 v176, v0, v1
    v_cvt_pk_bf16_f32 v177, v2, v3
    v_cvt_pk_bf16_f32 v178, v28, v29
    v_cvt_pk_bf16_f32 v179, v30, v31
    ds_read_b128 v[140:143], v231 offset:4096
    v_mfma_f32_16x16x32_bf16 v[8:11], a[56:59], a[8:11], v[8:11]
    ds_write_b128 v253, v[176:179] offset:0
    v_mfma_f32_16x16x32_bf16 v[36:39], a[60:63], a[8:11], v[36:39]
    v_mul_f32 v4, s40, v4
    v_mul_f32 v5, s40, v5
    v_mul_f32 v6, s40, v6
    v_mul_f32 v7, s40, v7
    v_mfma_f32_16x16x32_bf16 v[8:11], a[72:75], a[36:39], v[8:11]
    v_mul_f32 v32, s40, v32
    v_mul_f32 v33, s40, v33
    v_mul_f32 v34, s40, v34
    v_mul_f32 v35, s40, v35
    v_mfma_f32_16x16x32_bf16 v[36:39], a[76:79], a[36:39], v[36:39]
    v_cvt_pk_bf16_f32 v180, v4, v5
    v_cvt_pk_bf16_f32 v181, v6, v7
    v_cvt_pk_bf16_f32 v182, v32, v33
    v_cvt_pk_bf16_f32 v183, v34, v35
    v_mfma_f32_16x16x32_bf16 v[12:15], a[56:59], a[12:15], v[12:15]
    ds_write_b128 v253, v[180:183] offset:1024
    v_mfma_f32_16x16x32_bf16 v[40:43], a[60:63], a[12:15], v[40:43]
    v_mul_f32 v8, s40, v8
    v_mul_f32 v9, s40, v9
    v_mul_f32 v10, s40, v10
    v_mul_f32 v11, s40, v11
    v_mfma_f32_16x16x32_bf16 v[12:15], a[72:75], a[40:43], v[12:15]
    v_mul_f32 v36, s40, v36
    v_mul_f32 v37, s40, v37
    v_mul_f32 v38, s40, v38
    v_mul_f32 v39, s40, v39
    v_mfma_f32_16x16x32_bf16 v[40:43], a[76:79], a[40:43], v[40:43]
    v_cvt_pk_bf16_f32 v176, v8, v9
    v_cvt_pk_bf16_f32 v177, v10, v11
    v_cvt_pk_bf16_f32 v178, v36, v37
    v_cvt_pk_bf16_f32 v179, v38, v39
    v_mfma_f32_16x16x32_bf16 v[16:19], a[56:59], a[16:19], v[16:19]
    ds_write_b128 v253, v[176:179] offset:2048
    v_mfma_f32_16x16x32_bf16 v[44:47], a[60:63], a[16:19], v[44:47]
    v_mul_f32 v12, s40, v12
    v_mul_f32 v13, s40, v13
    v_mul_f32 v14, s40, v14
    v_mul_f32 v15, s40, v15
    v_mfma_f32_16x16x32_bf16 v[16:19], a[72:75], a[44:47], v[16:19]
    v_mul_f32 v40, s40, v40
    v_mul_f32 v41, s40, v41
    v_mul_f32 v42, s40, v42
    v_mul_f32 v43, s40, v43
    v_mfma_f32_16x16x32_bf16 v[44:47], a[76:79], a[44:47], v[44:47]
    v_cvt_pk_bf16_f32 v180, v12, v13
    v_cvt_pk_bf16_f32 v181, v14, v15
    v_cvt_pk_bf16_f32 v182, v40, v41
    v_cvt_pk_bf16_f32 v183, v42, v43
    v_mfma_f32_16x16x32_bf16 v[20:23], a[56:59], a[20:23], v[20:23]
    ds_write_b128 v253, v[180:183] offset:3072
    v_mfma_f32_16x16x32_bf16 v[48:51], a[60:63], a[20:23], v[48:51]
    v_mul_f32 v16, s40, v16
    v_mul_f32 v17, s40, v17
    v_mul_f32 v18, s40, v18
    v_mul_f32 v19, s40, v19
    v_mfma_f32_16x16x32_bf16 v[20:23], a[72:75], a[48:51], v[20:23]
    v_mul_f32 v44, s40, v44
    v_mul_f32 v45, s40, v45
    v_mul_f32 v46, s40, v46
    v_mul_f32 v47, s40, v47
    v_mfma_f32_16x16x32_bf16 v[48:51], a[76:79], a[48:51], v[48:51]
    v_cvt_pk_bf16_f32 v176, v16, v17
    v_cvt_pk_bf16_f32 v177, v18, v19
    v_cvt_pk_bf16_f32 v178, v44, v45
    v_cvt_pk_bf16_f32 v179, v46, v47
    v_mfma_f32_16x16x32_bf16 v[24:27], a[56:59], a[24:27], v[24:27]
    ds_write_b128 v253, v[176:179] offset:4096
    v_mfma_f32_16x16x32_bf16 v[52:55], a[60:63], a[24:27], v[52:55]
    v_mul_f32 v20, s40, v20
    v_mul_f32 v21, s40, v21
    v_mul_f32 v22, s40, v22
    v_mul_f32 v23, s40, v23
    v_mfma_f32_16x16x32_bf16 v[24:27], a[72:75], a[52:55], v[24:27]
    v_mul_f32 v48, s40, v48
    v_mul_f32 v49, s40, v49
    v_mul_f32 v50, s40, v50
    v_mul_f32 v51, s40, v51
    v_mfma_f32_16x16x32_bf16 v[52:55], a[76:79], a[52:55], v[52:55]
    v_cvt_pk_bf16_f32 v180, v20, v21
    v_cvt_pk_bf16_f32 v181, v22, v23
    v_cvt_pk_bf16_f32 v182, v48, v49
    v_cvt_pk_bf16_f32 v183, v50, v51
    v_mfma_f32_16x16x32_bf16 v[56:59], a[64:67], a[0:3], v[56:59]
    ds_write_b128 v253, v[180:183] offset:5120
    v_mfma_f32_16x16x32_bf16 v[84:87], a[68:71], a[0:3], v[84:87]
    v_mul_f32 v24, s40, v24
    v_mul_f32 v25, s40, v25
    v_mul_f32 v26, s40, v26
    v_mul_f32 v27, s40, v27
    v_mfma_f32_16x16x32_bf16 v[56:59], a[80:83], a[28:31], v[56:59]
    v_mul_f32 v52, s40, v52
    v_mul_f32 v53, s40, v53
    v_mul_f32 v54, s40, v54
    v_mul_f32 v55, s40, v55
    v_mfma_f32_16x16x32_bf16 v[84:87], a[84:87], a[28:31], v[84:87]
    v_cvt_pk_bf16_f32 v176, v24, v25
    v_cvt_pk_bf16_f32 v177, v26, v27
    v_cvt_pk_bf16_f32 v178, v52, v53
    v_cvt_pk_bf16_f32 v179, v54, v55
    v_mfma_f32_16x16x32_bf16 v[60:63], a[64:67], a[4:7], v[60:63]
    ds_write_b128 v253, v[176:179] offset:6144
    v_mfma_f32_16x16x32_bf16 v[88:91], a[68:71], a[4:7], v[88:91]
    v_mul_f32 v56, s40, v56
    v_mul_f32 v57, s40, v57
    v_mul_f32 v58, s40, v58
    v_mul_f32 v59, s40, v59
    v_mfma_f32_16x16x32_bf16 v[60:63], a[80:83], a[32:35], v[60:63]
    v_mul_f32 v84, s40, v84
    v_mul_f32 v85, s40, v85
    v_mul_f32 v86, s40, v86
    v_mul_f32 v87, s40, v87
    v_mfma_f32_16x16x32_bf16 v[88:91], a[84:87], a[32:35], v[88:91]
    v_cvt_pk_bf16_f32 v180, v56, v57
    v_cvt_pk_bf16_f32 v181, v58, v59
    v_cvt_pk_bf16_f32 v182, v84, v85
    v_cvt_pk_bf16_f32 v183, v86, v87
    v_mfma_f32_16x16x32_bf16 v[64:67], a[64:67], a[8:11], v[64:67]
    ds_write_b128 v253, v[180:183] offset:7168
    v_mfma_f32_16x16x32_bf16 v[92:95], a[68:71], a[8:11], v[92:95]
    v_mul_f32 v60, s40, v60
    v_mul_f32 v61, s40, v61
    v_mul_f32 v62, s40, v62
    v_mul_f32 v63, s40, v63
    v_mfma_f32_16x16x32_bf16 v[64:67], a[80:83], a[36:39], v[64:67]
    v_mul_f32 v88, s40, v88
    v_mul_f32 v89, s40, v89
    v_mul_f32 v90, s40, v90
    v_mul_f32 v91, s40, v91
    v_mfma_f32_16x16x32_bf16 v[92:95], a[84:87], a[36:39], v[92:95]
    v_cvt_pk_bf16_f32 v176, v60, v61
    v_cvt_pk_bf16_f32 v177, v62, v63
    v_cvt_pk_bf16_f32 v178, v88, v89
    v_cvt_pk_bf16_f32 v179, v90, v91
    v_mfma_f32_16x16x32_bf16 v[68:71], a[64:67], a[12:15], v[68:71]
    ds_write_b128 v253, v[176:179] offset:8192
    v_mfma_f32_16x16x32_bf16 v[96:99], a[68:71], a[12:15], v[96:99]
    v_mul_f32 v64, s40, v64
    v_mul_f32 v65, s40, v65
    v_mul_f32 v66, s40, v66
    v_mul_f32 v67, s40, v67
    v_mfma_f32_16x16x32_bf16 v[68:71], a[80:83], a[40:43], v[68:71]
    v_mul_f32 v92, s40, v92
    v_mul_f32 v93, s40, v93
    v_mul_f32 v94, s40, v94
    v_mul_f32 v95, s40, v95
    v_mfma_f32_16x16x32_bf16 v[96:99], a[84:87], a[40:43], v[96:99]
    v_cvt_pk_bf16_f32 v180, v64, v65
    v_cvt_pk_bf16_f32 v181, v66, v67
    v_cvt_pk_bf16_f32 v182, v92, v93
    v_cvt_pk_bf16_f32 v183, v94, v95
    v_mfma_f32_16x16x32_bf16 v[72:75], a[64:67], a[16:19], v[72:75]
    ds_write_b128 v253, v[180:183] offset:9216
    v_mfma_f32_16x16x32_bf16 v[100:103], a[68:71], a[16:19], v[100:103]
    v_mul_f32 v68, s40, v68
    v_mul_f32 v69, s40, v69
    v_mul_f32 v70, s40, v70
    v_mul_f32 v71, s40, v71
    v_mfma_f32_16x16x32_bf16 v[72:75], a[80:83], a[44:47], v[72:75]
    v_mul_f32 v96, s40, v96
    v_mul_f32 v97, s40, v97
    v_mul_f32 v98, s40, v98
    v_mul_f32 v99, s40, v99
    v_mfma_f32_16x16x32_bf16 v[100:103], a[84:87], a[44:47], v[100:103]
    v_cvt_pk_bf16_f32 v176, v68, v69
    v_cvt_pk_bf16_f32 v177, v70, v71
    v_cvt_pk_bf16_f32 v178, v96, v97
    v_cvt_pk_bf16_f32 v179, v98, v99
    v_mfma_f32_16x16x32_bf16 v[76:79], a[64:67], a[20:23], v[76:79]
    ds_write_b128 v253, v[176:179] offset:10240
    v_mfma_f32_16x16x32_bf16 v[104:107], a[68:71], a[20:23], v[104:107]
    v_mul_f32 v72, s40, v72
    v_mul_f32 v73, s40, v73
    v_mul_f32 v74, s40, v74
    v_mul_f32 v75, s40, v75
    v_mfma_f32_16x16x32_bf16 v[76:79], a[80:83], a[48:51], v[76:79]
    v_mul_f32 v100, s40, v100
    v_mul_f32 v101, s40, v101
    v_mul_f32 v102, s40, v102
    v_mul_f32 v103, s40, v103
    v_mfma_f32_16x16x32_bf16 v[104:107], a[84:87], a[48:51], v[104:107]
    v_cvt_pk_bf16_f32 v180, v72, v73
    v_cvt_pk_bf16_f32 v181, v74, v75
    v_cvt_pk_bf16_f32 v182, v100, v101
    v_cvt_pk_bf16_f32 v183, v102, v103
    v_mfma_f32_16x16x32_bf16 v[80:83], a[64:67], a[24:27], v[80:83]
    ds_write_b128 v253, v[180:183] offset:11264
    v_mfma_f32_16x16x32_bf16 v[108:111], a[68:71], a[24:27], v[108:111]
    v_mul_f32 v76, s40, v76
    v_mul_f32 v77, s40, v77
    v_mul_f32 v78, s40, v78
    v_mul_f32 v79, s40, v79
    v_mfma_f32_16x16x32_bf16 v[80:83], a[80:83], a[52:55], v[80:83]
    v_mul_f32 v104, s40, v104
    v_mul_f32 v105, s40, v105
    v_mul_f32 v106, s40, v106
    v_mul_f32 v107, s40, v107
    v_mfma_f32_16x16x32_bf16 v[108:111], a[84:87], a[52:55], v[108:111]
    v_cvt_pk_bf16_f32 v176, v76, v77
    v_cvt_pk_bf16_f32 v177, v78, v79
    v_cvt_pk_bf16_f32 v178, v104, v105
    v_cvt_pk_bf16_f32 v179, v106, v107
    ds_write_b128 v253, v[176:179] offset:12288
    s_nop 7
    v_mul_f32 v80, s40, v80
    v_mul_f32 v81, s40, v81
    v_mul_f32 v82, s40, v82
    v_mul_f32 v83, s40, v83
    v_mul_f32 v108, s40, v108
    v_mul_f32 v109, s40, v109
    v_mul_f32 v110, s40, v110
    v_mul_f32 v111, s40, v111
    v_cvt_pk_bf16_f32 v180, v80, v81
    v_cvt_pk_bf16_f32 v181, v82, v83
    v_cvt_pk_bf16_f32 v182, v108, v109
    v_cvt_pk_bf16_f32 v183, v110, v111
    ds_write_b128 v253, v[180:183] offset:13312
    s_waitcnt lgkmcnt(0)
    s_waitcnt vmcnt(10)
    s_barrier
A_ATT:
    ds_read_b128 a[0:3], v254 offset:0
    ds_read_b128 a[4:7], v254 offset:7168
    ds_read_b128 a[8:11], v254 offset:14336
    ds_read_b128 a[12:15], v254 offset:21504
    ds_read_b128 a[16:19], v254 offset:1024
    ds_read_b128 a[20:23], v254 offset:8192
    ds_read_b128 a[24:27], v254 offset:15360
    ds_read_b128 a[28:31], v254 offset:22528
    s_waitcnt lgkmcnt(4)
    v_mfma_f32_16x16x32_bf16 v[176:179], v[112:115], a[0:3], v[200:203]
    ds_read_b64_tr_b16 v[144:145], v232
    ds_read_b64_tr_b16 v[146:147], v232 offset:4096
    v_mfma_f32_16x16x32_bf16 v[176:179], v[116:119], a[4:7], v[176:179]
    ds_read_b64_tr_b16 v[148:149], v233
    ds_read_b64_tr_b16 v[150:151], v233 offset:4096
    v_mfma_f32_16x16x32_bf16 v[176:179], v[120:123], a[8:11], v[176:179]
    ds_read_b64_tr_b16 v[152:153], v234
    ds_read_b64_tr_b16 v[154:155], v234 offset:4096
    v_mfma_f32_16x16x32_bf16 v[176:179], v[124:127], a[12:15], v[176:179]
    ds_read_b64_tr_b16 v[156:157], v235
    ds_read_b64_tr_b16 v[158:159], v235 offset:4096
    v_mfma_f32_16x16x32_bf16 v[180:183], v[128:131], a[0:3], v[200:203]
    ds_read_b64_tr_b16 v[160:161], v236
    ds_read_b64_tr_b16 v[162:163], v236 offset:4096
    v_mfma_f32_16x16x32_bf16 v[180:183], v[132:135], a[4:7], v[180:183]
    ds_read_b64_tr_b16 v[164:165], v237
    ds_read_b64_tr_b16 v[166:167], v237 offset:4096
    v_mfma_f32_16x16x32_bf16 v[180:183], v[136:139], a[8:11], v[180:183]
    ds_read_b64_tr_b16 v[168:169], v238
    ds_read_b64_tr_b16 v[170:171], v238 offset:4096
    v_mfma_f32_16x16x32_bf16 v[180:183], v[140:143], a[12:15], v[180:183]
    ds_read_b128 a[32:35], v254 offset:2048
    ds_read_b128 a[36:39], v254 offset:9216
    ds_read_b128 a[40:43], v254 offset:16384
    ds_read_b128 a[44:47], v254 offset:23552
    s_waitcnt lgkmcnt(15)
    v_mfma_f32_16x16x32_bf16 v[184:187], v[112:115], a[16:19], v[204:207]
    v_exp_f32 v176, v176
    v_exp_f32 v177, v177
    v_mfma_f32_16x16x32_bf16 v[184:187], v[116:119], a[20:23], v[184:187]
    v_exp_f32 v178, v178
    v_exp_f32 v179, v179
    v_mfma_f32_16x16x32_bf16 v[184:187], v[120:123], a[24:27], v[184:187]
    v_exp_f32 v180, v180
    v_exp_f32 v181, v181
    v_mfma_f32_16x16x32_bf16 v[184:187], v[124:127], a[28:31], v[184:187]
    v_exp_f32 v182, v182
    v_exp_f32 v183, v183
    v_mfma_f32_16x16x32_bf16 v[188:191], v[128:131], a[16:19], v[204:207]
    v_cvt_pk_bf16_f32 v192, v176, v177
    v_cvt_pk_bf16_f32 v193, v178, v179
    v_mfma_f32_16x16x32_bf16 v[188:191], v[132:135], a[20:23], v[188:191]
    v_cvt_pk_bf16_f32 v194, v180, v181
    v_cvt_pk_bf16_f32 v195, v182, v183
    v_mfma_f32_16x16x32_bf16 v[188:191], v[136:139], a[24:27], v[188:191]
    v_mfma_f32_16x16x32_bf16 v[188:191], v[140:143], a[28:31], v[188:191]
    s_waitcnt lgkmcnt(10)
    v_mfma_f32_16x16x32_bf16 v[0:3], v[144:147], v[192:195], 0
    v_exp_f32 v184, v184
    v_mfma_f32_16x16x32_bf16 v[4:7], v[148:151], v[192:195], 0
    ds_read_b64_tr_b16 v[172:173], v239
    ds_read_b64_tr_b16 v[174:175], v239 offset:4096
    v_mfma_f32_16x16x32_bf16 v[8:11], v[152:155], v[192:195], 0
    v_exp_f32 v185, v185
    v_mfma_f32_16x16x32_bf16 v[12:15], v[156:159], v[192:195], 0
    s_waitcnt lgkmcnt(8)
    s_mov_b32 s56, 32768
    s_add_u32 m0, s44, 81920
    v_mfma_f32_16x16x32_bf16 a[112:115], v[160:163], v[192:195], 0
    v_exp_f32 v186, v186
    v_mfma_f32_16x16x32_bf16 a[116:119], v[164:167], v[192:195], 0
    s_waitcnt lgkmcnt(0)
    ds_read_b128 a[48:51], v254 offset:3072
    ds_read_b128 a[52:55], v254 offset:10240
    v_mfma_f32_16x16x32_bf16 a[120:123], v[168:171], v[192:195], 0
    v_exp_f32 v187, v187
    v_mfma_f32_16x16x32_bf16 a[124:127], v[172:175], v[192:195], 0
    v_cvt_pk_bf16_f32 v196, v184, v185
    v_cvt_pk_bf16_f32 v197, v186, v187
    v_mfma_f32_16x16x32_bf16 a[224:227], a[252:255], v[192:195], 0
    v_exp_f32 v188, v188
    v_mfma_f32_16x16x32_bf16 v[176:179], v[112:115], a[32:35], v[208:211]
    ds_read_b128 a[56:59], v254 offset:17408
    ds_read_b128 a[60:63], v254 offset:24576
    v_mfma_f32_16x16x32_bf16 v[176:179], v[116:119], a[36:39], v[176:179]
    v_exp_f32 v189, v189
    v_mfma_f32_16x16x32_bf16 v[176:179], v[120:123], a[40:43], v[176:179]
    buffer_load_dwordx4 v240, s[24:27], s56 offen nt lds
    v_mfma_f32_16x16x32_bf16 v[176:179], v[124:127], a[44:47], v[176:179]
    v_exp_f32 v190, v190
    v_mfma_f32_16x16x32_bf16 v[180:183], v[128:131], a[32:35], v[208:211]
    buffer_load_dwordx4 v241, s[24:27], s56 offen offset:1024 nt lds
    v_mfma_f32_16x16x32_bf16 v[180:183], v[132:135], a[36:39], v[180:183]
    v_exp_f32 v191, v191
    v_mfma_f32_16x16x32_bf16 v[180:183], v[136:139], a[40:43], v[180:183]
    v_cvt_pk_bf16_f32 v198, v188, v189
    v_cvt_pk_bf16_f32 v199, v190, v191
    v_mfma_f32_16x16x32_bf16 v[180:183], v[140:143], a[44:47], v[180:183]
    v_mfma_f32_16x16x32_bf16 v[16:19], v[144:147], v[196:199], 0
    v_exp_f32 v176, v176
    v_mfma_f32_16x16x32_bf16 v[20:23], v[148:151], v[196:199], 0
    v_add_u32 v232, 4294934528, v232
    v_add_u32 v233, 4294934528, v233
    v_mfma_f32_16x16x32_bf16 v[24:27], v[152:155], v[196:199], 0
    v_exp_f32 v177, v177
    v_mfma_f32_16x16x32_bf16 v[28:31], v[156:159], v[196:199], 0
    buffer_load_dwordx4 v240, s[24:27], s56 offen offset:2048 nt lds
    v_mfma_f32_16x16x32_bf16 a[128:131], v[160:163], v[196:199], 0
    v_exp_f32 v178, v178
    v_mfma_f32_16x16x32_bf16 a[132:135], v[164:167], v[196:199], 0
    ds_read_b128 a[64:67], v254 offset:4096
    ds_read_b128 a[68:71], v254 offset:11264
    v_mfma_f32_16x16x32_bf16 a[136:139], v[168:171], v[196:199], 0
    v_exp_f32 v179, v179
    v_mfma_f32_16x16x32_bf16 a[140:143], v[172:175], v[196:199], 0
    v_cvt_pk_bf16_f32 v192, v176, v177
    v_cvt_pk_bf16_f32 v193, v178, v179
    v_mfma_f32_16x16x32_bf16 a[228:231], a[252:255], v[196:199], 0
    v_exp_f32 v180, v180
    s_waitcnt lgkmcnt(2)
    v_mfma_f32_16x16x32_bf16 v[184:187], v[112:115], a[48:51], v[212:215]
    ds_read_b128 a[72:75], v254 offset:18432
    ds_read_b128 a[76:79], v254 offset:25600
    v_mfma_f32_16x16x32_bf16 v[184:187], v[116:119], a[52:55], v[184:187]
    v_exp_f32 v181, v181
    v_mfma_f32_16x16x32_bf16 v[184:187], v[120:123], a[56:59], v[184:187]
    buffer_load_dwordx4 v241, s[24:27], s56 offen offset:3072 nt lds
    v_mfma_f32_16x16x32_bf16 v[184:187], v[124:127], a[60:63], v[184:187]
    v_exp_f32 v182, v182
    v_mfma_f32_16x16x32_bf16 v[188:191], v[128:131], a[48:51], v[212:215]
    v_add_u32 v234, 4294934528, v234
    v_add_u32 v235, 4294934528, v235
    v_mfma_f32_16x16x32_bf16 v[188:191], v[132:135], a[52:55], v[188:191]
    v_exp_f32 v183, v183
    v_mfma_f32_16x16x32_bf16 v[188:191], v[136:139], a[56:59], v[188:191]
    v_cvt_pk_bf16_f32 v194, v180, v181
    v_cvt_pk_bf16_f32 v195, v182, v183
    v_mfma_f32_16x16x32_bf16 v[188:191], v[140:143], a[60:63], v[188:191]
    v_mfma_f32_16x16x32_bf16 v[32:35], v[144:147], v[192:195], 0
    v_exp_f32 v184, v184
    v_mfma_f32_16x16x32_bf16 v[36:39], v[148:151], v[192:195], 0
    v_add_u32 v236, 4294934528, v236
    v_add_u32 v237, 4294934528, v237
    v_mfma_f32_16x16x32_bf16 v[40:43], v[152:155], v[192:195], 0
    v_exp_f32 v185, v185
    v_mfma_f32_16x16x32_bf16 v[44:47], v[156:159], v[192:195], 0
    s_add_u32 m0, s44, 65536
    s_nop 0
    buffer_load_dwordx4 v240, s[28:31], s56 offen nt lds
    v_mfma_f32_16x16x32_bf16 a[144:147], v[160:163], v[192:195], 0
    v_exp_f32 v186, v186
    v_mfma_f32_16x16x32_bf16 a[148:151], v[164:167], v[192:195], 0
    ds_read_b128 a[80:83], v254 offset:5120
    ds_read_b128 a[84:87], v254 offset:12288
    v_mfma_f32_16x16x32_bf16 a[152:155], v[168:171], v[192:195], 0
    v_exp_f32 v187, v187
    v_mfma_f32_16x16x32_bf16 a[156:159], v[172:175], v[192:195], 0
    v_cvt_pk_bf16_f32 v196, v184, v185
    v_cvt_pk_bf16_f32 v197, v186, v187
    v_mfma_f32_16x16x32_bf16 a[232:235], a[252:255], v[192:195], 0
    v_exp_f32 v188, v188
    s_waitcnt lgkmcnt(2)
    v_mfma_f32_16x16x32_bf16 v[176:179], v[112:115], a[64:67], v[216:219]
    ds_read_b128 a[88:91], v254 offset:19456
    ds_read_b128 a[92:95], v254 offset:26624
    v_mfma_f32_16x16x32_bf16 v[176:179], v[116:119], a[68:71], v[176:179]
    v_exp_f32 v189, v189
    v_mfma_f32_16x16x32_bf16 v[176:179], v[120:123], a[72:75], v[176:179]
    buffer_load_dwordx4 v241, s[28:31], s56 offen offset:1024 nt lds
    v_mfma_f32_16x16x32_bf16 v[176:179], v[124:127], a[76:79], v[176:179]
    v_exp_f32 v190, v190
    v_mfma_f32_16x16x32_bf16 v[180:183], v[128:131], a[64:67], v[216:219]
    v_add_u32 v238, 4294934528, v238
    v_add_u32 v239, 4294934528, v239
    v_mfma_f32_16x16x32_bf16 v[180:183], v[132:135], a[68:71], v[180:183]
    v_exp_f32 v191, v191
    v_mfma_f32_16x16x32_bf16 v[180:183], v[136:139], a[72:75], v[180:183]
    v_cvt_pk_bf16_f32 v198, v188, v189
    v_cvt_pk_bf16_f32 v199, v190, v191
    v_mfma_f32_16x16x32_bf16 v[180:183], v[140:143], a[76:79], v[180:183]
    v_mfma_f32_16x16x32_bf16 v[48:51], v[144:147], v[196:199], 0
    v_exp_f32 v176, v176
    v_mfma_f32_16x16x32_bf16 v[52:55], v[148:151], v[196:199], 0
    v_add_u32 v228, 4294934528, v228
    v_add_u32 v229, 4294934528, v229
    v_mfma_f32_16x16x32_bf16 v[56:59], v[152:155], v[196:199], 0
    v_exp_f32 v177, v177
    v_mfma_f32_16x16x32_bf16 v[60:63], v[156:159], v[196:199], 0
    buffer_load_dwordx4 v240, s[28:31], s56 offen offset:2048 nt lds
    v_mfma_f32_16x16x32_bf16 a[160:163], v[160:163], v[196:199], 0
    v_exp_f32 v178, v178
    v_mfma_f32_16x16x32_bf16 a[164:167], v[164:167], v[196:199], 0
    ds_read_b128 a[96:99], v254 offset:6144
    ds_read_b128 a[100:103], v254 offset:13312
    v_mfma_f32_16x16x32_bf16 a[168:171], v[168:171], v[196:199], 0
    v_exp_f32 v179, v179
    v_mfma_f32_16x16x32_bf16 a[172:175], v[172:175], v[196:199], 0
    v_cvt_pk_bf16_f32 v192, v176, v177
    v_cvt_pk_bf16_f32 v193, v178, v179
    v_mfma_f32_16x16x32_bf16 a[236:239], a[252:255], v[196:199], 0
    v_exp_f32 v180, v180
    s_waitcnt lgkmcnt(2)
    v_mfma_f32_16x16x32_bf16 v[184:187], v[112:115], a[80:83], v[220:223]
    ds_read_b128 a[104:107], v254 offset:20480
    ds_read_b128 a[108:111], v254 offset:27648
    v_mfma_f32_16x16x32_bf16 v[184:187], v[116:119], a[84:87], v[184:187]
    v_exp_f32 v181, v181
    v_mfma_f32_16x16x32_bf16 v[184:187], v[120:123], a[88:91], v[184:187]
    buffer_load_dwordx4 v241, s[28:31], s56 offen offset:3072 nt lds
    v_mfma_f32_16x16x32_bf16 v[184:187], v[124:127], a[92:95], v[184:187]
    v_exp_f32 v182, v182
    v_mfma_f32_16x16x32_bf16 v[188:191], v[128:131], a[80:83], v[220:223]
    v_add_u32 v230, 4294934528, v230
    v_add_u32 v231, 4294934528, v231
    v_mfma_f32_16x16x32_bf16 v[188:191], v[132:135], a[84:87], v[188:191]
    v_exp_f32 v183, v183
    v_mfma_f32_16x16x32_bf16 v[188:191], v[136:139], a[88:91], v[188:191]
    v_cvt_pk_bf16_f32 v194, v180, v181
    v_cvt_pk_bf16_f32 v195, v182, v183
    v_mfma_f32_16x16x32_bf16 v[188:191], v[140:143], a[92:95], v[188:191]
    v_add_u32 v240, 49152, v240
    v_add_u32 v241, 49152, v241
    v_mfma_f32_16x16x32_bf16 v[64:67], v[144:147], v[192:195], 0
    v_exp_f32 v184, v184
    v_mfma_f32_16x16x32_bf16 v[68:71], v[148:151], v[192:195], 0
    v_mfma_f32_16x16x32_bf16 v[72:75], v[152:155], v[192:195], 0
    v_exp_f32 v185, v185
    v_mfma_f32_16x16x32_bf16 v[76:79], v[156:159], v[192:195], 0
    v_mfma_f32_16x16x32_bf16 a[176:179], v[160:163], v[192:195], 0
    v_exp_f32 v186, v186
    v_mfma_f32_16x16x32_bf16 a[180:183], v[164:167], v[192:195], 0
    s_waitcnt lgkmcnt(0)
    s_waitcnt vmcnt(10)
    s_barrier
    v_mfma_f32_16x16x32_bf16 a[184:187], v[168:171], v[192:195], 0
    v_exp_f32 v187, v187
    v_mfma_f32_16x16x32_bf16 a[188:191], v[172:175], v[192:195], 0
    v_cvt_pk_bf16_f32 v196, v184, v185
    v_cvt_pk_bf16_f32 v197, v186, v187
    v_mfma_f32_16x16x32_bf16 a[240:243], a[252:255], v[192:195], 0
    v_exp_f32 v188, v188
    v_mfma_f32_16x16x32_bf16 v[176:179], v[112:115], a[96:99], v[224:227]
    ds_read_b128 v[112:115], v228
    s_add_u32 m0, s44, 49152
    v_mfma_f32_16x16x32_bf16 v[176:179], v[116:119], a[100:103], v[176:179]
    v_exp_f32 v189, v189
    v_mfma_f32_16x16x32_bf16 v[176:179], v[120:123], a[104:107], v[176:179]
    ds_read_b128 v[116:119], v229
    ds_read_b128 v[120:123], v230
    v_mfma_f32_16x16x32_bf16 v[176:179], v[124:127], a[108:111], v[176:179]
    v_exp_f32 v190, v190
    v_mfma_f32_16x16x32_bf16 v[180:183], v[128:131], a[96:99], v[224:227]
    ds_read_b128 v[124:127], v231
    ds_read_b128 v[128:131], v228 offset:4096
    v_mfma_f32_16x16x32_bf16 v[180:183], v[132:135], a[100:103], v[180:183]
    v_exp_f32 v191, v191
    v_mfma_f32_16x16x32_bf16 v[180:183], v[136:139], a[104:107], v[180:183]
    v_cvt_pk_bf16_f32 v198, v188, v189
    v_cvt_pk_bf16_f32 v199, v190, v191
    v_mfma_f32_16x16x32_bf16 v[180:183], v[140:143], a[108:111], v[180:183]
    ds_read_b128 v[132:135], v229 offset:4096
    ds_read_b128 v[136:139], v230 offset:4096
    v_mfma_f32_16x16x32_bf16 v[80:83], v[144:147], v[196:199], 0
    v_exp_f32 v176, v176
    v_mfma_f32_16x16x32_bf16 v[84:87], v[148:151], v[196:199], 0
    ds_read_b128 v[140:143], v231 offset:4096
    buffer_load_dwordx4 v240, s[24:27], 0 offen nt lds
    v_mfma_f32_16x16x32_bf16 v[88:91], v[152:155], v[196:199], 0
    v_exp_f32 v177, v177
    v_mfma_f32_16x16x32_bf16 v[92:95], v[156:159], v[196:199], 0
    buffer_load_dwordx4 v241, s[24:27], 0 offen offset:1024 nt lds
    v_mfma_f32_16x16x32_bf16 a[192:195], v[160:163], v[196:199], 0
    v_exp_f32 v178, v178
    v_mfma_f32_16x16x32_bf16 a[196:199], v[164:167], v[196:199], 0
    s_waitcnt lgkmcnt(4)
    buffer_load_dwordx4 v240, s[24:27], 0 offen offset:2048 nt lds
    v_mfma_f32_16x16x32_bf16 a[200:203], v[168:171], v[196:199], 0
    v_exp_f32 v179, v179
    v_mfma_f32_16x16x32_bf16 a[204:207], v[172:175], v[196:199], 0
    v_cvt_pk_bf16_f32 v192, v176, v177
    v_cvt_pk_bf16_f32 v193, v178, v179
    buffer_load_dwordx4 v241, s[24:27], 0 offen offset:3072 nt lds
    v_mfma_f32_16x16x32_bf16 a[244:247], a[252:255], v[196:199], 0
    v_exp_f32 v180, v180
    v_mfma_f32_16x16x32_bf16 v[184:187], v[112:115], a[0:3], v[200:203]
    s_add_u32 m0, s44, 32768
    s_nop 0
    buffer_load_dwordx4 v240, s[28:31], 0 offen nt lds
    v_mfma_f32_16x16x32_bf16 v[184:187], v[116:119], a[4:7], v[184:187]
    v_exp_f32 v181, v181
    v_mfma_f32_16x16x32_bf16 v[184:187], v[120:123], a[8:11], v[184:187]
    s_waitcnt lgkmcnt(0)
    buffer_load_dwordx4 v241, s[28:31], 0 offen offset:1024 nt lds
    v_mfma_f32_16x16x32_bf16 v[184:187], v[124:127], a[12:15], v[184:187]
    v_exp_f32 v182, v182
    v_mfma_f32_16x16x32_bf16 v[188:191], v[128:131], a[0:3], v[200:203]
    buffer_load_dwordx4 v240, s[28:31], 0 offen offset:2048 nt lds
    v_mfma_f32_16x16x32_bf16 v[188:191], v[132:135], a[4:7], v[188:191]
    v_exp_f32 v183, v183
    v_mfma_f32_16x16x32_bf16 v[188:191], v[136:139], a[8:11], v[188:191]
    v_cvt_pk_bf16_f32 v194, v180, v181
    v_cvt_pk_bf16_f32 v195, v182, v183
    buffer_load_dwordx4 v241, s[28:31], 0 offen offset:3072 nt lds
    v_mfma_f32_16x16x32_bf16 v[188:191], v[140:143], a[12:15], v[188:191]
    v_add_u32 v240, 16384, v240
    v_add_u32 v241, 16384, v241
    s_add_u32 m0, s44, 147456
    v_mfma_f32_16x16x32_bf16 v[96:99], v[144:147], v[192:195], 0
    v_exp_f32 v184, v184
    buffer_load_dwordx4 v240, s[24:27], 0 offen nt lds
    v_mfma_f32_16x16x32_bf16 v[100:103], v[148:151], v[192:195], 0
    ds_read_b64_tr_b16 v[144:145], v232
    ds_read_b64_tr_b16 v[146:147], v232 offset:4096
    v_mfma_f32_16x16x32_bf16 v[104:107], v[152:155], v[192:195], 0
    v_exp_f32 v185, v185
    v_mfma_f32_16x16x32_bf16 v[108:111], v[156:159], v[192:195], 0
    ds_read_b64_tr_b16 v[148:149], v233
    ds_read_b64_tr_b16 v[150:151], v233 offset:4096
    v_mfma_f32_16x16x32_bf16 a[208:211], v[160:163], v[192:195], 0
    v_exp_f32 v186, v186
    buffer_load_dwordx4 v241, s[24:27], 0 offen offset:1024 nt lds
    v_mfma_f32_16x16x32_bf16 a[212:215], v[164:167], v[192:195], 0
    ds_read_b64_tr_b16 v[152:153], v234
    ds_read_b64_tr_b16 v[154:155], v234 offset:4096
    v_mfma_f32_16x16x32_bf16 a[216:219], v[168:171], v[192:195], 0
    v_exp_f32 v187, v187
    v_mfma_f32_16x16x32_bf16 a[220:223], v[172:175], v[192:195], 0
    v_cvt_pk_bf16_f32 v196, v184, v185
    v_cvt_pk_bf16_f32 v197, v186, v187
    v_mfma_f32_16x16x32_bf16 a[248:251], a[252:255], v[192:195], 0
    v_exp_f32 v188, v188
    buffer_load_dwordx4 v240, s[24:27], 0 offen offset:2048 nt lds
    v_mfma_f32_16x16x32_bf16 v[176:179], v[112:115], a[16:19], v[204:207]
    ds_read_b64_tr_b16 v[156:157], v235
    ds_read_b64_tr_b16 v[158:159], v235 offset:4096
    v_mfma_f32_16x16x32_bf16 v[176:179], v[116:119], a[20:23], v[176:179]
    v_exp_f32 v189, v189
    v_mfma_f32_16x16x32_bf16 v[176:179], v[120:123], a[24:27], v[176:179]
    ds_read_b64_tr_b16 v[160:161], v236
    ds_read_b64_tr_b16 v[162:163], v236 offset:4096
    v_mfma_f32_16x16x32_bf16 v[176:179], v[124:127], a[28:31], v[176:179]
    v_exp_f32 v190, v190
    buffer_load_dwordx4 v241, s[24:27], 0 offen offset:3072 nt lds
    v_mfma_f32_16x16x32_bf16 v[180:183], v[128:131], a[16:19], v[204:207]
    ds_read_b64_tr_b16 v[164:165], v237
    ds_read_b64_tr_b16 v[166:167], v237 offset:4096
    v_mfma_f32_16x16x32_bf16 v[180:183], v[132:135], a[20:23], v[180:183]
    v_exp_f32 v191, v191
    v_mfma_f32_16x16x32_bf16 v[180:183], v[136:139], a[24:27], v[180:183]
    v_cvt_pk_bf16_f32 v198, v188, v189
    v_cvt_pk_bf16_f32 v199, v190, v191
    v_mfma_f32_16x16x32_bf16 v[180:183], v[140:143], a[28:31], v[180:183]
    ds_read_b64_tr_b16 v[168:169], v238
    ds_read_b64_tr_b16 v[170:171], v238 offset:4096
    s_waitcnt lgkmcnt(6)
    v_mfma_f32_16x16x32_bf16 v[0:3], v[144:147], v[196:199], v[0:3]
    v_exp_f32 v176, v176
    v_mfma_f32_16x16x32_bf16 v[4:7], v[148:151], v[196:199], v[4:7]
    ds_read_b64_tr_b16 v[172:173], v239
    ds_read_b64_tr_b16 v[174:175], v239 offset:4096
    v_mfma_f32_16x16x32_bf16 v[8:11], v[152:155], v[196:199], v[8:11]
    v_exp_f32 v177, v177
    v_mfma_f32_16x16x32_bf16 v[12:15], v[156:159], v[196:199], v[12:15]
    s_waitcnt lgkmcnt(4)
    v_mfma_f32_16x16x32_bf16 a[112:115], v[160:163], v[196:199], a[112:115]
    v_exp_f32 v178, v178
    v_mfma_f32_16x16x32_bf16 a[116:119], v[164:167], v[196:199], a[116:119]
    s_waitcnt lgkmcnt(0)
    v_mfma_f32_16x16x32_bf16 a[120:123], v[168:171], v[196:199], a[120:123]
    v_exp_f32 v179, v179
    v_mfma_f32_16x16x32_bf16 a[124:127], v[172:175], v[196:199], a[124:127]
    v_cvt_pk_bf16_f32 v192, v176, v177
    v_cvt_pk_bf16_f32 v193, v178, v179
    v_mfma_f32_16x16x32_bf16 a[224:227], a[252:255], v[196:199], a[224:227]
    v_exp_f32 v180, v180
    v_mfma_f32_16x16x32_bf16 v[184:187], v[112:115], a[32:35], v[208:211]
    s_add_u32 m0, s44, 131072
    v_mfma_f32_16x16x32_bf16 v[184:187], v[116:119], a[36:39], v[184:187]
    v_exp_f32 v181, v181
    v_mfma_f32_16x16x32_bf16 v[184:187], v[120:123], a[40:43], v[184:187]
    v_mfma_f32_16x16x32_bf16 v[184:187], v[124:127], a[44:47], v[184:187]
    v_exp_f32 v182, v182
    v_mfma_f32_16x16x32_bf16 v[188:191], v[128:131], a[32:35], v[208:211]
    buffer_load_dwordx4 v240, s[28:31], 0 offen nt lds
    v_mfma_f32_16x16x32_bf16 v[188:191], v[132:135], a[36:39], v[188:191]
    v_exp_f32 v183, v183
    v_mfma_f32_16x16x32_bf16 v[188:191], v[136:139], a[40:43], v[188:191]
    v_cvt_pk_bf16_f32 v194, v180, v181
    v_cvt_pk_bf16_f32 v195, v182, v183
    v_mfma_f32_16x16x32_bf16 v[188:191], v[140:143], a[44:47], v[188:191]
    v_mfma_f32_16x16x32_bf16 v[16:19], v[144:147], v[192:195], v[16:19]
    v_exp_f32 v184, v184
    v_mfma_f32_16x16x32_bf16 v[20:23], v[148:151], v[192:195], v[20:23]
    v_mfma_f32_16x16x32_bf16 v[24:27], v[152:155], v[192:195], v[24:27]
    v_exp_f32 v185, v185
    v_mfma_f32_16x16x32_bf16 v[28:31], v[156:159], v[192:195], v[28:31]
    v_mfma_f32_16x16x32_bf16 a[128:131], v[160:163], v[192:195], a[128:131]
    v_exp_f32 v186, v186
    v_mfma_f32_16x16x32_bf16 a[132:135], v[164:167], v[192:195], a[132:135]
    buffer_load_dwordx4 v241, s[28:31], 0 offen offset:1024 nt lds
    v_mfma_f32_16x16x32_bf16 a[136:139], v[168:171], v[192:195], a[136:139]
    v_exp_f32 v187, v187
    v_mfma_f32_16x16x32_bf16 a[140:143], v[172:175], v[192:195], a[140:143]
    v_cvt_pk_bf16_f32 v196, v184, v185
    v_cvt_pk_bf16_f32 v197, v186, v187
    v_mfma_f32_16x16x32_bf16 a[228:231], a[252:255], v[192:195], a[228:231]
    v_exp_f32 v188, v188
    v_mfma_f32_16x16x32_bf16 v[176:179], v[112:115], a[48:51], v[212:215]
    v_add_u32 v232, 4294934528, v232
    v_add_u32 v233, 4294934528, v233
    v_mfma_f32_16x16x32_bf16 v[176:179], v[116:119], a[52:55], v[176:179]
    v_exp_f32 v189, v189
    v_mfma_f32_16x16x32_bf16 v[176:179], v[120:123], a[56:59], v[176:179]
    v_mfma_f32_16x16x32_bf16 v[176:179], v[124:127], a[60:63], v[176:179]
    v_exp_f32 v190, v190
    v_mfma_f32_16x16x32_bf16 v[180:183], v[128:131], a[48:51], v[212:215]
    v_add_u32 v234, 4294934528, v234
    v_add_u32 v235, 4294934528, v235
    v_mfma_f32_16x16x32_bf16 v[180:183], v[132:135], a[52:55], v[180:183]
    v_exp_f32 v191, v191
    v_mfma_f32_16x16x32_bf16 v[180:183], v[136:139], a[56:59], v[180:183]
    v_cvt_pk_bf16_f32 v198, v188, v189
    v_cvt_pk_bf16_f32 v199, v190, v191
    v_mfma_f32_16x16x32_bf16 v[180:183], v[140:143], a[60:63], v[180:183]
    v_mfma_f32_16x16x32_bf16 v[32:35], v[144:147], v[196:199], v[32:35]
    v_exp_f32 v176, v176
    v_mfma_f32_16x16x32_bf16 v[36:39], v[148:151], v[196:199], v[36:39]
    v_add_u32 v236, 4294934528, v236
    v_add_u32 v237, 4294934528, v237
    v_mfma_f32_16x16x32_bf16 v[40:43], v[152:155], v[196:199], v[40:43]
    v_exp_f32 v177, v177
    v_mfma_f32_16x16x32_bf16 v[44:47], v[156:159], v[196:199], v[44:47]
    v_mfma_f32_16x16x32_bf16 a[144:147], v[160:163], v[196:199], a[144:147]
    v_exp_f32 v178, v178
    v_mfma_f32_16x16x32_bf16 a[148:151], v[164:167], v[196:199], a[148:151]
    buffer_load_dwordx4 v240, s[28:31], 0 offen offset:2048 nt lds
    v_mfma_f32_16x16x32_bf16 a[152:155], v[168:171], v[196:199], a[152:155]
    v_exp_f32 v179, v179
    v_mfma_f32_16x16x32_bf16 a[156:159], v[172:175], v[196:199], a[156:159]
    v_cvt_pk_bf16_f32 v192, v176, v177
    v_cvt_pk_bf16_f32 v193, v178, v179
    v_mfma_f32_16x16x32_bf16 a[232:235], a[252:255], v[196:199], a[232:235]
    v_exp_f32 v180, v180
    v_mfma_f32_16x16x32_bf16 v[184:187], v[112:115], a[64:67], v[216:219]
    v_mfma_f32_16x16x32_bf16 v[184:187], v[116:119], a[68:71], v[184:187]
    v_exp_f32 v181, v181
    v_mfma_f32_16x16x32_bf16 v[184:187], v[120:123], a[72:75], v[184:187]
    v_mfma_f32_16x16x32_bf16 v[184:187], v[124:127], a[76:79], v[184:187]
    v_exp_f32 v182, v182
    v_mfma_f32_16x16x32_bf16 v[188:191], v[128:131], a[64:67], v[216:219]
    v_add_u32 v238, 4294934528, v238
    v_add_u32 v239, 4294934528, v239
    v_mfma_f32_16x16x32_bf16 v[188:191], v[132:135], a[68:71], v[188:191]
    v_exp_f32 v183, v183
    v_mfma_f32_16x16x32_bf16 v[188:191], v[136:139], a[72:75], v[188:191]
    v_cvt_pk_bf16_f32 v194, v180, v181
    v_cvt_pk_bf16_f32 v195, v182, v183
    v_mfma_f32_16x16x32_bf16 v[188:191], v[140:143], a[76:79], v[188:191]
    v_mfma_f32_16x16x32_bf16 v[48:51], v[144:147], v[192:195], v[48:51]
    v_exp_f32 v184, v184
    v_mfma_f32_16x16x32_bf16 v[52:55], v[148:151], v[192:195], v[52:55]
    v_add_u32 v228, 4294934528, v228
    v_add_u32 v229, 4294934528, v229
    v_mfma_f32_16x16x32_bf16 v[56:59], v[152:155], v[192:195], v[56:59]
    v_exp_f32 v185, v185
    v_mfma_f32_16x16x32_bf16 v[60:63], v[156:159], v[192:195], v[60:63]
    v_mfma_f32_16x16x32_bf16 a[160:163], v[160:163], v[192:195], a[160:163]
    v_exp_f32 v186, v186
    v_mfma_f32_16x16x32_bf16 a[164:167], v[164:167], v[192:195], a[164:167]
    buffer_load_dwordx4 v241, s[28:31], 0 offen offset:3072 nt lds
    v_mfma_f32_16x16x32_bf16 a[168:171], v[168:171], v[192:195], a[168:171]
    v_exp_f32 v187, v187
    v_mfma_f32_16x16x32_bf16 a[172:175], v[172:175], v[192:195], a[172:175]
    v_cvt_pk_bf16_f32 v196, v184, v185
    v_cvt_pk_bf16_f32 v197, v186, v187
    v_mfma_f32_16x16x32_bf16 a[236:239], a[252:255], v[192:195], a[236:239]
    v_exp_f32 v188, v188
    v_mfma_f32_16x16x32_bf16 v[176:179], v[112:115], a[80:83], v[220:223]
    v_mfma_f32_16x16x32_bf16 v[176:179], v[116:119], a[84:87], v[176:179]
    v_exp_f32 v189, v189
    v_mfma_f32_16x16x32_bf16 v[176:179], v[120:123], a[88:91], v[176:179]
    v_add_u32 v240, 16384, v240
    v_add_u32 v241, 16384, v241
    v_mfma_f32_16x16x32_bf16 v[176:179], v[124:127], a[92:95], v[176:179]
    v_exp_f32 v190, v190
    v_mfma_f32_16x16x32_bf16 v[180:183], v[128:131], a[80:83], v[220:223]
    v_add_u32 v230, 4294934528, v230
    v_add_u32 v231, 4294934528, v231
    v_mfma_f32_16x16x32_bf16 v[180:183], v[132:135], a[84:87], v[180:183]
    v_exp_f32 v191, v191
    v_mfma_f32_16x16x32_bf16 v[180:183], v[136:139], a[88:91], v[180:183]
    v_cvt_pk_bf16_f32 v198, v188, v189
    v_cvt_pk_bf16_f32 v199, v190, v191
    v_mfma_f32_16x16x32_bf16 v[180:183], v[140:143], a[92:95], v[180:183]
    v_mfma_f32_16x16x32_bf16 v[64:67], v[144:147], v[196:199], v[64:67]
    v_exp_f32 v176, v176
    v_mfma_f32_16x16x32_bf16 v[68:71], v[148:151], v[196:199], v[68:71]
    v_mfma_f32_16x16x32_bf16 v[72:75], v[152:155], v[196:199], v[72:75]
    v_exp_f32 v177, v177
    v_mfma_f32_16x16x32_bf16 v[76:79], v[156:159], v[196:199], v[76:79]
    v_mfma_f32_16x16x32_bf16 a[176:179], v[160:163], v[196:199], a[176:179]
    v_exp_f32 v178, v178
    v_mfma_f32_16x16x32_bf16 a[180:183], v[164:167], v[196:199], a[180:183]
    s_waitcnt vmcnt(16)
    s_barrier
    v_mfma_f32_16x16x32_bf16 a[184:187], v[168:171], v[196:199], a[184:187]
    v_exp_f32 v179, v179
    v_mfma_f32_16x16x32_bf16 a[188:191], v[172:175], v[196:199], a[188:191]
    v_cvt_pk_bf16_f32 v192, v176, v177
    v_cvt_pk_bf16_f32 v193, v178, v179
    v_mfma_f32_16x16x32_bf16 a[240:243], a[252:255], v[196:199], a[240:243]
    v_exp_f32 v180, v180
    v_mfma_f32_16x16x32_bf16 v[184:187], v[112:115], a[96:99], v[224:227]
    ds_read_b128 v[112:115], v228
    v_mfma_f32_16x16x32_bf16 v[184:187], v[116:119], a[100:103], v[184:187]
    v_exp_f32 v181, v181
    v_mfma_f32_16x16x32_bf16 v[184:187], v[120:123], a[104:107], v[184:187]
    ds_read_b128 v[116:119], v229
    ds_read_b128 v[120:123], v230
    v_mfma_f32_16x16x32_bf16 v[184:187], v[124:127], a[108:111], v[184:187]
    v_exp_f32 v182, v182
    v_mfma_f32_16x16x32_bf16 v[188:191], v[128:131], a[96:99], v[224:227]
    ds_read_b128 v[124:127], v231
    ds_read_b128 v[128:131], v228 offset:4096
    v_mfma_f32_16x16x32_bf16 v[188:191], v[132:135], a[100:103], v[188:191]
    v_exp_f32 v183, v183
    v_mfma_f32_16x16x32_bf16 v[188:191], v[136:139], a[104:107], v[188:191]
    v_cvt_pk_bf16_f32 v194, v180, v181
    v_cvt_pk_bf16_f32 v195, v182, v183
    v_mfma_f32_16x16x32_bf16 v[188:191], v[140:143], a[108:111], v[188:191]
    ds_read_b128 v[132:135], v229 offset:4096
    ds_read_b128 v[136:139], v230 offset:4096
    v_mfma_f32_16x16x32_bf16 v[80:83], v[144:147], v[192:195], v[80:83]
    v_exp_f32 v184, v184
    v_mfma_f32_16x16x32_bf16 v[84:87], v[148:151], v[192:195], v[84:87]
    ds_read_b128 v[140:143], v231 offset:4096
    s_add_u32 m0, s44, 114688
    v_mfma_f32_16x16x32_bf16 v[88:91], v[152:155], v[192:195], v[88:91]
    v_exp_f32 v185, v185
    v_mfma_f32_16x16x32_bf16 v[92:95], v[156:159], v[192:195], v[92:95]
    buffer_load_dwordx4 v240, s[24:27], 0 offen nt lds
    v_mfma_f32_16x16x32_bf16 a[192:195], v[160:163], v[192:195], a[192:195]
    v_exp_f32 v186, v186
    v_mfma_f32_16x16x32_bf16 a[196:199], v[164:167], v[192:195], a[196:199]
    s_waitcnt lgkmcnt(4)
    buffer_load_dwordx4 v241, s[24:27], 0 offen offset:1024 nt lds
    v_mfma_f32_16x16x32_bf16 a[200:203], v[168:171], v[192:195], a[200:203]
    v_exp_f32 v187, v187
    v_mfma_f32_16x16x32_bf16 a[204:207], v[172:175], v[192:195], a[204:207]
    v_cvt_pk_bf16_f32 v196, v184, v185
    v_cvt_pk_bf16_f32 v197, v186, v187
    v_mfma_f32_16x16x32_bf16 a[244:247], a[252:255], v[192:195], a[244:247]
    v_exp_f32 v188, v188
    v_mfma_f32_16x16x32_bf16 v[176:179], v[112:115], a[0:3], v[200:203]
    buffer_load_dwordx4 v240, s[24:27], 0 offen offset:2048 nt lds
    v_mfma_f32_16x16x32_bf16 v[176:179], v[116:119], a[4:7], v[176:179]
    v_exp_f32 v189, v189
    v_mfma_f32_16x16x32_bf16 v[176:179], v[120:123], a[8:11], v[176:179]
    s_waitcnt lgkmcnt(0)
    v_mfma_f32_16x16x32_bf16 v[176:179], v[124:127], a[12:15], v[176:179]
    v_exp_f32 v190, v190
    v_mfma_f32_16x16x32_bf16 v[180:183], v[128:131], a[0:3], v[200:203]
    buffer_load_dwordx4 v241, s[24:27], 0 offen offset:3072 nt lds
    v_mfma_f32_16x16x32_bf16 v[180:183], v[132:135], a[4:7], v[180:183]
    v_exp_f32 v191, v191
    v_mfma_f32_16x16x32_bf16 v[180:183], v[136:139], a[8:11], v[180:183]
    v_cvt_pk_bf16_f32 v198, v188, v189
    v_cvt_pk_bf16_f32 v199, v190, v191
    v_mfma_f32_16x16x32_bf16 v[180:183], v[140:143], a[12:15], v[180:183]
    v_mfma_f32_16x16x32_bf16 v[96:99], v[144:147], v[196:199], v[96:99]
    v_exp_f32 v176, v176
    v_mfma_f32_16x16x32_bf16 v[100:103], v[148:151], v[196:199], v[100:103]
    ds_read_b64_tr_b16 v[144:145], v232
    ds_read_b64_tr_b16 v[146:147], v232 offset:4096
    v_mfma_f32_16x16x32_bf16 v[104:107], v[152:155], v[196:199], v[104:107]
    v_exp_f32 v177, v177
    v_mfma_f32_16x16x32_bf16 v[108:111], v[156:159], v[196:199], v[108:111]
    ds_read_b64_tr_b16 v[148:149], v233
    ds_read_b64_tr_b16 v[150:151], v233 offset:4096
    v_mfma_f32_16x16x32_bf16 a[208:211], v[160:163], v[196:199], a[208:211]
    v_exp_f32 v178, v178
    v_mfma_f32_16x16x32_bf16 a[212:215], v[164:167], v[196:199], a[212:215]
    ds_read_b64_tr_b16 v[152:153], v234
    ds_read_b64_tr_b16 v[154:155], v234 offset:4096
    v_mfma_f32_16x16x32_bf16 a[216:219], v[168:171], v[196:199], a[216:219]
    v_exp_f32 v179, v179
    v_mfma_f32_16x16x32_bf16 a[220:223], v[172:175], v[196:199], a[220:223]
    v_cvt_pk_bf16_f32 v192, v176, v177
    v_cvt_pk_bf16_f32 v193, v178, v179
    v_mfma_f32_16x16x32_bf16 a[248:251], a[252:255], v[196:199], a[248:251]
    v_exp_f32 v180, v180
    v_mfma_f32_16x16x32_bf16 v[184:187], v[112:115], a[16:19], v[204:207]
    ds_read_b64_tr_b16 v[156:157], v235
    ds_read_b64_tr_b16 v[158:159], v235 offset:4096
    v_mfma_f32_16x16x32_bf16 v[184:187], v[116:119], a[20:23], v[184:187]
    v_exp_f32 v181, v181
    v_mfma_f32_16x16x32_bf16 v[184:187], v[120:123], a[24:27], v[184:187]
    ds_read_b64_tr_b16 v[160:161], v236
    ds_read_b64_tr_b16 v[162:163], v236 offset:4096
    v_mfma_f32_16x16x32_bf16 v[184:187], v[124:127], a[28:31], v[184:187]
    v_exp_f32 v182, v182
    v_mfma_f32_16x16x32_bf16 v[188:191], v[128:131], a[16:19], v[204:207]
    ds_read_b64_tr_b16 v[164:165], v237
    ds_read_b64_tr_b16 v[166:167], v237 offset:4096
    v_mfma_f32_16x16x32_bf16 v[188:191], v[132:135], a[20:23], v[188:191]
    v_exp_f32 v183, v183
    v_mfma_f32_16x16x32_bf16 v[188:191], v[136:139], a[24:27], v[188:191]
    v_cvt_pk_bf16_f32 v194, v180, v181
    v_cvt_pk_bf16_f32 v195, v182, v183
    v_mfma_f32_16x16x32_bf16 v[188:191], v[140:143], a[28:31], v[188:191]
    ds_read_b64_tr_b16 v[168:169], v238
    ds_read_b64_tr_b16 v[170:171], v238 offset:4096
    s_waitcnt lgkmcnt(6)
    v_mfma_f32_16x16x32_bf16 v[0:3], v[144:147], v[192:195], v[0:3]
    v_exp_f32 v184, v184
    v_mfma_f32_16x16x32_bf16 v[4:7], v[148:151], v[192:195], v[4:7]
    ds_read_b64_tr_b16 v[172:173], v239
    ds_read_b64_tr_b16 v[174:175], v239 offset:4096
    v_mfma_f32_16x16x32_bf16 v[8:11], v[152:155], v[192:195], v[8:11]
    v_exp_f32 v185, v185
    v_mfma_f32_16x16x32_bf16 v[12:15], v[156:159], v[192:195], v[12:15]
    s_waitcnt lgkmcnt(4)
    v_mfma_f32_16x16x32_bf16 a[112:115], v[160:163], v[192:195], a[112:115]
    v_exp_f32 v186, v186
    v_mfma_f32_16x16x32_bf16 a[116:119], v[164:167], v[192:195], a[116:119]
    s_waitcnt lgkmcnt(0)
    v_mfma_f32_16x16x32_bf16 a[120:123], v[168:171], v[192:195], a[120:123]
    v_exp_f32 v187, v187
    v_mfma_f32_16x16x32_bf16 a[124:127], v[172:175], v[192:195], a[124:127]
    v_cvt_pk_bf16_f32 v196, v184, v185
    v_cvt_pk_bf16_f32 v197, v186, v187
    v_mfma_f32_16x16x32_bf16 a[224:227], a[252:255], v[192:195], a[224:227]
    v_exp_f32 v188, v188
    v_mfma_f32_16x16x32_bf16 v[176:179], v[112:115], a[32:35], v[208:211]
    s_add_u32 m0, s44, 98304
    v_mfma_f32_16x16x32_bf16 v[176:179], v[116:119], a[36:39], v[176:179]
    v_exp_f32 v189, v189
    v_mfma_f32_16x16x32_bf16 v[176:179], v[120:123], a[40:43], v[176:179]
    v_mfma_f32_16x16x32_bf16 v[176:179], v[124:127], a[44:47], v[176:179]
    v_exp_f32 v190, v190
    v_mfma_f32_16x16x32_bf16 v[180:183], v[128:131], a[32:35], v[208:211]
    buffer_load_dwordx4 v240, s[28:31], 0 offen nt lds
    v_mfma_f32_16x16x32_bf16 v[180:183], v[132:135], a[36:39], v[180:183]
    v_exp_f32 v191, v191
    v_mfma_f32_16x16x32_bf16 v[180:183], v[136:139], a[40:43], v[180:183]
    v_cvt_pk_bf16_f32 v198, v188, v189
    v_cvt_pk_bf16_f32 v199, v190, v191
    v_mfma_f32_16x16x32_bf16 v[180:183], v[140:143], a[44:47], v[180:183]
    v_mfma_f32_16x16x32_bf16 v[16:19], v[144:147], v[196:199], v[16:19]
    v_exp_f32 v176, v176
    v_mfma_f32_16x16x32_bf16 v[20:23], v[148:151], v[196:199], v[20:23]
    v_mfma_f32_16x16x32_bf16 v[24:27], v[152:155], v[196:199], v[24:27]
    v_exp_f32 v177, v177
    v_mfma_f32_16x16x32_bf16 v[28:31], v[156:159], v[196:199], v[28:31]
    v_mfma_f32_16x16x32_bf16 a[128:131], v[160:163], v[196:199], a[128:131]
    v_exp_f32 v178, v178
    v_mfma_f32_16x16x32_bf16 a[132:135], v[164:167], v[196:199], a[132:135]
    buffer_load_dwordx4 v241, s[28:31], 0 offen offset:1024 nt lds
    v_mfma_f32_16x16x32_bf16 a[136:139], v[168:171], v[196:199], a[136:139]
    v_exp_f32 v179, v179
    v_mfma_f32_16x16x32_bf16 a[140:143], v[172:175], v[196:199], a[140:143]
    v_cvt_pk_bf16_f32 v192, v176, v177
    v_cvt_pk_bf16_f32 v193, v178, v179
    v_mfma_f32_16x16x32_bf16 a[228:231], a[252:255], v[196:199], a[228:231]
    v_exp_f32 v180, v180
    v_mfma_f32_16x16x32_bf16 v[184:187], v[112:115], a[48:51], v[212:215]
    v_add_u32 v232, 4294934528, v232
    v_add_u32 v233, 4294934528, v233
    v_mfma_f32_16x16x32_bf16 v[184:187], v[116:119], a[52:55], v[184:187]
    v_exp_f32 v181, v181
    v_mfma_f32_16x16x32_bf16 v[184:187], v[120:123], a[56:59], v[184:187]
    v_mfma_f32_16x16x32_bf16 v[184:187], v[124:127], a[60:63], v[184:187]
    v_exp_f32 v182, v182
    v_mfma_f32_16x16x32_bf16 v[188:191], v[128:131], a[48:51], v[212:215]
    v_add_u32 v234, 4294934528, v234
    v_add_u32 v235, 4294934528, v235
    v_mfma_f32_16x16x32_bf16 v[188:191], v[132:135], a[52:55], v[188:191]
    v_exp_f32 v183, v183
    v_mfma_f32_16x16x32_bf16 v[188:191], v[136:139], a[56:59], v[188:191]
    v_cvt_pk_bf16_f32 v194, v180, v181
    v_cvt_pk_bf16_f32 v195, v182, v183
    v_mfma_f32_16x16x32_bf16 v[188:191], v[140:143], a[60:63], v[188:191]
    v_mfma_f32_16x16x32_bf16 v[32:35], v[144:147], v[192:195], v[32:35]
    v_exp_f32 v184, v184
    v_mfma_f32_16x16x32_bf16 v[36:39], v[148:151], v[192:195], v[36:39]
    v_add_u32 v236, 4294934528, v236
    v_add_u32 v237, 4294934528, v237
    v_mfma_f32_16x16x32_bf16 v[40:43], v[152:155], v[192:195], v[40:43]
    v_exp_f32 v185, v185
    v_mfma_f32_16x16x32_bf16 v[44:47], v[156:159], v[192:195], v[44:47]
    v_mfma_f32_16x16x32_bf16 a[144:147], v[160:163], v[192:195], a[144:147]
    v_exp_f32 v186, v186
    v_mfma_f32_16x16x32_bf16 a[148:151], v[164:167], v[192:195], a[148:151]
    buffer_load_dwordx4 v240, s[28:31], 0 offen offset:2048 nt lds
    v_mfma_f32_16x16x32_bf16 a[152:155], v[168:171], v[192:195], a[152:155]
    v_exp_f32 v187, v187
    v_mfma_f32_16x16x32_bf16 a[156:159], v[172:175], v[192:195], a[156:159]
    v_cvt_pk_bf16_f32 v196, v184, v185
    v_cvt_pk_bf16_f32 v197, v186, v187
    v_mfma_f32_16x16x32_bf16 a[232:235], a[252:255], v[192:195], a[232:235]
    v_exp_f32 v188, v188
    v_mfma_f32_16x16x32_bf16 v[176:179], v[112:115], a[64:67], v[216:219]
    v_mfma_f32_16x16x32_bf16 v[176:179], v[116:119], a[68:71], v[176:179]
    v_exp_f32 v189, v189
    v_mfma_f32_16x16x32_bf16 v[176:179], v[120:123], a[72:75], v[176:179]
    v_mfma_f32_16x16x32_bf16 v[176:179], v[124:127], a[76:79], v[176:179]
    v_exp_f32 v190, v190
    v_mfma_f32_16x16x32_bf16 v[180:183], v[128:131], a[64:67], v[216:219]
    v_add_u32 v238, 4294934528, v238
    v_add_u32 v239, 4294934528, v239
    v_mfma_f32_16x16x32_bf16 v[180:183], v[132:135], a[68:71], v[180:183]
    v_exp_f32 v191, v191
    v_mfma_f32_16x16x32_bf16 v[180:183], v[136:139], a[72:75], v[180:183]
    v_cvt_pk_bf16_f32 v198, v188, v189
    v_cvt_pk_bf16_f32 v199, v190, v191
    v_mfma_f32_16x16x32_bf16 v[180:183], v[140:143], a[76:79], v[180:183]
    v_mfma_f32_16x16x32_bf16 v[48:51], v[144:147], v[196:199], v[48:51]
    v_exp_f32 v176, v176
    v_mfma_f32_16x16x32_bf16 v[52:55], v[148:151], v[196:199], v[52:55]
    v_add_u32 v228, 4294934528, v228
    v_add_u32 v229, 4294934528, v229
    v_mfma_f32_16x16x32_bf16 v[56:59], v[152:155], v[196:199], v[56:59]
    v_exp_f32 v177, v177
    v_mfma_f32_16x16x32_bf16 v[60:63], v[156:159], v[196:199], v[60:63]
    v_mfma_f32_16x16x32_bf16 a[160:163], v[160:163], v[196:199], a[160:163]
    v_exp_f32 v178, v178
    v_mfma_f32_16x16x32_bf16 a[164:167], v[164:167], v[196:199], a[164:167]
    buffer_load_dwordx4 v241, s[28:31], 0 offen offset:3072 nt lds
    v_mfma_f32_16x16x32_bf16 a[168:171], v[168:171], v[196:199], a[168:171]
    v_exp_f32 v179, v179
    v_mfma_f32_16x16x32_bf16 a[172:175], v[172:175], v[196:199], a[172:175]
    v_cvt_pk_bf16_f32 v192, v176, v177
    v_cvt_pk_bf16_f32 v193, v178, v179
    v_mfma_f32_16x16x32_bf16 a[236:239], a[252:255], v[196:199], a[236:239]
    v_exp_f32 v180, v180
    v_mfma_f32_16x16x32_bf16 v[184:187], v[112:115], a[80:83], v[220:223]
    v_mfma_f32_16x16x32_bf16 v[184:187], v[116:119], a[84:87], v[184:187]
    v_exp_f32 v181, v181
    v_mfma_f32_16x16x32_bf16 v[184:187], v[120:123], a[88:91], v[184:187]
    v_add_u32 v240, 16384, v240
    v_add_u32 v241, 16384, v241
    v_mfma_f32_16x16x32_bf16 v[184:187], v[124:127], a[92:95], v[184:187]
    v_exp_f32 v182, v182
    v_mfma_f32_16x16x32_bf16 v[188:191], v[128:131], a[80:83], v[220:223]
    v_add_u32 v230, 4294934528, v230
    v_add_u32 v231, 4294934528, v231
    v_mfma_f32_16x16x32_bf16 v[188:191], v[132:135], a[84:87], v[188:191]
    v_exp_f32 v183, v183
    v_mfma_f32_16x16x32_bf16 v[188:191], v[136:139], a[88:91], v[188:191]
    v_cvt_pk_bf16_f32 v194, v180, v181
    v_cvt_pk_bf16_f32 v195, v182, v183
    v_mfma_f32_16x16x32_bf16 v[188:191], v[140:143], a[92:95], v[188:191]
    v_mfma_f32_16x16x32_bf16 v[64:67], v[144:147], v[192:195], v[64:67]
    v_exp_f32 v184, v184
    v_mfma_f32_16x16x32_bf16 v[68:71], v[148:151], v[192:195], v[68:71]
    v_mfma_f32_16x16x32_bf16 v[72:75], v[152:155], v[192:195], v[72:75]
    v_exp_f32 v185, v185
    v_mfma_f32_16x16x32_bf16 v[76:79], v[156:159], v[192:195], v[76:79]
    v_mfma_f32_16x16x32_bf16 a[176:179], v[160:163], v[192:195], a[176:179]
    v_exp_f32 v186, v186
    v_mfma_f32_16x16x32_bf16 a[180:183], v[164:167], v[192:195], a[180:183]
    s_waitcnt vmcnt(16)
    s_barrier
    v_mfma_f32_16x16x32_bf16 a[184:187], v[168:171], v[192:195], a[184:187]
    v_exp_f32 v187, v187
    v_mfma_f32_16x16x32_bf16 a[188:191], v[172:175], v[192:195], a[188:191]
    v_cvt_pk_bf16_f32 v196, v184, v185
    v_cvt_pk_bf16_f32 v197, v186, v187
    v_mfma_f32_16x16x32_bf16 a[240:243], a[252:255], v[192:195], a[240:243]
    v_exp_f32 v188, v188
    v_mfma_f32_16x16x32_bf16 v[176:179], v[112:115], a[96:99], v[224:227]
    ds_read_b128 v[112:115], v228
    v_mfma_f32_16x16x32_bf16 v[176:179], v[116:119], a[100:103], v[176:179]
    v_exp_f32 v189, v189
    v_mfma_f32_16x16x32_bf16 v[176:179], v[120:123], a[104:107], v[176:179]
    ds_read_b128 v[116:119], v229
    ds_read_b128 v[120:123], v230
    v_mfma_f32_16x16x32_bf16 v[176:179], v[124:127], a[108:111], v[176:179]
    v_exp_f32 v190, v190
    v_mfma_f32_16x16x32_bf16 v[180:183], v[128:131], a[96:99], v[224:227]
    ds_read_b128 v[124:127], v231
    ds_read_b128 v[128:131], v228 offset:4096
    v_mfma_f32_16x16x32_bf16 v[180:183], v[132:135], a[100:103], v[180:183]
    v_exp_f32 v191, v191
    v_mfma_f32_16x16x32_bf16 v[180:183], v[136:139], a[104:107], v[180:183]
    v_cvt_pk_bf16_f32 v198, v188, v189
    v_cvt_pk_bf16_f32 v199, v190, v191
    v_mfma_f32_16x16x32_bf16 v[180:183], v[140:143], a[108:111], v[180:183]
    ds_read_b128 v[132:135], v229 offset:4096
    ds_read_b128 v[136:139], v230 offset:4096
    v_mfma_f32_16x16x32_bf16 v[80:83], v[144:147], v[196:199], v[80:83]
    v_exp_f32 v176, v176
    v_mfma_f32_16x16x32_bf16 v[84:87], v[148:151], v[196:199], v[84:87]
    ds_read_b128 v[140:143], v231 offset:4096
    s_add_u32 m0, s44, 81920
    v_mfma_f32_16x16x32_bf16 v[88:91], v[152:155], v[196:199], v[88:91]
    v_exp_f32 v177, v177
    v_mfma_f32_16x16x32_bf16 v[92:95], v[156:159], v[196:199], v[92:95]
    buffer_load_dwordx4 v240, s[24:27], 0 offen nt lds
    v_mfma_f32_16x16x32_bf16 a[192:195], v[160:163], v[196:199], a[192:195]
    v_exp_f32 v178, v178
    v_mfma_f32_16x16x32_bf16 a[196:199], v[164:167], v[196:199], a[196:199]
    s_waitcnt lgkmcnt(4)
    buffer_load_dwordx4 v241, s[24:27], 0 offen offset:1024 nt lds
    v_mfma_f32_16x16x32_bf16 a[200:203], v[168:171], v[196:199], a[200:203]
    v_exp_f32 v179, v179
    v_mfma_f32_16x16x32_bf16 a[204:207], v[172:175], v[196:199], a[204:207]
    v_cvt_pk_bf16_f32 v192, v176, v177
    v_cvt_pk_bf16_f32 v193, v178, v179
    v_mfma_f32_16x16x32_bf16 a[244:247], a[252:255], v[196:199], a[244:247]
    v_exp_f32 v180, v180
    v_mfma_f32_16x16x32_bf16 v[184:187], v[112:115], a[0:3], v[200:203]
    buffer_load_dwordx4 v240, s[24:27], 0 offen offset:2048 nt lds
    v_mfma_f32_16x16x32_bf16 v[184:187], v[116:119], a[4:7], v[184:187]
    v_exp_f32 v181, v181
    v_mfma_f32_16x16x32_bf16 v[184:187], v[120:123], a[8:11], v[184:187]
    s_waitcnt lgkmcnt(0)
    v_mfma_f32_16x16x32_bf16 v[184:187], v[124:127], a[12:15], v[184:187]
    v_exp_f32 v182, v182
    v_mfma_f32_16x16x32_bf16 v[188:191], v[128:131], a[0:3], v[200:203]
    buffer_load_dwordx4 v241, s[24:27], 0 offen offset:3072 nt lds
    v_mfma_f32_16x16x32_bf16 v[188:191], v[132:135], a[4:7], v[188:191]
    v_exp_f32 v183, v183
    v_mfma_f32_16x16x32_bf16 v[188:191], v[136:139], a[8:11], v[188:191]
    v_cvt_pk_bf16_f32 v194, v180, v181
    v_cvt_pk_bf16_f32 v195, v182, v183
    v_mfma_f32_16x16x32_bf16 v[188:191], v[140:143], a[12:15], v[188:191]
    v_mfma_f32_16x16x32_bf16 v[96:99], v[144:147], v[192:195], v[96:99]
    v_exp_f32 v184, v184
    v_mfma_f32_16x16x32_bf16 v[100:103], v[148:151], v[192:195], v[100:103]
    ds_read_b64_tr_b16 v[144:145], v232
    ds_read_b64_tr_b16 v[146:147], v232 offset:4096
    v_mfma_f32_16x16x32_bf16 v[104:107], v[152:155], v[192:195], v[104:107]
    v_exp_f32 v185, v185
    v_mfma_f32_16x16x32_bf16 v[108:111], v[156:159], v[192:195], v[108:111]
    ds_read_b64_tr_b16 v[148:149], v233
    ds_read_b64_tr_b16 v[150:151], v233 offset:4096
    v_mfma_f32_16x16x32_bf16 a[208:211], v[160:163], v[192:195], a[208:211]
    v_exp_f32 v186, v186
    v_mfma_f32_16x16x32_bf16 a[212:215], v[164:167], v[192:195], a[212:215]
    ds_read_b64_tr_b16 v[152:153], v234
    ds_read_b64_tr_b16 v[154:155], v234 offset:4096
    v_mfma_f32_16x16x32_bf16 a[216:219], v[168:171], v[192:195], a[216:219]
    v_exp_f32 v187, v187
    v_mfma_f32_16x16x32_bf16 a[220:223], v[172:175], v[192:195], a[220:223]
    v_cvt_pk_bf16_f32 v196, v184, v185
    v_cvt_pk_bf16_f32 v197, v186, v187
    v_mfma_f32_16x16x32_bf16 a[248:251], a[252:255], v[192:195], a[248:251]
    v_exp_f32 v188, v188
    v_mfma_f32_16x16x32_bf16 v[176:179], v[112:115], a[16:19], v[204:207]
    ds_read_b64_tr_b16 v[156:157], v235
    ds_read_b64_tr_b16 v[158:159], v235 offset:4096
    v_mfma_f32_16x16x32_bf16 v[176:179], v[116:119], a[20:23], v[176:179]
    v_exp_f32 v189, v189
    v_mfma_f32_16x16x32_bf16 v[176:179], v[120:123], a[24:27], v[176:179]
    ds_read_b64_tr_b16 v[160:161], v236
    ds_read_b64_tr_b16 v[162:163], v236 offset:4096
    v_mfma_f32_16x16x32_bf16 v[176:179], v[124:127], a[28:31], v[176:179]
    v_exp_f32 v190, v190
    v_mfma_f32_16x16x32_bf16 v[180:183], v[128:131], a[16:19], v[204:207]
    ds_read_b64_tr_b16 v[164:165], v237
    ds_read_b64_tr_b16 v[166:167], v237 offset:4096
    v_mfma_f32_16x16x32_bf16 v[180:183], v[132:135], a[20:23], v[180:183]
    v_exp_f32 v191, v191
    v_mfma_f32_16x16x32_bf16 v[180:183], v[136:139], a[24:27], v[180:183]
    v_cvt_pk_bf16_f32 v198, v188, v189
    v_cvt_pk_bf16_f32 v199, v190, v191
    v_mfma_f32_16x16x32_bf16 v[180:183], v[140:143], a[28:31], v[180:183]
    ds_read_b64_tr_b16 v[168:169], v238
    ds_read_b64_tr_b16 v[170:171], v238 offset:4096
    s_waitcnt lgkmcnt(6)
    v_mfma_f32_16x16x32_bf16 v[0:3], v[144:147], v[196:199], v[0:3]
    v_exp_f32 v176, v176
    v_mfma_f32_16x16x32_bf16 v[4:7], v[148:151], v[196:199], v[4:7]
    ds_read_b64_tr_b16 v[172:173], v239
    ds_read_b64_tr_b16 v[174:175], v239 offset:4096
    v_mfma_f32_16x16x32_bf16 v[8:11], v[152:155], v[196:199], v[8:11]
    v_exp_f32 v177, v177
    v_mfma_f32_16x16x32_bf16 v[12:15], v[156:159], v[196:199], v[12:15]
    s_waitcnt lgkmcnt(4)
    v_mfma_f32_16x16x32_bf16 a[112:115], v[160:163], v[196:199], a[112:115]
    v_exp_f32 v178, v178
    v_mfma_f32_16x16x32_bf16 a[116:119], v[164:167], v[196:199], a[116:119]
    s_waitcnt lgkmcnt(0)
    v_mfma_f32_16x16x32_bf16 a[120:123], v[168:171], v[196:199], a[120:123]
    v_exp_f32 v179, v179
    v_mfma_f32_16x16x32_bf16 a[124:127], v[172:175], v[196:199], a[124:127]
    v_cvt_pk_bf16_f32 v192, v176, v177
    v_cvt_pk_bf16_f32 v193, v178, v179
    v_mfma_f32_16x16x32_bf16 a[224:227], a[252:255], v[196:199], a[224:227]
    v_exp_f32 v180, v180
    v_mfma_f32_16x16x32_bf16 v[184:187], v[112:115], a[32:35], v[208:211]
    s_add_u32 m0, s44, 65536
    v_mfma_f32_16x16x32_bf16 v[184:187], v[116:119], a[36:39], v[184:187]
    v_exp_f32 v181, v181
    v_mfma_f32_16x16x32_bf16 v[184:187], v[120:123], a[40:43], v[184:187]
    v_mfma_f32_16x16x32_bf16 v[184:187], v[124:127], a[44:47], v[184:187]
    v_exp_f32 v182, v182
    v_mfma_f32_16x16x32_bf16 v[188:191], v[128:131], a[32:35], v[208:211]
    buffer_load_dwordx4 v240, s[28:31], 0 offen nt lds
    v_mfma_f32_16x16x32_bf16 v[188:191], v[132:135], a[36:39], v[188:191]
    v_exp_f32 v183, v183
    v_mfma_f32_16x16x32_bf16 v[188:191], v[136:139], a[40:43], v[188:191]
    v_cvt_pk_bf16_f32 v194, v180, v181
    v_cvt_pk_bf16_f32 v195, v182, v183
    v_mfma_f32_16x16x32_bf16 v[188:191], v[140:143], a[44:47], v[188:191]
    v_mfma_f32_16x16x32_bf16 v[16:19], v[144:147], v[192:195], v[16:19]
    v_exp_f32 v184, v184
    v_mfma_f32_16x16x32_bf16 v[20:23], v[148:151], v[192:195], v[20:23]
    v_mfma_f32_16x16x32_bf16 v[24:27], v[152:155], v[192:195], v[24:27]
    v_exp_f32 v185, v185
    v_mfma_f32_16x16x32_bf16 v[28:31], v[156:159], v[192:195], v[28:31]
    v_mfma_f32_16x16x32_bf16 a[128:131], v[160:163], v[192:195], a[128:131]
    v_exp_f32 v186, v186
    v_mfma_f32_16x16x32_bf16 a[132:135], v[164:167], v[192:195], a[132:135]
    buffer_load_dwordx4 v241, s[28:31], 0 offen offset:1024 nt lds
    v_mfma_f32_16x16x32_bf16 a[136:139], v[168:171], v[192:195], a[136:139]
    v_exp_f32 v187, v187
    v_mfma_f32_16x16x32_bf16 a[140:143], v[172:175], v[192:195], a[140:143]
    v_cvt_pk_bf16_f32 v196, v184, v185
    v_cvt_pk_bf16_f32 v197, v186, v187
    v_mfma_f32_16x16x32_bf16 a[228:231], a[252:255], v[192:195], a[228:231]
    v_exp_f32 v188, v188
    v_mfma_f32_16x16x32_bf16 v[176:179], v[112:115], a[48:51], v[212:215]
    v_add_u32 v232, 98304, v232
    v_add_u32 v233, 98304, v233
    v_mfma_f32_16x16x32_bf16 v[176:179], v[116:119], a[52:55], v[176:179]
    v_exp_f32 v189, v189
    v_mfma_f32_16x16x32_bf16 v[176:179], v[120:123], a[56:59], v[176:179]
    v_mfma_f32_16x16x32_bf16 v[176:179], v[124:127], a[60:63], v[176:179]
    v_exp_f32 v190, v190
    v_mfma_f32_16x16x32_bf16 v[180:183], v[128:131], a[48:51], v[212:215]
    v_add_u32 v234, 98304, v234
    v_add_u32 v235, 98304, v235
    v_mfma_f32_16x16x32_bf16 v[180:183], v[132:135], a[52:55], v[180:183]
    v_exp_f32 v191, v191
    v_mfma_f32_16x16x32_bf16 v[180:183], v[136:139], a[56:59], v[180:183]
    v_cvt_pk_bf16_f32 v198, v188, v189
    v_cvt_pk_bf16_f32 v199, v190, v191
    v_mfma_f32_16x16x32_bf16 v[180:183], v[140:143], a[60:63], v[180:183]
    v_mfma_f32_16x16x32_bf16 v[32:35], v[144:147], v[196:199], v[32:35]
    v_exp_f32 v176, v176
    v_mfma_f32_16x16x32_bf16 v[36:39], v[148:151], v[196:199], v[36:39]
    v_add_u32 v236, 98304, v236
    v_add_u32 v237, 98304, v237
    v_mfma_f32_16x16x32_bf16 v[40:43], v[152:155], v[196:199], v[40:43]
    v_exp_f32 v177, v177
    v_mfma_f32_16x16x32_bf16 v[44:47], v[156:159], v[196:199], v[44:47]
    v_mfma_f32_16x16x32_bf16 a[144:147], v[160:163], v[196:199], a[144:147]
    v_exp_f32 v178, v178
    v_mfma_f32_16x16x32_bf16 a[148:151], v[164:167], v[196:199], a[148:151]
    buffer_load_dwordx4 v240, s[28:31], 0 offen offset:2048 nt lds
    v_mfma_f32_16x16x32_bf16 a[152:155], v[168:171], v[196:199], a[152:155]
    v_exp_f32 v179, v179
    v_mfma_f32_16x16x32_bf16 a[156:159], v[172:175], v[196:199], a[156:159]
    v_cvt_pk_bf16_f32 v192, v176, v177
    v_cvt_pk_bf16_f32 v193, v178, v179
    v_mfma_f32_16x16x32_bf16 a[232:235], a[252:255], v[196:199], a[232:235]
    v_exp_f32 v180, v180
    v_mfma_f32_16x16x32_bf16 v[184:187], v[112:115], a[64:67], v[216:219]
    v_mfma_f32_16x16x32_bf16 v[184:187], v[116:119], a[68:71], v[184:187]
    v_exp_f32 v181, v181
    v_mfma_f32_16x16x32_bf16 v[184:187], v[120:123], a[72:75], v[184:187]
    v_mfma_f32_16x16x32_bf16 v[184:187], v[124:127], a[76:79], v[184:187]
    v_exp_f32 v182, v182
    v_mfma_f32_16x16x32_bf16 v[188:191], v[128:131], a[64:67], v[216:219]
    v_add_u32 v238, 98304, v238
    v_add_u32 v239, 98304, v239
    v_mfma_f32_16x16x32_bf16 v[188:191], v[132:135], a[68:71], v[188:191]
    v_exp_f32 v183, v183
    v_mfma_f32_16x16x32_bf16 v[188:191], v[136:139], a[72:75], v[188:191]
    v_cvt_pk_bf16_f32 v194, v180, v181
    v_cvt_pk_bf16_f32 v195, v182, v183
    v_mfma_f32_16x16x32_bf16 v[188:191], v[140:143], a[76:79], v[188:191]
    v_mfma_f32_16x16x32_bf16 v[48:51], v[144:147], v[192:195], v[48:51]
    v_exp_f32 v184, v184
    v_mfma_f32_16x16x32_bf16 v[52:55], v[148:151], v[192:195], v[52:55]
    v_add_u32 v228, 98304, v228
    v_add_u32 v229, 98304, v229
    v_mfma_f32_16x16x32_bf16 v[56:59], v[152:155], v[192:195], v[56:59]
    v_exp_f32 v185, v185
    v_mfma_f32_16x16x32_bf16 v[60:63], v[156:159], v[192:195], v[60:63]
    v_mfma_f32_16x16x32_bf16 a[160:163], v[160:163], v[192:195], a[160:163]
    v_exp_f32 v186, v186
    v_mfma_f32_16x16x32_bf16 a[164:167], v[164:167], v[192:195], a[164:167]
    buffer_load_dwordx4 v241, s[28:31], 0 offen offset:3072 nt lds
    v_mfma_f32_16x16x32_bf16 a[168:171], v[168:171], v[192:195], a[168:171]
    v_exp_f32 v187, v187
    v_mfma_f32_16x16x32_bf16 a[172:175], v[172:175], v[192:195], a[172:175]
    v_cvt_pk_bf16_f32 v196, v184, v185
    v_cvt_pk_bf16_f32 v197, v186, v187
    v_mfma_f32_16x16x32_bf16 a[236:239], a[252:255], v[192:195], a[236:239]
    v_exp_f32 v188, v188
    v_mfma_f32_16x16x32_bf16 v[176:179], v[112:115], a[80:83], v[220:223]
    v_mfma_f32_16x16x32_bf16 v[176:179], v[116:119], a[84:87], v[176:179]
    v_exp_f32 v189, v189
    v_mfma_f32_16x16x32_bf16 v[176:179], v[120:123], a[88:91], v[176:179]
    v_add_u32 v240, 16384, v240
    v_add_u32 v241, 16384, v241
    v_mfma_f32_16x16x32_bf16 v[176:179], v[124:127], a[92:95], v[176:179]
    v_exp_f32 v190, v190
    v_mfma_f32_16x16x32_bf16 v[180:183], v[128:131], a[80:83], v[220:223]
    v_add_u32 v230, 98304, v230
    v_add_u32 v231, 98304, v231
    v_mfma_f32_16x16x32_bf16 v[180:183], v[132:135], a[84:87], v[180:183]
    v_exp_f32 v191, v191
    v_mfma_f32_16x16x32_bf16 v[180:183], v[136:139], a[88:91], v[180:183]
    v_cvt_pk_bf16_f32 v198, v188, v189
    v_cvt_pk_bf16_f32 v199, v190, v191
    v_mfma_f32_16x16x32_bf16 v[180:183], v[140:143], a[92:95], v[180:183]
    v_mfma_f32_16x16x32_bf16 v[64:67], v[144:147], v[196:199], v[64:67]
    v_exp_f32 v176, v176
    v_mfma_f32_16x16x32_bf16 v[68:71], v[148:151], v[196:199], v[68:71]
    v_mfma_f32_16x16x32_bf16 v[72:75], v[152:155], v[196:199], v[72:75]
    v_exp_f32 v177, v177
    v_mfma_f32_16x16x32_bf16 v[76:79], v[156:159], v[196:199], v[76:79]
    v_mfma_f32_16x16x32_bf16 a[176:179], v[160:163], v[196:199], a[176:179]
    v_exp_f32 v178, v178
    v_mfma_f32_16x16x32_bf16 a[180:183], v[164:167], v[196:199], a[180:183]
    s_waitcnt vmcnt(16)
    s_barrier
    v_mfma_f32_16x16x32_bf16 a[184:187], v[168:171], v[196:199], a[184:187]
    v_exp_f32 v179, v179
    v_mfma_f32_16x16x32_bf16 a[188:191], v[172:175], v[196:199], a[188:191]
    v_cvt_pk_bf16_f32 v192, v176, v177
    v_cvt_pk_bf16_f32 v193, v178, v179
    v_mfma_f32_16x16x32_bf16 a[240:243], a[252:255], v[196:199], a[240:243]
    v_exp_f32 v180, v180
    v_mfma_f32_16x16x32_bf16 v[184:187], v[112:115], a[96:99], v[224:227]
    ds_read_b128 v[112:115], v228
    v_mfma_f32_16x16x32_bf16 v[184:187], v[116:119], a[100:103], v[184:187]
    v_exp_f32 v181, v181
    v_mfma_f32_16x16x32_bf16 v[184:187], v[120:123], a[104:107], v[184:187]
    ds_read_b128 v[116:119], v229
    ds_read_b128 v[120:123], v230
    v_mfma_f32_16x16x32_bf16 v[184:187], v[124:127], a[108:111], v[184:187]
    v_exp_f32 v182, v182
    v_mfma_f32_16x16x32_bf16 v[188:191], v[128:131], a[96:99], v[224:227]
    ds_read_b128 v[124:127], v231
    ds_read_b128 v[128:131], v228 offset:4096
    v_mfma_f32_16x16x32_bf16 v[188:191], v[132:135], a[100:103], v[188:191]
    v_exp_f32 v183, v183
    v_mfma_f32_16x16x32_bf16 v[188:191], v[136:139], a[104:107], v[188:191]
    v_cvt_pk_bf16_f32 v194, v180, v181
    v_cvt_pk_bf16_f32 v195, v182, v183
    v_mfma_f32_16x16x32_bf16 v[188:191], v[140:143], a[108:111], v[188:191]
    ds_read_b128 v[132:135], v229 offset:4096
    ds_read_b128 v[136:139], v230 offset:4096
    v_mfma_f32_16x16x32_bf16 v[80:83], v[144:147], v[192:195], v[80:83]
    v_exp_f32 v184, v184
    v_mfma_f32_16x16x32_bf16 v[84:87], v[148:151], v[192:195], v[84:87]
    ds_read_b128 v[140:143], v231 offset:4096
    s_add_u32 m0, s44, 49152
    v_mfma_f32_16x16x32_bf16 v[88:91], v[152:155], v[192:195], v[88:91]
    v_exp_f32 v185, v185
    v_mfma_f32_16x16x32_bf16 v[92:95], v[156:159], v[192:195], v[92:95]
    buffer_load_dwordx4 v240, s[24:27], 0 offen nt lds
    v_mfma_f32_16x16x32_bf16 a[192:195], v[160:163], v[192:195], a[192:195]
    v_exp_f32 v186, v186
    v_mfma_f32_16x16x32_bf16 a[196:199], v[164:167], v[192:195], a[196:199]
    s_waitcnt lgkmcnt(4)
    buffer_load_dwordx4 v241, s[24:27], 0 offen offset:1024 nt lds
    v_mfma_f32_16x16x32_bf16 a[200:203], v[168:171], v[192:195], a[200:203]
    v_exp_f32 v187, v187
    v_mfma_f32_16x16x32_bf16 a[204:207], v[172:175], v[192:195], a[204:207]
    v_cvt_pk_bf16_f32 v196, v184, v185
    v_cvt_pk_bf16_f32 v197, v186, v187
    v_mfma_f32_16x16x32_bf16 a[244:247], a[252:255], v[192:195], a[244:247]
    v_exp_f32 v188, v188
    v_mfma_f32_16x16x32_bf16 v[176:179], v[112:115], a[0:3], v[200:203]
    buffer_load_dwordx4 v240, s[24:27], 0 offen offset:2048 nt lds
    v_mfma_f32_16x16x32_bf16 v[176:179], v[116:119], a[4:7], v[176:179]
    v_exp_f32 v189, v189
    v_mfma_f32_16x16x32_bf16 v[176:179], v[120:123], a[8:11], v[176:179]
    s_waitcnt lgkmcnt(0)
    v_mfma_f32_16x16x32_bf16 v[176:179], v[124:127], a[12:15], v[176:179]
    v_exp_f32 v190, v190
    v_mfma_f32_16x16x32_bf16 v[180:183], v[128:131], a[0:3], v[200:203]
    buffer_load_dwordx4 v241, s[24:27], 0 offen offset:3072 nt lds
    v_mfma_f32_16x16x32_bf16 v[180:183], v[132:135], a[4:7], v[180:183]
    v_exp_f32 v191, v191
    v_mfma_f32_16x16x32_bf16 v[180:183], v[136:139], a[8:11], v[180:183]
    v_cvt_pk_bf16_f32 v198, v188, v189
    v_cvt_pk_bf16_f32 v199, v190, v191
    v_mfma_f32_16x16x32_bf16 v[180:183], v[140:143], a[12:15], v[180:183]
    v_mfma_f32_16x16x32_bf16 v[96:99], v[144:147], v[196:199], v[96:99]
    v_exp_f32 v176, v176
    v_mfma_f32_16x16x32_bf16 v[100:103], v[148:151], v[196:199], v[100:103]
    ds_read_b64_tr_b16 v[144:145], v232
    ds_read_b64_tr_b16 v[146:147], v232 offset:4096
    v_mfma_f32_16x16x32_bf16 v[104:107], v[152:155], v[196:199], v[104:107]
    v_exp_f32 v177, v177
    v_mfma_f32_16x16x32_bf16 v[108:111], v[156:159], v[196:199], v[108:111]
    ds_read_b64_tr_b16 v[148:149], v233
    ds_read_b64_tr_b16 v[150:151], v233 offset:4096
    v_mfma_f32_16x16x32_bf16 a[208:211], v[160:163], v[196:199], a[208:211]
    v_exp_f32 v178, v178
    v_mfma_f32_16x16x32_bf16 a[212:215], v[164:167], v[196:199], a[212:215]
    ds_read_b64_tr_b16 v[152:153], v234
    ds_read_b64_tr_b16 v[154:155], v234 offset:4096
    v_mfma_f32_16x16x32_bf16 a[216:219], v[168:171], v[196:199], a[216:219]
    v_exp_f32 v179, v179
    v_mfma_f32_16x16x32_bf16 a[220:223], v[172:175], v[196:199], a[220:223]
    v_cvt_pk_bf16_f32 v192, v176, v177
    v_cvt_pk_bf16_f32 v193, v178, v179
    v_mfma_f32_16x16x32_bf16 a[248:251], a[252:255], v[196:199], a[248:251]
    v_exp_f32 v180, v180
    v_mfma_f32_16x16x32_bf16 v[184:187], v[112:115], a[16:19], v[204:207]
    ds_read_b64_tr_b16 v[156:157], v235
    ds_read_b64_tr_b16 v[158:159], v235 offset:4096
    v_mfma_f32_16x16x32_bf16 v[184:187], v[116:119], a[20:23], v[184:187]
    v_exp_f32 v181, v181
    v_mfma_f32_16x16x32_bf16 v[184:187], v[120:123], a[24:27], v[184:187]
    ds_read_b64_tr_b16 v[160:161], v236
    ds_read_b64_tr_b16 v[162:163], v236 offset:4096
    v_mfma_f32_16x16x32_bf16 v[184:187], v[124:127], a[28:31], v[184:187]
    v_exp_f32 v182, v182
    v_mfma_f32_16x16x32_bf16 v[188:191], v[128:131], a[16:19], v[204:207]
    ds_read_b64_tr_b16 v[164:165], v237
    ds_read_b64_tr_b16 v[166:167], v237 offset:4096
    v_mfma_f32_16x16x32_bf16 v[188:191], v[132:135], a[20:23], v[188:191]
    v_exp_f32 v183, v183
    v_mfma_f32_16x16x32_bf16 v[188:191], v[136:139], a[24:27], v[188:191]
    v_cvt_pk_bf16_f32 v194, v180, v181
    v_cvt_pk_bf16_f32 v195, v182, v183
    v_mfma_f32_16x16x32_bf16 v[188:191], v[140:143], a[28:31], v[188:191]
    ds_read_b64_tr_b16 v[168:169], v238
    ds_read_b64_tr_b16 v[170:171], v238 offset:4096
    s_mov_b32 s47, 2
A_LOOP:
    s_waitcnt lgkmcnt(6)
    v_mfma_f32_16x16x32_bf16 v[0:3], v[144:147], v[192:195], v[0:3]
    v_exp_f32 v184, v184
    v_mfma_f32_16x16x32_bf16 v[4:7], v[148:151], v[192:195], v[4:7]
    ds_read_b64_tr_b16 v[172:173], v239
    ds_read_b64_tr_b16 v[174:175], v239 offset:4096
    v_mfma_f32_16x16x32_bf16 v[8:11], v[152:155], v[192:195], v[8:11]
    v_exp_f32 v185, v185
    v_mfma_f32_16x16x32_bf16 v[12:15], v[156:159], v[192:195], v[12:15]
    s_waitcnt lgkmcnt(4)
    v_mfma_f32_16x16x32_bf16 a[112:115], v[160:163], v[192:195], a[112:115]
    v_exp_f32 v186, v186
    v_mfma_f32_16x16x32_bf16 a[116:119], v[164:167], v[192:195], a[116:119]
    s_waitcnt lgkmcnt(0)
    v_mfma_f32_16x16x32_bf16 a[120:123], v[168:171], v[192:195], a[120:123]
    v_exp_f32 v187, v187
    v_mfma_f32_16x16x32_bf16 a[124:127], v[172:175], v[192:195], a[124:127]
    v_cvt_pk_bf16_f32 v196, v184, v185
    v_cvt_pk_bf16_f32 v197, v186, v187
    v_mfma_f32_16x16x32_bf16 a[224:227], a[252:255], v[192:195], a[224:227]
    v_exp_f32 v188, v188
    v_mfma_f32_16x16x32_bf16 v[176:179], v[112:115], a[32:35], v[208:211]
    s_add_u32 m0, s44, 32768
    v_mfma_f32_16x16x32_bf16 v[176:179], v[116:119], a[36:39], v[176:179]
    v_exp_f32 v189, v189
    v_mfma_f32_16x16x32_bf16 v[176:179], v[120:123], a[40:43], v[176:179]
    v_mfma_f32_16x16x32_bf16 v[176:179], v[124:127], a[44:47], v[176:179]
    v_exp_f32 v190, v190
    v_mfma_f32_16x16x32_bf16 v[180:183], v[128:131], a[32:35], v[208:211]
    buffer_load_dwordx4 v240, s[28:31], 0 offen nt lds
    v_mfma_f32_16x16x32_bf16 v[180:183], v[132:135], a[36:39], v[180:183]
    v_exp_f32 v191, v191
    v_mfma_f32_16x16x32_bf16 v[180:183], v[136:139], a[40:43], v[180:183]
    v_cvt_pk_bf16_f32 v198, v188, v189
    v_cvt_pk_bf16_f32 v199, v190, v191
    v_mfma_f32_16x16x32_bf16 v[180:183], v[140:143], a[44:47], v[180:183]
    v_mfma_f32_16x16x32_bf16 v[16:19], v[144:147], v[196:199], v[16:19]
    v_exp_f32 v176, v176
    v_mfma_f32_16x16x32_bf16 v[20:23], v[148:151], v[196:199], v[20:23]
    v_mfma_f32_16x16x32_bf16 v[24:27], v[152:155], v[196:199], v[24:27]
    v_exp_f32 v177, v177
    v_mfma_f32_16x16x32_bf16 v[28:31], v[156:159], v[196:199], v[28:31]
    v_mfma_f32_16x16x32_bf16 a[128:131], v[160:163], v[196:199], a[128:131]
    v_exp_f32 v178, v178
    v_mfma_f32_16x16x32_bf16 a[132:135], v[164:167], v[196:199], a[132:135]
    buffer_load_dwordx4 v241, s[28:31], 0 offen offset:1024 nt lds
    v_mfma_f32_16x16x32_bf16 a[136:139], v[168:171], v[196:199], a[136:139]
    v_exp_f32 v179, v179
    v_mfma_f32_16x16x32_bf16 a[140:143], v[172:175], v[196:199], a[140:143]
    v_cvt_pk_bf16_f32 v192, v176, v177
    v_cvt_pk_bf16_f32 v193, v178, v179
    v_mfma_f32_16x16x32_bf16 a[228:231], a[252:255], v[196:199], a[228:231]
    v_exp_f32 v180, v180
    v_mfma_f32_16x16x32_bf16 v[184:187], v[112:115], a[48:51], v[212:215]
    v_add_u32 v232, 4294934528, v232
    v_add_u32 v233, 4294934528, v233
    v_mfma_f32_16x16x32_bf16 v[184:187], v[116:119], a[52:55], v[184:187]
    v_exp_f32 v181, v181
    v_mfma_f32_16x16x32_bf16 v[184:187], v[120:123], a[56:59], v[184:187]
    v_mfma_f32_16x16x32_bf16 v[184:187], v[124:127], a[60:63], v[184:187]
    v_exp_f32 v182, v182
    v_mfma_f32_16x16x32_bf16 v[188:191], v[128:131], a[48:51], v[212:215]
    v_add_u32 v234, 4294934528, v234
    v_add_u32 v235, 4294934528, v235
    v_mfma_f32_16x16x32_bf16 v[188:191], v[132:135], a[52:55], v[188:191]
    v_exp_f32 v183, v183
    v_mfma_f32_16x16x32_bf16 v[188:191], v[136:139], a[56:59], v[188:191]
    v_cvt_pk_bf16_f32 v194, v180, v181
    v_cvt_pk_bf16_f32 v195, v182, v183
    v_mfma_f32_16x16x32_bf16 v[188:191], v[140:143], a[60:63], v[188:191]
    v_mfma_f32_16x16x32_bf16 v[32:35], v[144:147], v[192:195], v[32:35]
    v_exp_f32 v184, v184
    v_mfma_f32_16x16x32_bf16 v[36:39], v[148:151], v[192:195], v[36:39]
    v_add_u32 v236, 4294934528, v236
    v_add_u32 v237, 4294934528, v237
    v_mfma_f32_16x16x32_bf16 v[40:43], v[152:155], v[192:195], v[40:43]
    v_exp_f32 v185, v185
    v_mfma_f32_16x16x32_bf16 v[44:47], v[156:159], v[192:195], v[44:47]
    v_mfma_f32_16x16x32_bf16 a[144:147], v[160:163], v[192:195], a[144:147]
    v_exp_f32 v186, v186
    v_mfma_f32_16x16x32_bf16 a[148:151], v[164:167], v[192:195], a[148:151]
    buffer_load_dwordx4 v240, s[28:31], 0 offen offset:2048 nt lds
    v_mfma_f32_16x16x32_bf16 a[152:155], v[168:171], v[192:195], a[152:155]
    v_exp_f32 v187, v187
    v_mfma_f32_16x16x32_bf16 a[156:159], v[172:175], v[192:195], a[156:159]
    v_cvt_pk_bf16_f32 v196, v184, v185
    v_cvt_pk_bf16_f32 v197, v186, v187
    v_mfma_f32_16x16x32_bf16 a[232:235], a[252:255], v[192:195], a[232:235]
    v_exp_f32 v188, v188
    v_mfma_f32_16x16x32_bf16 v[176:179], v[112:115], a[64:67], v[216:219]
    v_mfma_f32_16x16x32_bf16 v[176:179], v[116:119], a[68:71], v[176:179]
    v_exp_f32 v189, v189
    v_mfma_f32_16x16x32_bf16 v[176:179], v[120:123], a[72:75], v[176:179]
    v_mfma_f32_16x16x32_bf16 v[176:179], v[124:127], a[76:79], v[176:179]
    v_exp_f32 v190, v190
    v_mfma_f32_16x16x32_bf16 v[180:183], v[128:131], a[64:67], v[216:219]
    v_add_u32 v238, 4294934528, v238
    v_add_u32 v239, 4294934528, v239
    v_mfma_f32_16x16x32_bf16 v[180:183], v[132:135], a[68:71], v[180:183]
    v_exp_f32 v191, v191
    v_mfma_f32_16x16x32_bf16 v[180:183], v[136:139], a[72:75], v[180:183]
    v_cvt_pk_bf16_f32 v198, v188, v189
    v_cvt_pk_bf16_f32 v199, v190, v191
    v_mfma_f32_16x16x32_bf16 v[180:183], v[140:143], a[76:79], v[180:183]
    v_mfma_f32_16x16x32_bf16 v[48:51], v[144:147], v[196:199], v[48:51]
    v_exp_f32 v176, v176
    v_mfma_f32_16x16x32_bf16 v[52:55], v[148:151], v[196:199], v[52:55]
    v_add_u32 v228, 4294934528, v228
    v_add_u32 v229, 4294934528, v229
    v_mfma_f32_16x16x32_bf16 v[56:59], v[152:155], v[196:199], v[56:59]
    v_exp_f32 v177, v177
    v_mfma_f32_16x16x32_bf16 v[60:63], v[156:159], v[196:199], v[60:63]
    v_mfma_f32_16x16x32_bf16 a[160:163], v[160:163], v[196:199], a[160:163]
    v_exp_f32 v178, v178
    v_mfma_f32_16x16x32_bf16 a[164:167], v[164:167], v[196:199], a[164:167]
    buffer_load_dwordx4 v241, s[28:31], 0 offen offset:3072 nt lds
    v_mfma_f32_16x16x32_bf16 a[168:171], v[168:171], v[196:199], a[168:171]
    v_exp_f32 v179, v179
    v_mfma_f32_16x16x32_bf16 a[172:175], v[172:175], v[196:199], a[172:175]
    v_cvt_pk_bf16_f32 v192, v176, v177
    v_cvt_pk_bf16_f32 v193, v178, v179
    v_mfma_f32_16x16x32_bf16 a[236:239], a[252:255], v[196:199], a[236:239]
    v_exp_f32 v180, v180
    v_mfma_f32_16x16x32_bf16 v[184:187], v[112:115], a[80:83], v[220:223]
    v_mfma_f32_16x16x32_bf16 v[184:187], v[116:119], a[84:87], v[184:187]
    v_exp_f32 v181, v181
    v_mfma_f32_16x16x32_bf16 v[184:187], v[120:123], a[88:91], v[184:187]
    v_add_u32 v240, 16384, v240
    v_add_u32 v241, 16384, v241
    v_mfma_f32_16x16x32_bf16 v[184:187], v[124:127], a[92:95], v[184:187]
    v_exp_f32 v182, v182
    v_mfma_f32_16x16x32_bf16 v[188:191], v[128:131], a[80:83], v[220:223]
    v_add_u32 v230, 4294934528, v230
    v_add_u32 v231, 4294934528, v231
    v_mfma_f32_16x16x32_bf16 v[188:191], v[132:135], a[84:87], v[188:191]
    v_exp_f32 v183, v183
    v_mfma_f32_16x16x32_bf16 v[188:191], v[136:139], a[88:91], v[188:191]
    v_cvt_pk_bf16_f32 v194, v180, v181
    v_cvt_pk_bf16_f32 v195, v182, v183
    v_mfma_f32_16x16x32_bf16 v[188:191], v[140:143], a[92:95], v[188:191]
    v_mfma_f32_16x16x32_bf16 v[64:67], v[144:147], v[192:195], v[64:67]
    v_exp_f32 v184, v184
    v_mfma_f32_16x16x32_bf16 v[68:71], v[148:151], v[192:195], v[68:71]
    v_mfma_f32_16x16x32_bf16 v[72:75], v[152:155], v[192:195], v[72:75]
    v_exp_f32 v185, v185
    v_mfma_f32_16x16x32_bf16 v[76:79], v[156:159], v[192:195], v[76:79]
    v_mfma_f32_16x16x32_bf16 a[176:179], v[160:163], v[192:195], a[176:179]
    v_exp_f32 v186, v186
    v_mfma_f32_16x16x32_bf16 a[180:183], v[164:167], v[192:195], a[180:183]
    s_waitcnt vmcnt(16)
    s_barrier
    v_mfma_f32_16x16x32_bf16 a[184:187], v[168:171], v[192:195], a[184:187]
    v_exp_f32 v187, v187
    v_mfma_f32_16x16x32_bf16 a[188:191], v[172:175], v[192:195], a[188:191]
    v_cvt_pk_bf16_f32 v196, v184, v185
    v_cvt_pk_bf16_f32 v197, v186, v187
    v_mfma_f32_16x16x32_bf16 a[240:243], a[252:255], v[192:195], a[240:243]
    v_exp_f32 v188, v188
    v_mfma_f32_16x16x32_bf16 v[176:179], v[112:115], a[96:99], v[224:227]
    ds_read_b128 v[112:115], v228
    v_mfma_f32_16x16x32_bf16 v[176:179], v[116:119], a[100:103], v[176:179]
    v_exp_f32 v189, v189
    v_mfma_f32_16x16x32_bf16 v[176:179], v[120:123], a[104:107], v[176:179]
    ds_read_b128 v[116:119], v229
    ds_read_b128 v[120:123], v230
    v_mfma_f32_16x16x32_bf16 v[176:179], v[124:127], a[108:111], v[176:179]
    v_exp_f32 v190, v190
    v_mfma_f32_16x16x32_bf16 v[180:183], v[128:131], a[96:99], v[224:227]
    ds_read_b128 v[124:127], v231
    ds_read_b128 v[128:131], v228 offset:4096
    v_mfma_f32_16x16x32_bf16 v[180:183], v[132:135], a[100:103], v[180:183]
    v_exp_f32 v191, v191
    v_mfma_f32_16x16x32_bf16 v[180:183], v[136:139], a[104:107], v[180:183]
    v_cvt_pk_bf16_f32 v198, v188, v189
    v_cvt_pk_bf16_f32 v199, v190, v191
    v_mfma_f32_16x16x32_bf16 v[180:183], v[140:143], a[108:111], v[180:183]
    ds_read_b128 v[132:135], v229 offset:4096
    ds_read_b128 v[136:139], v230 offset:4096
    v_mfma_f32_16x16x32_bf16 v[80:83], v[144:147], v[196:199], v[80:83]
    v_exp_f32 v176, v176
    v_mfma_f32_16x16x32_bf16 v[84:87], v[148:151], v[196:199], v[84:87]
    ds_read_b128 v[140:143], v231 offset:4096
    s_add_u32 m0, s44, 147456
    v_mfma_f32_16x16x32_bf16 v[88:91], v[152:155], v[196:199], v[88:91]
    v_exp_f32 v177, v177
    v_mfma_f32_16x16x32_bf16 v[92:95], v[156:159], v[196:199], v[92:95]
    buffer_load_dwordx4 v240, s[24:27], 0 offen nt lds
    v_mfma_f32_16x16x32_bf16 a[192:195], v[160:163], v[196:199], a[192:195]
    v_exp_f32 v178, v178
    v_mfma_f32_16x16x32_bf16 a[196:199], v[164:167], v[196:199], a[196:199]
    s_waitcnt lgkmcnt(4)
    buffer_load_dwordx4 v241, s[24:27], 0 offen offset:1024 nt lds
    v_mfma_f32_16x16x32_bf16 a[200:203], v[168:171], v[196:199], a[200:203]
    v_exp_f32 v179, v179
    v_mfma_f32_16x16x32_bf16 a[204:207], v[172:175], v[196:199], a[204:207]
    v_cvt_pk_bf16_f32 v192, v176, v177
    v_cvt_pk_bf16_f32 v193, v178, v179
    v_mfma_f32_16x16x32_bf16 a[244:247], a[252:255], v[196:199], a[244:247]
    v_exp_f32 v180, v180
    v_mfma_f32_16x16x32_bf16 v[184:187], v[112:115], a[0:3], v[200:203]
    buffer_load_dwordx4 v240, s[24:27], 0 offen offset:2048 nt lds
    v_mfma_f32_16x16x32_bf16 v[184:187], v[116:119], a[4:7], v[184:187]
    v_exp_f32 v181, v181
    v_mfma_f32_16x16x32_bf16 v[184:187], v[120:123], a[8:11], v[184:187]
    s_waitcnt lgkmcnt(0)
    v_mfma_f32_16x16x32_bf16 v[184:187], v[124:127], a[12:15], v[184:187]
    v_exp_f32 v182, v182
    v_mfma_f32_16x16x32_bf16 v[188:191], v[128:131], a[0:3], v[200:203]
    buffer_load_dwordx4 v241, s[24:27], 0 offen offset:3072 nt lds
    v_mfma_f32_16x16x32_bf16 v[188:191], v[132:135], a[4:7], v[188:191]
    v_exp_f32 v183, v183
    v_mfma_f32_16x16x32_bf16 v[188:191], v[136:139], a[8:11], v[188:191]
    v_cvt_pk_bf16_f32 v194, v180, v181
    v_cvt_pk_bf16_f32 v195, v182, v183
    v_mfma_f32_16x16x32_bf16 v[188:191], v[140:143], a[12:15], v[188:191]
    v_mfma_f32_16x16x32_bf16 v[96:99], v[144:147], v[192:195], v[96:99]
    v_exp_f32 v184, v184
    v_mfma_f32_16x16x32_bf16 v[100:103], v[148:151], v[192:195], v[100:103]
    ds_read_b64_tr_b16 v[144:145], v232
    ds_read_b64_tr_b16 v[146:147], v232 offset:4096
    v_mfma_f32_16x16x32_bf16 v[104:107], v[152:155], v[192:195], v[104:107]
    v_exp_f32 v185, v185
    v_mfma_f32_16x16x32_bf16 v[108:111], v[156:159], v[192:195], v[108:111]
    ds_read_b64_tr_b16 v[148:149], v233
    ds_read_b64_tr_b16 v[150:151], v233 offset:4096
    v_mfma_f32_16x16x32_bf16 a[208:211], v[160:163], v[192:195], a[208:211]
    v_exp_f32 v186, v186
    v_mfma_f32_16x16x32_bf16 a[212:215], v[164:167], v[192:195], a[212:215]
    ds_read_b64_tr_b16 v[152:153], v234
    ds_read_b64_tr_b16 v[154:155], v234 offset:4096
    v_mfma_f32_16x16x32_bf16 a[216:219], v[168:171], v[192:195], a[216:219]
    v_exp_f32 v187, v187
    v_mfma_f32_16x16x32_bf16 a[220:223], v[172:175], v[192:195], a[220:223]
    v_cvt_pk_bf16_f32 v196, v184, v185
    v_cvt_pk_bf16_f32 v197, v186, v187
    v_mfma_f32_16x16x32_bf16 a[248:251], a[252:255], v[192:195], a[248:251]
    v_exp_f32 v188, v188
    v_mfma_f32_16x16x32_bf16 v[176:179], v[112:115], a[16:19], v[204:207]
    ds_read_b64_tr_b16 v[156:157], v235
    ds_read_b64_tr_b16 v[158:159], v235 offset:4096
    v_mfma_f32_16x16x32_bf16 v[176:179], v[116:119], a[20:23], v[176:179]
    v_exp_f32 v189, v189
    v_mfma_f32_16x16x32_bf16 v[176:179], v[120:123], a[24:27], v[176:179]
    ds_read_b64_tr_b16 v[160:161], v236
    ds_read_b64_tr_b16 v[162:163], v236 offset:4096
    v_mfma_f32_16x16x32_bf16 v[176:179], v[124:127], a[28:31], v[176:179]
    v_exp_f32 v190, v190
    v_mfma_f32_16x16x32_bf16 v[180:183], v[128:131], a[16:19], v[204:207]
    ds_read_b64_tr_b16 v[164:165], v237
    ds_read_b64_tr_b16 v[166:167], v237 offset:4096
    v_mfma_f32_16x16x32_bf16 v[180:183], v[132:135], a[20:23], v[180:183]
    v_exp_f32 v191, v191
    v_mfma_f32_16x16x32_bf16 v[180:183], v[136:139], a[24:27], v[180:183]
    v_cvt_pk_bf16_f32 v198, v188, v189
    v_cvt_pk_bf16_f32 v199, v190, v191
    v_mfma_f32_16x16x32_bf16 v[180:183], v[140:143], a[28:31], v[180:183]
    ds_read_b64_tr_b16 v[168:169], v238
    ds_read_b64_tr_b16 v[170:171], v238 offset:4096
    s_waitcnt lgkmcnt(6)
    v_mfma_f32_16x16x32_bf16 v[0:3], v[144:147], v[196:199], v[0:3]
    v_exp_f32 v176, v176
    v_mfma_f32_16x16x32_bf16 v[4:7], v[148:151], v[196:199], v[4:7]
    ds_read_b64_tr_b16 v[172:173], v239
    ds_read_b64_tr_b16 v[174:175], v239 offset:4096
    v_mfma_f32_16x16x32_bf16 v[8:11], v[152:155], v[196:199], v[8:11]
    v_exp_f32 v177, v177
    v_mfma_f32_16x16x32_bf16 v[12:15], v[156:159], v[196:199], v[12:15]
    s_waitcnt lgkmcnt(4)
    v_mfma_f32_16x16x32_bf16 a[112:115], v[160:163], v[196:199], a[112:115]
    v_exp_f32 v178, v178
    v_mfma_f32_16x16x32_bf16 a[116:119], v[164:167], v[196:199], a[116:119]
    s_waitcnt lgkmcnt(0)
    v_mfma_f32_16x16x32_bf16 a[120:123], v[168:171], v[196:199], a[120:123]
    v_exp_f32 v179, v179
    v_mfma_f32_16x16x32_bf16 a[124:127], v[172:175], v[196:199], a[124:127]
    v_cvt_pk_bf16_f32 v192, v176, v177
    v_cvt_pk_bf16_f32 v193, v178, v179
    v_mfma_f32_16x16x32_bf16 a[224:227], a[252:255], v[196:199], a[224:227]
    v_exp_f32 v180, v180
    v_mfma_f32_16x16x32_bf16 v[184:187], v[112:115], a[32:35], v[208:211]
    s_add_u32 m0, s44, 131072
    v_mfma_f32_16x16x32_bf16 v[184:187], v[116:119], a[36:39], v[184:187]
    v_exp_f32 v181, v181
    v_mfma_f32_16x16x32_bf16 v[184:187], v[120:123], a[40:43], v[184:187]
    v_mfma_f32_16x16x32_bf16 v[184:187], v[124:127], a[44:47], v[184:187]
    v_exp_f32 v182, v182
    v_mfma_f32_16x16x32_bf16 v[188:191], v[128:131], a[32:35], v[208:211]
    buffer_load_dwordx4 v240, s[28:31], 0 offen nt lds
    v_mfma_f32_16x16x32_bf16 v[188:191], v[132:135], a[36:39], v[188:191]
    v_exp_f32 v183, v183
    v_mfma_f32_16x16x32_bf16 v[188:191], v[136:139], a[40:43], v[188:191]
    v_cvt_pk_bf16_f32 v194, v180, v181
    v_cvt_pk_bf16_f32 v195, v182, v183
    v_mfma_f32_16x16x32_bf16 v[188:191], v[140:143], a[44:47], v[188:191]
    v_mfma_f32_16x16x32_bf16 v[16:19], v[144:147], v[192:195], v[16:19]
    v_exp_f32 v184, v184
    v_mfma_f32_16x16x32_bf16 v[20:23], v[148:151], v[192:195], v[20:23]
    v_mfma_f32_16x16x32_bf16 v[24:27], v[152:155], v[192:195], v[24:27]
    v_exp_f32 v185, v185
    v_mfma_f32_16x16x32_bf16 v[28:31], v[156:159], v[192:195], v[28:31]
    v_mfma_f32_16x16x32_bf16 a[128:131], v[160:163], v[192:195], a[128:131]
    v_exp_f32 v186, v186
    v_mfma_f32_16x16x32_bf16 a[132:135], v[164:167], v[192:195], a[132:135]
    buffer_load_dwordx4 v241, s[28:31], 0 offen offset:1024 nt lds
    v_mfma_f32_16x16x32_bf16 a[136:139], v[168:171], v[192:195], a[136:139]
    v_exp_f32 v187, v187
    v_mfma_f32_16x16x32_bf16 a[140:143], v[172:175], v[192:195], a[140:143]
    v_cvt_pk_bf16_f32 v196, v184, v185
    v_cvt_pk_bf16_f32 v197, v186, v187
    v_mfma_f32_16x16x32_bf16 a[228:231], a[252:255], v[192:195], a[228:231]
    v_exp_f32 v188, v188
    v_mfma_f32_16x16x32_bf16 v[176:179], v[112:115], a[48:51], v[212:215]
    v_add_u32 v232, 4294934528, v232
    v_add_u32 v233, 4294934528, v233
    v_mfma_f32_16x16x32_bf16 v[176:179], v[116:119], a[52:55], v[176:179]
    v_exp_f32 v189, v189
    v_mfma_f32_16x16x32_bf16 v[176:179], v[120:123], a[56:59], v[176:179]
    v_mfma_f32_16x16x32_bf16 v[176:179], v[124:127], a[60:63], v[176:179]
    v_exp_f32 v190, v190
    v_mfma_f32_16x16x32_bf16 v[180:183], v[128:131], a[48:51], v[212:215]
    v_add_u32 v234, 4294934528, v234
    v_add_u32 v235, 4294934528, v235
    v_mfma_f32_16x16x32_bf16 v[180:183], v[132:135], a[52:55], v[180:183]
    v_exp_f32 v191, v191
    v_mfma_f32_16x16x32_bf16 v[180:183], v[136:139], a[56:59], v[180:183]
    v_cvt_pk_bf16_f32 v198, v188, v189
    v_cvt_pk_bf16_f32 v199, v190, v191
    v_mfma_f32_16x16x32_bf16 v[180:183], v[140:143], a[60:63], v[180:183]
    v_mfma_f32_16x16x32_bf16 v[32:35], v[144:147], v[196:199], v[32:35]
    v_exp_f32 v176, v176
    v_mfma_f32_16x16x32_bf16 v[36:39], v[148:151], v[196:199], v[36:39]
    v_add_u32 v236, 4294934528, v236
    v_add_u32 v237, 4294934528, v237
    v_mfma_f32_16x16x32_bf16 v[40:43], v[152:155], v[196:199], v[40:43]
    v_exp_f32 v177, v177
    v_mfma_f32_16x16x32_bf16 v[44:47], v[156:159], v[196:199], v[44:47]
    v_mfma_f32_16x16x32_bf16 a[144:147], v[160:163], v[196:199], a[144:147]
    v_exp_f32 v178, v178
    v_mfma_f32_16x16x32_bf16 a[148:151], v[164:167], v[196:199], a[148:151]
    buffer_load_dwordx4 v240, s[28:31], 0 offen offset:2048 nt lds
    v_mfma_f32_16x16x32_bf16 a[152:155], v[168:171], v[196:199], a[152:155]
    v_exp_f32 v179, v179
    v_mfma_f32_16x16x32_bf16 a[156:159], v[172:175], v[196:199], a[156:159]
    v_cvt_pk_bf16_f32 v192, v176, v177
    v_cvt_pk_bf16_f32 v193, v178, v179
    v_mfma_f32_16x16x32_bf16 a[232:235], a[252:255], v[196:199], a[232:235]
    v_exp_f32 v180, v180
    v_mfma_f32_16x16x32_bf16 v[184:187], v[112:115], a[64:67], v[216:219]
    v_mfma_f32_16x16x32_bf16 v[184:187], v[116:119], a[68:71], v[184:187]
    v_exp_f32 v181, v181
    v_mfma_f32_16x16x32_bf16 v[184:187], v[120:123], a[72:75], v[184:187]
    v_mfma_f32_16x16x32_bf16 v[184:187], v[124:127], a[76:79], v[184:187]
    v_exp_f32 v182, v182
    v_mfma_f32_16x16x32_bf16 v[188:191], v[128:131], a[64:67], v[216:219]
    v_add_u32 v238, 4294934528, v238
    v_add_u32 v239, 4294934528, v239
    v_mfma_f32_16x16x32_bf16 v[188:191], v[132:135], a[68:71], v[188:191]
    v_exp_f32 v183, v183
    v_mfma_f32_16x16x32_bf16 v[188:191], v[136:139], a[72:75], v[188:191]
    v_cvt_pk_bf16_f32 v194, v180, v181
    v_cvt_pk_bf16_f32 v195, v182, v183
    v_mfma_f32_16x16x32_bf16 v[188:191], v[140:143], a[76:79], v[188:191]
    v_mfma_f32_16x16x32_bf16 v[48:51], v[144:147], v[192:195], v[48:51]
    v_exp_f32 v184, v184
    v_mfma_f32_16x16x32_bf16 v[52:55], v[148:151], v[192:195], v[52:55]
    v_add_u32 v228, 4294934528, v228
    v_add_u32 v229, 4294934528, v229
    v_mfma_f32_16x16x32_bf16 v[56:59], v[152:155], v[192:195], v[56:59]
    v_exp_f32 v185, v185
    v_mfma_f32_16x16x32_bf16 v[60:63], v[156:159], v[192:195], v[60:63]
    v_mfma_f32_16x16x32_bf16 a[160:163], v[160:163], v[192:195], a[160:163]
    v_exp_f32 v186, v186
    v_mfma_f32_16x16x32_bf16 a[164:167], v[164:167], v[192:195], a[164:167]
    buffer_load_dwordx4 v241, s[28:31], 0 offen offset:3072 nt lds
    v_mfma_f32_16x16x32_bf16 a[168:171], v[168:171], v[192:195], a[168:171]
    v_exp_f32 v187, v187
    v_mfma_f32_16x16x32_bf16 a[172:175], v[172:175], v[192:195], a[172:175]
    v_cvt_pk_bf16_f32 v196, v184, v185
    v_cvt_pk_bf16_f32 v197, v186, v187
    v_mfma_f32_16x16x32_bf16 a[236:239], a[252:255], v[192:195], a[236:239]
    v_exp_f32 v188, v188
    v_mfma_f32_16x16x32_bf16 v[176:179], v[112:115], a[80:83], v[220:223]
    v_mfma_f32_16x16x32_bf16 v[176:179], v[116:119], a[84:87], v[176:179]
    v_exp_f32 v189, v189
    v_mfma_f32_16x16x32_bf16 v[176:179], v[120:123], a[88:91], v[176:179]
    v_add_u32 v240, 16384, v240
    v_add_u32 v241, 16384, v241
    v_mfma_f32_16x16x32_bf16 v[176:179], v[124:127], a[92:95], v[176:179]
    v_exp_f32 v190, v190
    v_mfma_f32_16x16x32_bf16 v[180:183], v[128:131], a[80:83], v[220:223]
    v_add_u32 v230, 4294934528, v230
    v_add_u32 v231, 4294934528, v231
    v_mfma_f32_16x16x32_bf16 v[180:183], v[132:135], a[84:87], v[180:183]
    v_exp_f32 v191, v191
    v_mfma_f32_16x16x32_bf16 v[180:183], v[136:139], a[88:91], v[180:183]
    v_cvt_pk_bf16_f32 v198, v188, v189
    v_cvt_pk_bf16_f32 v199, v190, v191
    v_mfma_f32_16x16x32_bf16 v[180:183], v[140:143], a[92:95], v[180:183]
    v_mfma_f32_16x16x32_bf16 v[64:67], v[144:147], v[196:199], v[64:67]
    v_exp_f32 v176, v176
    v_mfma_f32_16x16x32_bf16 v[68:71], v[148:151], v[196:199], v[68:71]
    v_mfma_f32_16x16x32_bf16 v[72:75], v[152:155], v[196:199], v[72:75]
    v_exp_f32 v177, v177
    v_mfma_f32_16x16x32_bf16 v[76:79], v[156:159], v[196:199], v[76:79]
    v_mfma_f32_16x16x32_bf16 a[176:179], v[160:163], v[196:199], a[176:179]
    v_exp_f32 v178, v178
    v_mfma_f32_16x16x32_bf16 a[180:183], v[164:167], v[196:199], a[180:183]
    s_waitcnt vmcnt(16)
    s_barrier
    v_mfma_f32_16x16x32_bf16 a[184:187], v[168:171], v[196:199], a[184:187]
    v_exp_f32 v179, v179
    v_mfma_f32_16x16x32_bf16 a[188:191], v[172:175], v[196:199], a[188:191]
    v_cvt_pk_bf16_f32 v192, v176, v177
    v_cvt_pk_bf16_f32 v193, v178, v179
    v_mfma_f32_16x16x32_bf16 a[240:243], a[252:255], v[196:199], a[240:243]
    v_exp_f32 v180, v180
    v_mfma_f32_16x16x32_bf16 v[184:187], v[112:115], a[96:99], v[224:227]
    ds_read_b128 v[112:115], v228
    v_mfma_f32_16x16x32_bf16 v[184:187], v[116:119], a[100:103], v[184:187]
    v_exp_f32 v181, v181
    v_mfma_f32_16x16x32_bf16 v[184:187], v[120:123], a[104:107], v[184:187]
    ds_read_b128 v[116:119], v229
    ds_read_b128 v[120:123], v230
    v_mfma_f32_16x16x32_bf16 v[184:187], v[124:127], a[108:111], v[184:187]
    v_exp_f32 v182, v182
    v_mfma_f32_16x16x32_bf16 v[188:191], v[128:131], a[96:99], v[224:227]
    ds_read_b128 v[124:127], v231
    ds_read_b128 v[128:131], v228 offset:4096
    v_mfma_f32_16x16x32_bf16 v[188:191], v[132:135], a[100:103], v[188:191]
    v_exp_f32 v183, v183
    v_mfma_f32_16x16x32_bf16 v[188:191], v[136:139], a[104:107], v[188:191]
    v_cvt_pk_bf16_f32 v194, v180, v181
    v_cvt_pk_bf16_f32 v195, v182, v183
    v_mfma_f32_16x16x32_bf16 v[188:191], v[140:143], a[108:111], v[188:191]
    ds_read_b128 v[132:135], v229 offset:4096
    ds_read_b128 v[136:139], v230 offset:4096
    v_mfma_f32_16x16x32_bf16 v[80:83], v[144:147], v[192:195], v[80:83]
    v_exp_f32 v184, v184
    v_mfma_f32_16x16x32_bf16 v[84:87], v[148:151], v[192:195], v[84:87]
    ds_read_b128 v[140:143], v231 offset:4096
    s_add_u32 m0, s44, 114688
    v_mfma_f32_16x16x32_bf16 v[88:91], v[152:155], v[192:195], v[88:91]
    v_exp_f32 v185, v185
    v_mfma_f32_16x16x32_bf16 v[92:95], v[156:159], v[192:195], v[92:95]
    buffer_load_dwordx4 v240, s[24:27], 0 offen nt lds
    v_mfma_f32_16x16x32_bf16 a[192:195], v[160:163], v[192:195], a[192:195]
    v_exp_f32 v186, v186
    v_mfma_f32_16x16x32_bf16 a[196:199], v[164:167], v[192:195], a[196:199]
    s_waitcnt lgkmcnt(4)
    buffer_load_dwordx4 v241, s[24:27], 0 offen offset:1024 nt lds
    v_mfma_f32_16x16x32_bf16 a[200:203], v[168:171], v[192:195], a[200:203]
    v_exp_f32 v187, v187
    v_mfma_f32_16x16x32_bf16 a[204:207], v[172:175], v[192:195], a[204:207]
    v_cvt_pk_bf16_f32 v196, v184, v185
    v_cvt_pk_bf16_f32 v197, v186, v187
    v_mfma_f32_16x16x32_bf16 a[244:247], a[252:255], v[192:195], a[244:247]
    v_exp_f32 v188, v188
    v_mfma_f32_16x16x32_bf16 v[176:179], v[112:115], a[0:3], v[200:203]
    buffer_load_dwordx4 v240, s[24:27], 0 offen offset:2048 nt lds
    v_mfma_f32_16x16x32_bf16 v[176:179], v[116:119], a[4:7], v[176:179]
    v_exp_f32 v189, v189
    v_mfma_f32_16x16x32_bf16 v[176:179], v[120:123], a[8:11], v[176:179]
    s_waitcnt lgkmcnt(0)
    v_mfma_f32_16x16x32_bf16 v[176:179], v[124:127], a[12:15], v[176:179]
    v_exp_f32 v190, v190
    v_mfma_f32_16x16x32_bf16 v[180:183], v[128:131], a[0:3], v[200:203]
    buffer_load_dwordx4 v241, s[24:27], 0 offen offset:3072 nt lds
    v_mfma_f32_16x16x32_bf16 v[180:183], v[132:135], a[4:7], v[180:183]
    v_exp_f32 v191, v191
    v_mfma_f32_16x16x32_bf16 v[180:183], v[136:139], a[8:11], v[180:183]
    v_cvt_pk_bf16_f32 v198, v188, v189
    v_cvt_pk_bf16_f32 v199, v190, v191
    v_mfma_f32_16x16x32_bf16 v[180:183], v[140:143], a[12:15], v[180:183]
    v_mfma_f32_16x16x32_bf16 v[96:99], v[144:147], v[196:199], v[96:99]
    v_exp_f32 v176, v176
    v_mfma_f32_16x16x32_bf16 v[100:103], v[148:151], v[196:199], v[100:103]
    ds_read_b64_tr_b16 v[144:145], v232
    ds_read_b64_tr_b16 v[146:147], v232 offset:4096
    v_mfma_f32_16x16x32_bf16 v[104:107], v[152:155], v[196:199], v[104:107]
    v_exp_f32 v177, v177
    v_mfma_f32_16x16x32_bf16 v[108:111], v[156:159], v[196:199], v[108:111]
    ds_read_b64_tr_b16 v[148:149], v233
    ds_read_b64_tr_b16 v[150:151], v233 offset:4096
    v_mfma_f32_16x16x32_bf16 a[208:211], v[160:163], v[196:199], a[208:211]
    v_exp_f32 v178, v178
    v_mfma_f32_16x16x32_bf16 a[212:215], v[164:167], v[196:199], a[212:215]
    ds_read_b64_tr_b16 v[152:153], v234
    ds_read_b64_tr_b16 v[154:155], v234 offset:4096
    v_mfma_f32_16x16x32_bf16 a[216:219], v[168:171], v[196:199], a[216:219]
    v_exp_f32 v179, v179
    v_mfma_f32_16x16x32_bf16 a[220:223], v[172:175], v[196:199], a[220:223]
    v_cvt_pk_bf16_f32 v192, v176, v177
    v_cvt_pk_bf16_f32 v193, v178, v179
    v_mfma_f32_16x16x32_bf16 a[248:251], a[252:255], v[196:199], a[248:251]
    v_exp_f32 v180, v180
    v_mfma_f32_16x16x32_bf16 v[184:187], v[112:115], a[16:19], v[204:207]
    ds_read_b64_tr_b16 v[156:157], v235
    ds_read_b64_tr_b16 v[158:159], v235 offset:4096
    v_mfma_f32_16x16x32_bf16 v[184:187], v[116:119], a[20:23], v[184:187]
    v_exp_f32 v181, v181
    v_mfma_f32_16x16x32_bf16 v[184:187], v[120:123], a[24:27], v[184:187]
    ds_read_b64_tr_b16 v[160:161], v236
    ds_read_b64_tr_b16 v[162:163], v236 offset:4096
    v_mfma_f32_16x16x32_bf16 v[184:187], v[124:127], a[28:31], v[184:187]
    v_exp_f32 v182, v182
    v_mfma_f32_16x16x32_bf16 v[188:191], v[128:131], a[16:19], v[204:207]
    ds_read_b64_tr_b16 v[164:165], v237
    ds_read_b64_tr_b16 v[166:167], v237 offset:4096
    v_mfma_f32_16x16x32_bf16 v[188:191], v[132:135], a[20:23], v[188:191]
    v_exp_f32 v183, v183
    v_mfma_f32_16x16x32_bf16 v[188:191], v[136:139], a[24:27], v[188:191]
    v_cvt_pk_bf16_f32 v194, v180, v181
    v_cvt_pk_bf16_f32 v195, v182, v183
    v_mfma_f32_16x16x32_bf16 v[188:191], v[140:143], a[28:31], v[188:191]
    ds_read_b64_tr_b16 v[168:169], v238
    ds_read_b64_tr_b16 v[170:171], v238 offset:4096
    s_waitcnt lgkmcnt(6)
    v_mfma_f32_16x16x32_bf16 v[0:3], v[144:147], v[192:195], v[0:3]
    v_exp_f32 v184, v184
    v_mfma_f32_16x16x32_bf16 v[4:7], v[148:151], v[192:195], v[4:7]
    ds_read_b64_tr_b16 v[172:173], v239
    ds_read_b64_tr_b16 v[174:175], v239 offset:4096
    v_mfma_f32_16x16x32_bf16 v[8:11], v[152:155], v[192:195], v[8:11]
    v_exp_f32 v185, v185
    v_mfma_f32_16x16x32_bf16 v[12:15], v[156:159], v[192:195], v[12:15]
    s_waitcnt lgkmcnt(4)
    v_mfma_f32_16x16x32_bf16 a[112:115], v[160:163], v[192:195], a[112:115]
    v_exp_f32 v186, v186
    v_mfma_f32_16x16x32_bf16 a[116:119], v[164:167], v[192:195], a[116:119]
    s_waitcnt lgkmcnt(0)
    v_mfma_f32_16x16x32_bf16 a[120:123], v[168:171], v[192:195], a[120:123]
    v_exp_f32 v187, v187
    v_mfma_f32_16x16x32_bf16 a[124:127], v[172:175], v[192:195], a[124:127]
    v_cvt_pk_bf16_f32 v196, v184, v185
    v_cvt_pk_bf16_f32 v197, v186, v187
    v_mfma_f32_16x16x32_bf16 a[224:227], a[252:255], v[192:195], a[224:227]
    v_exp_f32 v188, v188
    v_mfma_f32_16x16x32_bf16 v[176:179], v[112:115], a[32:35], v[208:211]
    s_add_u32 m0, s44, 98304
    v_mfma_f32_16x16x32_bf16 v[176:179], v[116:119], a[36:39], v[176:179]
    v_exp_f32 v189, v189
    v_mfma_f32_16x16x32_bf16 v[176:179], v[120:123], a[40:43], v[176:179]
    v_mfma_f32_16x16x32_bf16 v[176:179], v[124:127], a[44:47], v[176:179]
    v_exp_f32 v190, v190
    v_mfma_f32_16x16x32_bf16 v[180:183], v[128:131], a[32:35], v[208:211]
    buffer_load_dwordx4 v240, s[28:31], 0 offen nt lds
    v_mfma_f32_16x16x32_bf16 v[180:183], v[132:135], a[36:39], v[180:183]
    v_exp_f32 v191, v191
    v_mfma_f32_16x16x32_bf16 v[180:183], v[136:139], a[40:43], v[180:183]
    v_cvt_pk_bf16_f32 v198, v188, v189
    v_cvt_pk_bf16_f32 v199, v190, v191
    v_mfma_f32_16x16x32_bf16 v[180:183], v[140:143], a[44:47], v[180:183]
    v_mfma_f32_16x16x32_bf16 v[16:19], v[144:147], v[196:199], v[16:19]
    v_exp_f32 v176, v176
    v_mfma_f32_16x16x32_bf16 v[20:23], v[148:151], v[196:199], v[20:23]
    v_mfma_f32_16x16x32_bf16 v[24:27], v[152:155], v[196:199], v[24:27]
    v_exp_f32 v177, v177
    v_mfma_f32_16x16x32_bf16 v[28:31], v[156:159], v[196:199], v[28:31]
    v_mfma_f32_16x16x32_bf16 a[128:131], v[160:163], v[196:199], a[128:131]
    v_exp_f32 v178, v178
    v_mfma_f32_16x16x32_bf16 a[132:135], v[164:167], v[196:199], a[132:135]
    buffer_load_dwordx4 v241, s[28:31], 0 offen offset:1024 nt lds
    v_mfma_f32_16x16x32_bf16 a[136:139], v[168:171], v[196:199], a[136:139]
    v_exp_f32 v179, v179
    v_mfma_f32_16x16x32_bf16 a[140:143], v[172:175], v[196:199], a[140:143]
    v_cvt_pk_bf16_f32 v192, v176, v177
    v_cvt_pk_bf16_f32 v193, v178, v179
    v_mfma_f32_16x16x32_bf16 a[228:231], a[252:255], v[196:199], a[228:231]
    v_exp_f32 v180, v180
    v_mfma_f32_16x16x32_bf16 v[184:187], v[112:115], a[48:51], v[212:215]
    v_add_u32 v232, 4294934528, v232
    v_add_u32 v233, 4294934528, v233
    v_mfma_f32_16x16x32_bf16 v[184:187], v[116:119], a[52:55], v[184:187]
    v_exp_f32 v181, v181
    v_mfma_f32_16x16x32_bf16 v[184:187], v[120:123], a[56:59], v[184:187]
    v_mfma_f32_16x16x32_bf16 v[184:187], v[124:127], a[60:63], v[184:187]
    v_exp_f32 v182, v182
    v_mfma_f32_16x16x32_bf16 v[188:191], v[128:131], a[48:51], v[212:215]
    v_add_u32 v234, 4294934528, v234
    v_add_u32 v235, 4294934528, v235
    v_mfma_f32_16x16x32_bf16 v[188:191], v[132:135], a[52:55], v[188:191]
    v_exp_f32 v183, v183
    v_mfma_f32_16x16x32_bf16 v[188:191], v[136:139], a[56:59], v[188:191]
    v_cvt_pk_bf16_f32 v194, v180, v181
    v_cvt_pk_bf16_f32 v195, v182, v183
    v_mfma_f32_16x16x32_bf16 v[188:191], v[140:143], a[60:63], v[188:191]
    v_mfma_f32_16x16x32_bf16 v[32:35], v[144:147], v[192:195], v[32:35]
    v_exp_f32 v184, v184
    v_mfma_f32_16x16x32_bf16 v[36:39], v[148:151], v[192:195], v[36:39]
    v_add_u32 v236, 4294934528, v236
    v_add_u32 v237, 4294934528, v237
    v_mfma_f32_16x16x32_bf16 v[40:43], v[152:155], v[192:195], v[40:43]
    v_exp_f32 v185, v185
    v_mfma_f32_16x16x32_bf16 v[44:47], v[156:159], v[192:195], v[44:47]
    v_mfma_f32_16x16x32_bf16 a[144:147], v[160:163], v[192:195], a[144:147]
    v_exp_f32 v186, v186
    v_mfma_f32_16x16x32_bf16 a[148:151], v[164:167], v[192:195], a[148:151]
    buffer_load_dwordx4 v240, s[28:31], 0 offen offset:2048 nt lds
    v_mfma_f32_16x16x32_bf16 a[152:155], v[168:171], v[192:195], a[152:155]
    v_exp_f32 v187, v187
    v_mfma_f32_16x16x32_bf16 a[156:159], v[172:175], v[192:195], a[156:159]
    v_cvt_pk_bf16_f32 v196, v184, v185
    v_cvt_pk_bf16_f32 v197, v186, v187
    v_mfma_f32_16x16x32_bf16 a[232:235], a[252:255], v[192:195], a[232:235]
    v_exp_f32 v188, v188
    v_mfma_f32_16x16x32_bf16 v[176:179], v[112:115], a[64:67], v[216:219]
    v_mfma_f32_16x16x32_bf16 v[176:179], v[116:119], a[68:71], v[176:179]
    v_exp_f32 v189, v189
    v_mfma_f32_16x16x32_bf16 v[176:179], v[120:123], a[72:75], v[176:179]
    v_mfma_f32_16x16x32_bf16 v[176:179], v[124:127], a[76:79], v[176:179]
    v_exp_f32 v190, v190
    v_mfma_f32_16x16x32_bf16 v[180:183], v[128:131], a[64:67], v[216:219]
    v_add_u32 v238, 4294934528, v238
    v_add_u32 v239, 4294934528, v239
    v_mfma_f32_16x16x32_bf16 v[180:183], v[132:135], a[68:71], v[180:183]
    v_exp_f32 v191, v191
    v_mfma_f32_16x16x32_bf16 v[180:183], v[136:139], a[72:75], v[180:183]
    v_cvt_pk_bf16_f32 v198, v188, v189
    v_cvt_pk_bf16_f32 v199, v190, v191
    v_mfma_f32_16x16x32_bf16 v[180:183], v[140:143], a[76:79], v[180:183]
    v_mfma_f32_16x16x32_bf16 v[48:51], v[144:147], v[196:199], v[48:51]
    v_exp_f32 v176, v176
    v_mfma_f32_16x16x32_bf16 v[52:55], v[148:151], v[196:199], v[52:55]
    v_add_u32 v228, 4294934528, v228
    v_add_u32 v229, 4294934528, v229
    v_mfma_f32_16x16x32_bf16 v[56:59], v[152:155], v[196:199], v[56:59]
    v_exp_f32 v177, v177
    v_mfma_f32_16x16x32_bf16 v[60:63], v[156:159], v[196:199], v[60:63]
    v_mfma_f32_16x16x32_bf16 a[160:163], v[160:163], v[196:199], a[160:163]
    v_exp_f32 v178, v178
    v_mfma_f32_16x16x32_bf16 a[164:167], v[164:167], v[196:199], a[164:167]
    buffer_load_dwordx4 v241, s[28:31], 0 offen offset:3072 nt lds
    v_mfma_f32_16x16x32_bf16 a[168:171], v[168:171], v[196:199], a[168:171]
    v_exp_f32 v179, v179
    v_mfma_f32_16x16x32_bf16 a[172:175], v[172:175], v[196:199], a[172:175]
    v_cvt_pk_bf16_f32 v192, v176, v177
    v_cvt_pk_bf16_f32 v193, v178, v179
    v_mfma_f32_16x16x32_bf16 a[236:239], a[252:255], v[196:199], a[236:239]
    v_exp_f32 v180, v180
    v_mfma_f32_16x16x32_bf16 v[184:187], v[112:115], a[80:83], v[220:223]
    v_mfma_f32_16x16x32_bf16 v[184:187], v[116:119], a[84:87], v[184:187]
    v_exp_f32 v181, v181
    v_mfma_f32_16x16x32_bf16 v[184:187], v[120:123], a[88:91], v[184:187]
    v_add_u32 v240, 16384, v240
    v_add_u32 v241, 16384, v241
    v_mfma_f32_16x16x32_bf16 v[184:187], v[124:127], a[92:95], v[184:187]
    v_exp_f32 v182, v182
    v_mfma_f32_16x16x32_bf16 v[188:191], v[128:131], a[80:83], v[220:223]
    v_add_u32 v230, 4294934528, v230
    v_add_u32 v231, 4294934528, v231
    v_mfma_f32_16x16x32_bf16 v[188:191], v[132:135], a[84:87], v[188:191]
    v_exp_f32 v183, v183
    v_mfma_f32_16x16x32_bf16 v[188:191], v[136:139], a[88:91], v[188:191]
    v_cvt_pk_bf16_f32 v194, v180, v181
    v_cvt_pk_bf16_f32 v195, v182, v183
    v_mfma_f32_16x16x32_bf16 v[188:191], v[140:143], a[92:95], v[188:191]
    v_mfma_f32_16x16x32_bf16 v[64:67], v[144:147], v[192:195], v[64:67]
    v_exp_f32 v184, v184
    v_mfma_f32_16x16x32_bf16 v[68:71], v[148:151], v[192:195], v[68:71]
    v_mfma_f32_16x16x32_bf16 v[72:75], v[152:155], v[192:195], v[72:75]
    v_exp_f32 v185, v185
    v_mfma_f32_16x16x32_bf16 v[76:79], v[156:159], v[192:195], v[76:79]
    v_mfma_f32_16x16x32_bf16 a[176:179], v[160:163], v[192:195], a[176:179]
    v_exp_f32 v186, v186
    v_mfma_f32_16x16x32_bf16 a[180:183], v[164:167], v[192:195], a[180:183]
    s_waitcnt vmcnt(16)
    s_barrier
    v_mfma_f32_16x16x32_bf16 a[184:187], v[168:171], v[192:195], a[184:187]
    v_exp_f32 v187, v187
    v_mfma_f32_16x16x32_bf16 a[188:191], v[172:175], v[192:195], a[188:191]
    v_cvt_pk_bf16_f32 v196, v184, v185
    v_cvt_pk_bf16_f32 v197, v186, v187
    v_mfma_f32_16x16x32_bf16 a[240:243], a[252:255], v[192:195], a[240:243]
    v_exp_f32 v188, v188
    v_mfma_f32_16x16x32_bf16 v[176:179], v[112:115], a[96:99], v[224:227]
    ds_read_b128 v[112:115], v228
    v_mfma_f32_16x16x32_bf16 v[176:179], v[116:119], a[100:103], v[176:179]
    v_exp_f32 v189, v189
    v_mfma_f32_16x16x32_bf16 v[176:179], v[120:123], a[104:107], v[176:179]
    ds_read_b128 v[116:119], v229
    ds_read_b128 v[120:123], v230
    v_mfma_f32_16x16x32_bf16 v[176:179], v[124:127], a[108:111], v[176:179]
    v_exp_f32 v190, v190
    v_mfma_f32_16x16x32_bf16 v[180:183], v[128:131], a[96:99], v[224:227]
    ds_read_b128 v[124:127], v231
    ds_read_b128 v[128:131], v228 offset:4096
    v_mfma_f32_16x16x32_bf16 v[180:183], v[132:135], a[100:103], v[180:183]
    v_exp_f32 v191, v191
    v_mfma_f32_16x16x32_bf16 v[180:183], v[136:139], a[104:107], v[180:183]
    v_cvt_pk_bf16_f32 v198, v188, v189
    v_cvt_pk_bf16_f32 v199, v190, v191
    v_mfma_f32_16x16x32_bf16 v[180:183], v[140:143], a[108:111], v[180:183]
    ds_read_b128 v[132:135], v229 offset:4096
    ds_read_b128 v[136:139], v230 offset:4096
    v_mfma_f32_16x16x32_bf16 v[80:83], v[144:147], v[196:199], v[80:83]
    v_exp_f32 v176, v176
    v_mfma_f32_16x16x32_bf16 v[84:87], v[148:151], v[196:199], v[84:87]
    ds_read_b128 v[140:143], v231 offset:4096
    s_add_u32 m0, s44, 81920
    v_mfma_f32_16x16x32_bf16 v[88:91], v[152:155], v[196:199], v[88:91]
    v_exp_f32 v177, v177
    v_mfma_f32_16x16x32_bf16 v[92:95], v[156:159], v[196:199], v[92:95]
    buffer_load_dwordx4 v240, s[24:27], 0 offen nt lds
    v_mfma_f32_16x16x32_bf16 a[192:195], v[160:163], v[196:199], a[192:195]
    v_exp_f32 v178, v178
    v_mfma_f32_16x16x32_bf16 a[196:199], v[164:167], v[196:199], a[196:199]
    s_waitcnt lgkmcnt(4)
    buffer_load_dwordx4 v241, s[24:27], 0 offen offset:1024 nt lds
    v_mfma_f32_16x16x32_bf16 a[200:203], v[168:171], v[196:199], a[200:203]
    v_exp_f32 v179, v179
    v_mfma_f32_16x16x32_bf16 a[204:207], v[172:175], v[196:199], a[204:207]
    v_cvt_pk_bf16_f32 v192, v176, v177
    v_cvt_pk_bf16_f32 v193, v178, v179
    v_mfma_f32_16x16x32_bf16 a[244:247], a[252:255], v[196:199], a[244:247]
    v_exp_f32 v180, v180
    v_mfma_f32_16x16x32_bf16 v[184:187], v[112:115], a[0:3], v[200:203]
    buffer_load_dwordx4 v240, s[24:27], 0 offen offset:2048 nt lds
    v_mfma_f32_16x16x32_bf16 v[184:187], v[116:119], a[4:7], v[184:187]
    v_exp_f32 v181, v181
    v_mfma_f32_16x16x32_bf16 v[184:187], v[120:123], a[8:11], v[184:187]
    s_waitcnt lgkmcnt(0)
    v_mfma_f32_16x16x32_bf16 v[184:187], v[124:127], a[12:15], v[184:187]
    v_exp_f32 v182, v182
    v_mfma_f32_16x16x32_bf16 v[188:191], v[128:131], a[0:3], v[200:203]
    buffer_load_dwordx4 v241, s[24:27], 0 offen offset:3072 nt lds
    v_mfma_f32_16x16x32_bf16 v[188:191], v[132:135], a[4:7], v[188:191]
    v_exp_f32 v183, v183
    v_mfma_f32_16x16x32_bf16 v[188:191], v[136:139], a[8:11], v[188:191]
    v_cvt_pk_bf16_f32 v194, v180, v181
    v_cvt_pk_bf16_f32 v195, v182, v183
    v_mfma_f32_16x16x32_bf16 v[188:191], v[140:143], a[12:15], v[188:191]
    v_mfma_f32_16x16x32_bf16 v[96:99], v[144:147], v[192:195], v[96:99]
    v_exp_f32 v184, v184
    v_mfma_f32_16x16x32_bf16 v[100:103], v[148:151], v[192:195], v[100:103]
    ds_read_b64_tr_b16 v[144:145], v232
    ds_read_b64_tr_b16 v[146:147], v232 offset:4096
    v_mfma_f32_16x16x32_bf16 v[104:107], v[152:155], v[192:195], v[104:107]
    v_exp_f32 v185, v185
    v_mfma_f32_16x16x32_bf16 v[108:111], v[156:159], v[192:195], v[108:111]
    ds_read_b64_tr_b16 v[148:149], v233
    ds_read_b64_tr_b16 v[150:151], v233 offset:4096
    v_mfma_f32_16x16x32_bf16 a[208:211], v[160:163], v[192:195], a[208:211]
    v_exp_f32 v186, v186
    v_mfma_f32_16x16x32_bf16 a[212:215], v[164:167], v[192:195], a[212:215]
    ds_read_b64_tr_b16 v[152:153], v234
    ds_read_b64_tr_b16 v[154:155], v234 offset:4096
    v_mfma_f32_16x16x32_bf16 a[216:219], v[168:171], v[192:195], a[216:219]
    v_exp_f32 v187, v187
    v_mfma_f32_16x16x32_bf16 a[220:223], v[172:175], v[192:195], a[220:223]
    v_cvt_pk_bf16_f32 v196, v184, v185
    v_cvt_pk_bf16_f32 v197, v186, v187
    v_mfma_f32_16x16x32_bf16 a[248:251], a[252:255], v[192:195], a[248:251]
    v_exp_f32 v188, v188
    v_mfma_f32_16x16x32_bf16 v[176:179], v[112:115], a[16:19], v[204:207]
    ds_read_b64_tr_b16 v[156:157], v235
    ds_read_b64_tr_b16 v[158:159], v235 offset:4096
    v_mfma_f32_16x16x32_bf16 v[176:179], v[116:119], a[20:23], v[176:179]
    v_exp_f32 v189, v189
    v_mfma_f32_16x16x32_bf16 v[176:179], v[120:123], a[24:27], v[176:179]
    ds_read_b64_tr_b16 v[160:161], v236
    ds_read_b64_tr_b16 v[162:163], v236 offset:4096
    v_mfma_f32_16x16x32_bf16 v[176:179], v[124:127], a[28:31], v[176:179]
    v_exp_f32 v190, v190
    v_mfma_f32_16x16x32_bf16 v[180:183], v[128:131], a[16:19], v[204:207]
    ds_read_b64_tr_b16 v[164:165], v237
    ds_read_b64_tr_b16 v[166:167], v237 offset:4096
    v_mfma_f32_16x16x32_bf16 v[180:183], v[132:135], a[20:23], v[180:183]
    v_exp_f32 v191, v191
    v_mfma_f32_16x16x32_bf16 v[180:183], v[136:139], a[24:27], v[180:183]
    v_cvt_pk_bf16_f32 v198, v188, v189
    v_cvt_pk_bf16_f32 v199, v190, v191
    v_mfma_f32_16x16x32_bf16 v[180:183], v[140:143], a[28:31], v[180:183]
    ds_read_b64_tr_b16 v[168:169], v238
    ds_read_b64_tr_b16 v[170:171], v238 offset:4096
    s_waitcnt lgkmcnt(6)
    v_mfma_f32_16x16x32_bf16 v[0:3], v[144:147], v[196:199], v[0:3]
    v_exp_f32 v176, v176
    v_mfma_f32_16x16x32_bf16 v[4:7], v[148:151], v[196:199], v[4:7]
    ds_read_b64_tr_b16 v[172:173], v239
    ds_read_b64_tr_b16 v[174:175], v239 offset:4096
    v_mfma_f32_16x16x32_bf16 v[8:11], v[152:155], v[196:199], v[8:11]
    v_exp_f32 v177, v177
    v_mfma_f32_16x16x32_bf16 v[12:15], v[156:159], v[196:199], v[12:15]
    s_waitcnt lgkmcnt(4)
    v_mfma_f32_16x16x32_bf16 a[112:115], v[160:163], v[196:199], a[112:115]
    v_exp_f32 v178, v178
    v_mfma_f32_16x16x32_bf16 a[116:119], v[164:167], v[196:199], a[116:119]
    s_waitcnt lgkmcnt(0)
    v_mfma_f32_16x16x32_bf16 a[120:123], v[168:171], v[196:199], a[120:123]
    v_exp_f32 v179, v179
    v_mfma_f32_16x16x32_bf16 a[124:127], v[172:175], v[196:199], a[124:127]
    v_cvt_pk_bf16_f32 v192, v176, v177
    v_cvt_pk_bf16_f32 v193, v178, v179
    v_mfma_f32_16x16x32_bf16 a[224:227], a[252:255], v[196:199], a[224:227]
    v_exp_f32 v180, v180
    v_mfma_f32_16x16x32_bf16 v[184:187], v[112:115], a[32:35], v[208:211]
    s_add_u32 m0, s44, 65536
    v_mfma_f32_16x16x32_bf16 v[184:187], v[116:119], a[36:39], v[184:187]
    v_exp_f32 v181, v181
    v_mfma_f32_16x16x32_bf16 v[184:187], v[120:123], a[40:43], v[184:187]
    v_mfma_f32_16x16x32_bf16 v[184:187], v[124:127], a[44:47], v[184:187]
    v_exp_f32 v182, v182
    v_mfma_f32_16x16x32_bf16 v[188:191], v[128:131], a[32:35], v[208:211]
    buffer_load_dwordx4 v240, s[28:31], 0 offen nt lds
    v_mfma_f32_16x16x32_bf16 v[188:191], v[132:135], a[36:39], v[188:191]
    v_exp_f32 v183, v183
    v_mfma_f32_16x16x32_bf16 v[188:191], v[136:139], a[40:43], v[188:191]
    v_cvt_pk_bf16_f32 v194, v180, v181
    v_cvt_pk_bf16_f32 v195, v182, v183
    v_mfma_f32_16x16x32_bf16 v[188:191], v[140:143], a[44:47], v[188:191]
    v_mfma_f32_16x16x32_bf16 v[16:19], v[144:147], v[192:195], v[16:19]
    v_exp_f32 v184, v184
    v_mfma_f32_16x16x32_bf16 v[20:23], v[148:151], v[192:195], v[20:23]
    v_mfma_f32_16x16x32_bf16 v[24:27], v[152:155], v[192:195], v[24:27]
    v_exp_f32 v185, v185
    v_mfma_f32_16x16x32_bf16 v[28:31], v[156:159], v[192:195], v[28:31]
    v_mfma_f32_16x16x32_bf16 a[128:131], v[160:163], v[192:195], a[128:131]
    v_exp_f32 v186, v186
    v_mfma_f32_16x16x32_bf16 a[132:135], v[164:167], v[192:195], a[132:135]
    buffer_load_dwordx4 v241, s[28:31], 0 offen offset:1024 nt lds
    v_mfma_f32_16x16x32_bf16 a[136:139], v[168:171], v[192:195], a[136:139]
    v_exp_f32 v187, v187
    v_mfma_f32_16x16x32_bf16 a[140:143], v[172:175], v[192:195], a[140:143]
    v_cvt_pk_bf16_f32 v196, v184, v185
    v_cvt_pk_bf16_f32 v197, v186, v187
    v_mfma_f32_16x16x32_bf16 a[228:231], a[252:255], v[192:195], a[228:231]
    v_exp_f32 v188, v188
    v_mfma_f32_16x16x32_bf16 v[176:179], v[112:115], a[48:51], v[212:215]
    v_add_u32 v232, 98304, v232
    v_add_u32 v233, 98304, v233
    v_mfma_f32_16x16x32_bf16 v[176:179], v[116:119], a[52:55], v[176:179]
    v_exp_f32 v189, v189
    v_mfma_f32_16x16x32_bf16 v[176:179], v[120:123], a[56:59], v[176:179]
    v_mfma_f32_16x16x32_bf16 v[176:179], v[124:127], a[60:63], v[176:179]
    v_exp_f32 v190, v190
    v_mfma_f32_16x16x32_bf16 v[180:183], v[128:131], a[48:51], v[212:215]
    v_add_u32 v234, 98304, v234
    v_add_u32 v235, 98304, v235
    v_mfma_f32_16x16x32_bf16 v[180:183], v[132:135], a[52:55], v[180:183]
    v_exp_f32 v191, v191
    v_mfma_f32_16x16x32_bf16 v[180:183], v[136:139], a[56:59], v[180:183]
    v_cvt_pk_bf16_f32 v198, v188, v189
    v_cvt_pk_bf16_f32 v199, v190, v191
    v_mfma_f32_16x16x32_bf16 v[180:183], v[140:143], a[60:63], v[180:183]
    v_mfma_f32_16x16x32_bf16 v[32:35], v[144:147], v[196:199], v[32:35]
    v_exp_f32 v176, v176
    v_mfma_f32_16x16x32_bf16 v[36:39], v[148:151], v[196:199], v[36:39]
    v_add_u32 v236, 98304, v236
    v_add_u32 v237, 98304, v237
    v_mfma_f32_16x16x32_bf16 v[40:43], v[152:155], v[196:199], v[40:43]
    v_exp_f32 v177, v177
    v_mfma_f32_16x16x32_bf16 v[44:47], v[156:159], v[196:199], v[44:47]
    v_mfma_f32_16x16x32_bf16 a[144:147], v[160:163], v[196:199], a[144:147]
    v_exp_f32 v178, v178
    v_mfma_f32_16x16x32_bf16 a[148:151], v[164:167], v[196:199], a[148:151]
    buffer_load_dwordx4 v240, s[28:31], 0 offen offset:2048 nt lds
    v_mfma_f32_16x16x32_bf16 a[152:155], v[168:171], v[196:199], a[152:155]
    v_exp_f32 v179, v179
    v_mfma_f32_16x16x32_bf16 a[156:159], v[172:175], v[196:199], a[156:159]
    v_cvt_pk_bf16_f32 v192, v176, v177
    v_cvt_pk_bf16_f32 v193, v178, v179
    v_mfma_f32_16x16x32_bf16 a[232:235], a[252:255], v[196:199], a[232:235]
    v_exp_f32 v180, v180
    v_mfma_f32_16x16x32_bf16 v[184:187], v[112:115], a[64:67], v[216:219]
    v_mfma_f32_16x16x32_bf16 v[184:187], v[116:119], a[68:71], v[184:187]
    v_exp_f32 v181, v181
    v_mfma_f32_16x16x32_bf16 v[184:187], v[120:123], a[72:75], v[184:187]
    v_mfma_f32_16x16x32_bf16 v[184:187], v[124:127], a[76:79], v[184:187]
    v_exp_f32 v182, v182
    v_mfma_f32_16x16x32_bf16 v[188:191], v[128:131], a[64:67], v[216:219]
    v_add_u32 v238, 98304, v238
    v_add_u32 v239, 98304, v239
    v_mfma_f32_16x16x32_bf16 v[188:191], v[132:135], a[68:71], v[188:191]
    v_exp_f32 v183, v183
    v_mfma_f32_16x16x32_bf16 v[188:191], v[136:139], a[72:75], v[188:191]
    v_cvt_pk_bf16_f32 v194, v180, v181
    v_cvt_pk_bf16_f32 v195, v182, v183
    v_mfma_f32_16x16x32_bf16 v[188:191], v[140:143], a[76:79], v[188:191]
    v_mfma_f32_16x16x32_bf16 v[48:51], v[144:147], v[192:195], v[48:51]
    v_exp_f32 v184, v184
    v_mfma_f32_16x16x32_bf16 v[52:55], v[148:151], v[192:195], v[52:55]
    v_add_u32 v228, 98304, v228
    v_add_u32 v229, 98304, v229
    v_mfma_f32_16x16x32_bf16 v[56:59], v[152:155], v[192:195], v[56:59]
    v_exp_f32 v185, v185
    v_mfma_f32_16x16x32_bf16 v[60:63], v[156:159], v[192:195], v[60:63]
    v_mfma_f32_16x16x32_bf16 a[160:163], v[160:163], v[192:195], a[160:163]
    v_exp_f32 v186, v186
    v_mfma_f32_16x16x32_bf16 a[164:167], v[164:167], v[192:195], a[164:167]
    buffer_load_dwordx4 v241, s[28:31], 0 offen offset:3072 nt lds
    v_mfma_f32_16x16x32_bf16 a[168:171], v[168:171], v[192:195], a[168:171]
    v_exp_f32 v187, v187
    v_mfma_f32_16x16x32_bf16 a[172:175], v[172:175], v[192:195], a[172:175]
    v_cvt_pk_bf16_f32 v196, v184, v185
    v_cvt_pk_bf16_f32 v197, v186, v187
    v_mfma_f32_16x16x32_bf16 a[236:239], a[252:255], v[192:195], a[236:239]
    v_exp_f32 v188, v188
    v_mfma_f32_16x16x32_bf16 v[176:179], v[112:115], a[80:83], v[220:223]
    v_mfma_f32_16x16x32_bf16 v[176:179], v[116:119], a[84:87], v[176:179]
    v_exp_f32 v189, v189
    v_mfma_f32_16x16x32_bf16 v[176:179], v[120:123], a[88:91], v[176:179]
    v_add_u32 v240, 16384, v240
    v_add_u32 v241, 16384, v241
    v_mfma_f32_16x16x32_bf16 v[176:179], v[124:127], a[92:95], v[176:179]
    v_exp_f32 v190, v190
    v_mfma_f32_16x16x32_bf16 v[180:183], v[128:131], a[80:83], v[220:223]
    v_add_u32 v230, 98304, v230
    v_add_u32 v231, 98304, v231
    v_mfma_f32_16x16x32_bf16 v[180:183], v[132:135], a[84:87], v[180:183]
    v_exp_f32 v191, v191
    v_mfma_f32_16x16x32_bf16 v[180:183], v[136:139], a[88:91], v[180:183]
    v_cvt_pk_bf16_f32 v198, v188, v189
    v_cvt_pk_bf16_f32 v199, v190, v191
    v_mfma_f32_16x16x32_bf16 v[180:183], v[140:143], a[92:95], v[180:183]
    v_mfma_f32_16x16x32_bf16 v[64:67], v[144:147], v[196:199], v[64:67]
    v_exp_f32 v176, v176
    v_mfma_f32_16x16x32_bf16 v[68:71], v[148:151], v[196:199], v[68:71]
    v_mfma_f32_16x16x32_bf16 v[72:75], v[152:155], v[196:199], v[72:75]
    v_exp_f32 v177, v177
    v_mfma_f32_16x16x32_bf16 v[76:79], v[156:159], v[196:199], v[76:79]
    v_mfma_f32_16x16x32_bf16 a[176:179], v[160:163], v[196:199], a[176:179]
    v_exp_f32 v178, v178
    v_mfma_f32_16x16x32_bf16 a[180:183], v[164:167], v[196:199], a[180:183]
    s_waitcnt vmcnt(16)
    s_barrier
    v_mfma_f32_16x16x32_bf16 a[184:187], v[168:171], v[196:199], a[184:187]
    v_exp_f32 v179, v179
    v_mfma_f32_16x16x32_bf16 a[188:191], v[172:175], v[196:199], a[188:191]
    v_cvt_pk_bf16_f32 v192, v176, v177
    v_cvt_pk_bf16_f32 v193, v178, v179
    v_mfma_f32_16x16x32_bf16 a[240:243], a[252:255], v[196:199], a[240:243]
    v_exp_f32 v180, v180
    v_mfma_f32_16x16x32_bf16 v[184:187], v[112:115], a[96:99], v[224:227]
    ds_read_b128 v[112:115], v228
    v_mfma_f32_16x16x32_bf16 v[184:187], v[116:119], a[100:103], v[184:187]
    v_exp_f32 v181, v181
    v_mfma_f32_16x16x32_bf16 v[184:187], v[120:123], a[104:107], v[184:187]
    ds_read_b128 v[116:119], v229
    ds_read_b128 v[120:123], v230
    v_mfma_f32_16x16x32_bf16 v[184:187], v[124:127], a[108:111], v[184:187]
    v_exp_f32 v182, v182
    v_mfma_f32_16x16x32_bf16 v[188:191], v[128:131], a[96:99], v[224:227]
    ds_read_b128 v[124:127], v231
    ds_read_b128 v[128:131], v228 offset:4096
    v_mfma_f32_16x16x32_bf16 v[188:191], v[132:135], a[100:103], v[188:191]
    v_exp_f32 v183, v183
    v_mfma_f32_16x16x32_bf16 v[188:191], v[136:139], a[104:107], v[188:191]
    v_cvt_pk_bf16_f32 v194, v180, v181
    v_cvt_pk_bf16_f32 v195, v182, v183
    v_mfma_f32_16x16x32_bf16 v[188:191], v[140:143], a[108:111], v[188:191]
    ds_read_b128 v[132:135], v229 offset:4096
    ds_read_b128 v[136:139], v230 offset:4096
    v_mfma_f32_16x16x32_bf16 v[80:83], v[144:147], v[192:195], v[80:83]
    v_exp_f32 v184, v184
    v_mfma_f32_16x16x32_bf16 v[84:87], v[148:151], v[192:195], v[84:87]
    ds_read_b128 v[140:143], v231 offset:4096
    s_add_u32 m0, s44, 49152
    v_mfma_f32_16x16x32_bf16 v[88:91], v[152:155], v[192:195], v[88:91]
    v_exp_f32 v185, v185
    v_mfma_f32_16x16x32_bf16 v[92:95], v[156:159], v[192:195], v[92:95]
    buffer_load_dwordx4 v240, s[24:27], 0 offen nt lds
    v_mfma_f32_16x16x32_bf16 a[192:195], v[160:163], v[192:195], a[192:195]
    v_exp_f32 v186, v186
    v_mfma_f32_16x16x32_bf16 a[196:199], v[164:167], v[192:195], a[196:199]
    s_waitcnt lgkmcnt(4)
    buffer_load_dwordx4 v241, s[24:27], 0 offen offset:1024 nt lds
    v_mfma_f32_16x16x32_bf16 a[200:203], v[168:171], v[192:195], a[200:203]
    v_exp_f32 v187, v187
    v_mfma_f32_16x16x32_bf16 a[204:207], v[172:175], v[192:195], a[204:207]
    v_cvt_pk_bf16_f32 v196, v184, v185
    v_cvt_pk_bf16_f32 v197, v186, v187
    v_mfma_f32_16x16x32_bf16 a[244:247], a[252:255], v[192:195], a[244:247]
    v_exp_f32 v188, v188
    v_mfma_f32_16x16x32_bf16 v[176:179], v[112:115], a[0:3], v[200:203]
    buffer_load_dwordx4 v240, s[24:27], 0 offen offset:2048 nt lds
    v_mfma_f32_16x16x32_bf16 v[176:179], v[116:119], a[4:7], v[176:179]
    v_exp_f32 v189, v189
    v_mfma_f32_16x16x32_bf16 v[176:179], v[120:123], a[8:11], v[176:179]
    s_waitcnt lgkmcnt(0)
    v_mfma_f32_16x16x32_bf16 v[176:179], v[124:127], a[12:15], v[176:179]
    v_exp_f32 v190, v190
    v_mfma_f32_16x16x32_bf16 v[180:183], v[128:131], a[0:3], v[200:203]
    buffer_load_dwordx4 v241, s[24:27], 0 offen offset:3072 nt lds
    v_mfma_f32_16x16x32_bf16 v[180:183], v[132:135], a[4:7], v[180:183]
    v_exp_f32 v191, v191
    v_mfma_f32_16x16x32_bf16 v[180:183], v[136:139], a[8:11], v[180:183]
    v_cvt_pk_bf16_f32 v198, v188, v189
    v_cvt_pk_bf16_f32 v199, v190, v191
    v_mfma_f32_16x16x32_bf16 v[180:183], v[140:143], a[12:15], v[180:183]
    v_mfma_f32_16x16x32_bf16 v[96:99], v[144:147], v[196:199], v[96:99]
    v_exp_f32 v176, v176
    v_mfma_f32_16x16x32_bf16 v[100:103], v[148:151], v[196:199], v[100:103]
    ds_read_b64_tr_b16 v[144:145], v232
    ds_read_b64_tr_b16 v[146:147], v232 offset:4096
    v_mfma_f32_16x16x32_bf16 v[104:107], v[152:155], v[196:199], v[104:107]
    v_exp_f32 v177, v177
    v_mfma_f32_16x16x32_bf16 v[108:111], v[156:159], v[196:199], v[108:111]
    ds_read_b64_tr_b16 v[148:149], v233
    ds_read_b64_tr_b16 v[150:151], v233 offset:4096
    v_mfma_f32_16x16x32_bf16 a[208:211], v[160:163], v[196:199], a[208:211]
    v_exp_f32 v178, v178
    v_mfma_f32_16x16x32_bf16 a[212:215], v[164:167], v[196:199], a[212:215]
    ds_read_b64_tr_b16 v[152:153], v234
    ds_read_b64_tr_b16 v[154:155], v234 offset:4096
    v_mfma_f32_16x16x32_bf16 a[216:219], v[168:171], v[196:199], a[216:219]
    v_exp_f32 v179, v179
    v_mfma_f32_16x16x32_bf16 a[220:223], v[172:175], v[196:199], a[220:223]
    v_cvt_pk_bf16_f32 v192, v176, v177
    v_cvt_pk_bf16_f32 v193, v178, v179
    v_mfma_f32_16x16x32_bf16 a[248:251], a[252:255], v[196:199], a[248:251]
    v_exp_f32 v180, v180
    v_mfma_f32_16x16x32_bf16 v[184:187], v[112:115], a[16:19], v[204:207]
    ds_read_b64_tr_b16 v[156:157], v235
    ds_read_b64_tr_b16 v[158:159], v235 offset:4096
    v_mfma_f32_16x16x32_bf16 v[184:187], v[116:119], a[20:23], v[184:187]
    v_exp_f32 v181, v181
    v_mfma_f32_16x16x32_bf16 v[184:187], v[120:123], a[24:27], v[184:187]
    ds_read_b64_tr_b16 v[160:161], v236
    ds_read_b64_tr_b16 v[162:163], v236 offset:4096
    v_mfma_f32_16x16x32_bf16 v[184:187], v[124:127], a[28:31], v[184:187]
    v_exp_f32 v182, v182
    v_mfma_f32_16x16x32_bf16 v[188:191], v[128:131], a[16:19], v[204:207]
    ds_read_b64_tr_b16 v[164:165], v237
    ds_read_b64_tr_b16 v[166:167], v237 offset:4096
    v_mfma_f32_16x16x32_bf16 v[188:191], v[132:135], a[20:23], v[188:191]
    v_exp_f32 v183, v183
    v_mfma_f32_16x16x32_bf16 v[188:191], v[136:139], a[24:27], v[188:191]
    v_cvt_pk_bf16_f32 v194, v180, v181
    v_cvt_pk_bf16_f32 v195, v182, v183
    v_mfma_f32_16x16x32_bf16 v[188:191], v[140:143], a[28:31], v[188:191]
    ds_read_b64_tr_b16 v[168:169], v238
    ds_read_b64_tr_b16 v[170:171], v238 offset:4096
    s_sub_u32 s47, s47, 1
    s_cmp_lg_u32 s47, 0
    s_cbranch_scc1 A_LOOP
    s_waitcnt lgkmcnt(6)
    v_mfma_f32_16x16x32_bf16 v[0:3], v[144:147], v[192:195], v[0:3]
    v_exp_f32 v184, v184
    v_mfma_f32_16x16x32_bf16 v[4:7], v[148:151], v[192:195], v[4:7]
    ds_read_b64_tr_b16 v[172:173], v239
    ds_read_b64_tr_b16 v[174:175], v239 offset:4096
    v_mfma_f32_16x16x32_bf16 v[8:11], v[152:155], v[192:195], v[8:11]
    v_exp_f32 v185, v185
    v_mfma_f32_16x16x32_bf16 v[12:15], v[156:159], v[192:195], v[12:15]
    s_waitcnt lgkmcnt(4)
    v_mfma_f32_16x16x32_bf16 a[112:115], v[160:163], v[192:195], a[112:115]
    v_exp_f32 v186, v186
    v_mfma_f32_16x16x32_bf16 a[116:119], v[164:167], v[192:195], a[116:119]
    s_waitcnt lgkmcnt(0)
    v_mfma_f32_16x16x32_bf16 a[120:123], v[168:171], v[192:195], a[120:123]
    v_exp_f32 v187, v187
    v_mfma_f32_16x16x32_bf16 a[124:127], v[172:175], v[192:195], a[124:127]
    v_cvt_pk_bf16_f32 v196, v184, v185
    v_cvt_pk_bf16_f32 v197, v186, v187
    v_mfma_f32_16x16x32_bf16 a[224:227], a[252:255], v[192:195], a[224:227]
    v_exp_f32 v188, v188
    v_mfma_f32_16x16x32_bf16 v[176:179], v[112:115], a[32:35], v[208:211]
    s_add_u32 m0, s44, 32768
    v_mfma_f32_16x16x32_bf16 v[176:179], v[116:119], a[36:39], v[176:179]
    v_exp_f32 v189, v189
    v_mfma_f32_16x16x32_bf16 v[176:179], v[120:123], a[40:43], v[176:179]
    v_mfma_f32_16x16x32_bf16 v[176:179], v[124:127], a[44:47], v[176:179]
    v_exp_f32 v190, v190
    v_mfma_f32_16x16x32_bf16 v[180:183], v[128:131], a[32:35], v[208:211]
    buffer_load_dwordx4 v240, s[28:31], 0 offen nt lds
    v_mfma_f32_16x16x32_bf16 v[180:183], v[132:135], a[36:39], v[180:183]
    v_exp_f32 v191, v191
    v_mfma_f32_16x16x32_bf16 v[180:183], v[136:139], a[40:43], v[180:183]
    v_cvt_pk_bf16_f32 v198, v188, v189
    v_cvt_pk_bf16_f32 v199, v190, v191
    v_mfma_f32_16x16x32_bf16 v[180:183], v[140:143], a[44:47], v[180:183]
    v_mfma_f32_16x16x32_bf16 v[16:19], v[144:147], v[196:199], v[16:19]
    v_exp_f32 v176, v176
    v_mfma_f32_16x16x32_bf16 v[20:23], v[148:151], v[196:199], v[20:23]
    v_mfma_f32_16x16x32_bf16 v[24:27], v[152:155], v[196:199], v[24:27]
    v_exp_f32 v177, v177
    v_mfma_f32_16x16x32_bf16 v[28:31], v[156:159], v[196:199], v[28:31]
    v_mfma_f32_16x16x32_bf16 a[128:131], v[160:163], v[196:199], a[128:131]
    v_exp_f32 v178, v178
    v_mfma_f32_16x16x32_bf16 a[132:135], v[164:167], v[196:199], a[132:135]
    buffer_load_dwordx4 v241, s[28:31], 0 offen offset:1024 nt lds
    v_mfma_f32_16x16x32_bf16 a[136:139], v[168:171], v[196:199], a[136:139]
    v_exp_f32 v179, v179
    v_mfma_f32_16x16x32_bf16 a[140:143], v[172:175], v[196:199], a[140:143]
    v_cvt_pk_bf16_f32 v192, v176, v177
    v_cvt_pk_bf16_f32 v193, v178, v179
    v_mfma_f32_16x16x32_bf16 a[228:231], a[252:255], v[196:199], a[228:231]
    v_exp_f32 v180, v180
    v_mfma_f32_16x16x32_bf16 v[184:187], v[112:115], a[48:51], v[212:215]
    v_add_u32 v232, 4294934528, v232
    v_add_u32 v233, 4294934528, v233
    v_mfma_f32_16x16x32_bf16 v[184:187], v[116:119], a[52:55], v[184:187]
    v_exp_f32 v181, v181
    v_mfma_f32_16x16x32_bf16 v[184:187], v[120:123], a[56:59], v[184:187]
    v_mfma_f32_16x16x32_bf16 v[184:187], v[124:127], a[60:63], v[184:187]
    v_exp_f32 v182, v182
    v_mfma_f32_16x16x32_bf16 v[188:191], v[128:131], a[48:51], v[212:215]
    v_add_u32 v234, 4294934528, v234
    v_add_u32 v235, 4294934528, v235
    v_mfma_f32_16x16x32_bf16 v[188:191], v[132:135], a[52:55], v[188:191]
    v_exp_f32 v183, v183
    v_mfma_f32_16x16x32_bf16 v[188:191], v[136:139], a[56:59], v[188:191]
    v_cvt_pk_bf16_f32 v194, v180, v181
    v_cvt_pk_bf16_f32 v195, v182, v183
    v_mfma_f32_16x16x32_bf16 v[188:191], v[140:143], a[60:63], v[188:191]
    v_mfma_f32_16x16x32_bf16 v[32:35], v[144:147], v[192:195], v[32:35]
    v_exp_f32 v184, v184
    v_mfma_f32_16x16x32_bf16 v[36:39], v[148:151], v[192:195], v[36:39]
    v_add_u32 v236, 4294934528, v236
    v_add_u32 v237, 4294934528, v237
    v_mfma_f32_16x16x32_bf16 v[40:43], v[152:155], v[192:195], v[40:43]
    v_exp_f32 v185, v185
    v_mfma_f32_16x16x32_bf16 v[44:47], v[156:159], v[192:195], v[44:47]
    v_mfma_f32_16x16x32_bf16 a[144:147], v[160:163], v[192:195], a[144:147]
    v_exp_f32 v186, v186
    v_mfma_f32_16x16x32_bf16 a[148:151], v[164:167], v[192:195], a[148:151]
    buffer_load_dwordx4 v240, s[28:31], 0 offen offset:2048 nt lds
    v_mfma_f32_16x16x32_bf16 a[152:155], v[168:171], v[192:195], a[152:155]
    v_exp_f32 v187, v187
    v_mfma_f32_16x16x32_bf16 a[156:159], v[172:175], v[192:195], a[156:159]
    v_cvt_pk_bf16_f32 v196, v184, v185
    v_cvt_pk_bf16_f32 v197, v186, v187
    v_mfma_f32_16x16x32_bf16 a[232:235], a[252:255], v[192:195], a[232:235]
    v_exp_f32 v188, v188
    v_mfma_f32_16x16x32_bf16 v[176:179], v[112:115], a[64:67], v[216:219]
    v_mfma_f32_16x16x32_bf16 v[176:179], v[116:119], a[68:71], v[176:179]
    v_exp_f32 v189, v189
    v_mfma_f32_16x16x32_bf16 v[176:179], v[120:123], a[72:75], v[176:179]
    v_mfma_f32_16x16x32_bf16 v[176:179], v[124:127], a[76:79], v[176:179]
    v_exp_f32 v190, v190
    v_mfma_f32_16x16x32_bf16 v[180:183], v[128:131], a[64:67], v[216:219]
    v_add_u32 v238, 4294934528, v238
    v_add_u32 v239, 4294934528, v239
    v_mfma_f32_16x16x32_bf16 v[180:183], v[132:135], a[68:71], v[180:183]
    v_exp_f32 v191, v191
    v_mfma_f32_16x16x32_bf16 v[180:183], v[136:139], a[72:75], v[180:183]
    v_cvt_pk_bf16_f32 v198, v188, v189
    v_cvt_pk_bf16_f32 v199, v190, v191
    v_mfma_f32_16x16x32_bf16 v[180:183], v[140:143], a[76:79], v[180:183]
    v_mfma_f32_16x16x32_bf16 v[48:51], v[144:147], v[196:199], v[48:51]
    v_exp_f32 v176, v176
    v_mfma_f32_16x16x32_bf16 v[52:55], v[148:151], v[196:199], v[52:55]
    v_add_u32 v228, 4294934528, v228
    v_add_u32 v229, 4294934528, v229
    v_mfma_f32_16x16x32_bf16 v[56:59], v[152:155], v[196:199], v[56:59]
    v_exp_f32 v177, v177
    v_mfma_f32_16x16x32_bf16 v[60:63], v[156:159], v[196:199], v[60:63]
    v_mfma_f32_16x16x32_bf16 a[160:163], v[160:163], v[196:199], a[160:163]
    v_exp_f32 v178, v178
    v_mfma_f32_16x16x32_bf16 a[164:167], v[164:167], v[196:199], a[164:167]
    buffer_load_dwordx4 v241, s[28:31], 0 offen offset:3072 nt lds
    v_mfma_f32_16x16x32_bf16 a[168:171], v[168:171], v[196:199], a[168:171]
    v_exp_f32 v179, v179
    v_mfma_f32_16x16x32_bf16 a[172:175], v[172:175], v[196:199], a[172:175]
    v_cvt_pk_bf16_f32 v192, v176, v177
    v_cvt_pk_bf16_f32 v193, v178, v179
    v_mfma_f32_16x16x32_bf16 a[236:239], a[252:255], v[196:199], a[236:239]
    v_exp_f32 v180, v180
    v_mfma_f32_16x16x32_bf16 v[184:187], v[112:115], a[80:83], v[220:223]
    v_mfma_f32_16x16x32_bf16 v[184:187], v[116:119], a[84:87], v[184:187]
    v_exp_f32 v181, v181
    v_mfma_f32_16x16x32_bf16 v[184:187], v[120:123], a[88:91], v[184:187]
    v_mfma_f32_16x16x32_bf16 v[184:187], v[124:127], a[92:95], v[184:187]
    v_exp_f32 v182, v182
    v_mfma_f32_16x16x32_bf16 v[188:191], v[128:131], a[80:83], v[220:223]
    v_add_u32 v230, 4294934528, v230
    v_add_u32 v231, 4294934528, v231
    v_mfma_f32_16x16x32_bf16 v[188:191], v[132:135], a[84:87], v[188:191]
    v_exp_f32 v183, v183
    v_mfma_f32_16x16x32_bf16 v[188:191], v[136:139], a[88:91], v[188:191]
    v_cvt_pk_bf16_f32 v194, v180, v181
    v_cvt_pk_bf16_f32 v195, v182, v183
    v_mfma_f32_16x16x32_bf16 v[188:191], v[140:143], a[92:95], v[188:191]
    v_mfma_f32_16x16x32_bf16 v[64:67], v[144:147], v[192:195], v[64:67]
    v_exp_f32 v184, v184
    v_mfma_f32_16x16x32_bf16 v[68:71], v[148:151], v[192:195], v[68:71]
    v_mfma_f32_16x16x32_bf16 v[72:75], v[152:155], v[192:195], v[72:75]
    v_exp_f32 v185, v185
    v_mfma_f32_16x16x32_bf16 v[76:79], v[156:159], v[192:195], v[76:79]
    v_mfma_f32_16x16x32_bf16 a[176:179], v[160:163], v[192:195], a[176:179]
    v_exp_f32 v186, v186
    v_mfma_f32_16x16x32_bf16 a[180:183], v[164:167], v[192:195], a[180:183]
    s_waitcnt vmcnt(16)
    s_barrier
    v_mfma_f32_16x16x32_bf16 a[184:187], v[168:171], v[192:195], a[184:187]
    v_exp_f32 v187, v187
    v_mfma_f32_16x16x32_bf16 a[188:191], v[172:175], v[192:195], a[188:191]
    v_cvt_pk_bf16_f32 v196, v184, v185
    v_cvt_pk_bf16_f32 v197, v186, v187
    v_mfma_f32_16x16x32_bf16 a[240:243], a[252:255], v[192:195], a[240:243]
    v_exp_f32 v188, v188
    v_mfma_f32_16x16x32_bf16 v[176:179], v[112:115], a[96:99], v[224:227]
    ds_read_b128 v[112:115], v228
    v_and_b32 v243, 63, v242
    s_lshr_b32 s49, s2, 3
    v_mfma_f32_16x16x32_bf16 v[176:179], v[116:119], a[100:103], v[176:179]
    v_exp_f32 v189, v189
    s_lshl_b32 s49, s49, 2
    s_add_u32 s49, s49, s36
    v_mfma_f32_16x16x32_bf16 v[176:179], v[120:123], a[104:107], v[176:179]
    ds_read_b128 v[116:119], v229
    ds_read_b128 v[120:123], v230
    s_mul_i32 s49, s49, 36864
    s_and_b32 s50, s2, 1
    v_mfma_f32_16x16x32_bf16 v[176:179], v[124:127], a[108:111], v[176:179]
    v_exp_f32 v190, v190
    s_lshl_b32 s50, s50, 9
    s_add_u32 s49, s49, s50
    v_mfma_f32_16x16x32_bf16 v[180:183], v[128:131], a[96:99], v[224:227]
    ds_read_b128 v[124:127], v231
    ds_read_b128 v[128:131], v228 offset:4096
    v_cmp_gt_u32 vcc, 32, v243
    v_mul_u32_u24 v243, 1152, v243
    v_mfma_f32_16x16x32_bf16 v[180:183], v[132:135], a[100:103], v[180:183]
    v_exp_f32 v191, v191
    v_add_u32 v243, s49, v243
    v_mov_b32 v255, 0x40000000
    v_mfma_f32_16x16x32_bf16 v[180:183], v[136:139], a[104:107], v[180:183]
    v_cvt_pk_bf16_f32 v198, v188, v189
    v_cvt_pk_bf16_f32 v199, v190, v191
    v_cndmask_b32 v243, v255, v243, vcc
    v_mfma_f32_16x16x32_bf16 v[180:183], v[140:143], a[108:111], v[180:183]
    ds_read_b128 v[132:135], v229 offset:4096
    ds_read_b128 v[136:139], v230 offset:4096
    v_mfma_f32_16x16x32_bf16 v[80:83], v[144:147], v[196:199], v[80:83]
    v_exp_f32 v176, v176
    v_mfma_f32_16x16x32_bf16 v[84:87], v[148:151], v[196:199], v[84:87]
    ds_read_b128 v[140:143], v231 offset:4096
    v_mfma_f32_16x16x32_bf16 v[88:91], v[152:155], v[196:199], v[88:91]
    v_exp_f32 v177, v177
    v_mfma_f32_16x16x32_bf16 v[92:95], v[156:159], v[196:199], v[92:95]
    v_mfma_f32_16x16x32_bf16 a[192:195], v[160:163], v[196:199], a[192:195]
    v_exp_f32 v178, v178
    v_mfma_f32_16x16x32_bf16 a[196:199], v[164:167], v[196:199], a[196:199]
    s_waitcnt lgkmcnt(4)
    v_mfma_f32_16x16x32_bf16 a[200:203], v[168:171], v[196:199], a[200:203]
    v_exp_f32 v179, v179
    v_mfma_f32_16x16x32_bf16 a[204:207], v[172:175], v[196:199], a[204:207]
    v_cvt_pk_bf16_f32 v192, v176, v177
    v_cvt_pk_bf16_f32 v193, v178, v179
    v_mfma_f32_16x16x32_bf16 a[244:247], a[252:255], v[196:199], a[244:247]
    v_exp_f32 v180, v180
    v_mfma_f32_16x16x32_bf16 v[184:187], v[112:115], a[0:3], v[200:203]
    v_mfma_f32_16x16x32_bf16 v[184:187], v[116:119], a[4:7], v[184:187]
    v_exp_f32 v181, v181
    v_mfma_f32_16x16x32_bf16 v[184:187], v[120:123], a[8:11], v[184:187]
    s_waitcnt lgkmcnt(0)
    v_mfma_f32_16x16x32_bf16 v[184:187], v[124:127], a[12:15], v[184:187]
    v_exp_f32 v182, v182
    v_mfma_f32_16x16x32_bf16 v[188:191], v[128:131], a[0:3], v[200:203]
    v_mfma_f32_16x16x32_bf16 v[188:191], v[132:135], a[4:7], v[188:191]
    v_exp_f32 v183, v183
    v_mfma_f32_16x16x32_bf16 v[188:191], v[136:139], a[8:11], v[188:191]
    v_cvt_pk_bf16_f32 v194, v180, v181
    v_cvt_pk_bf16_f32 v195, v182, v183
    v_mfma_f32_16x16x32_bf16 v[188:191], v[140:143], a[12:15], v[188:191]
    v_mfma_f32_16x16x32_bf16 v[96:99], v[144:147], v[192:195], v[96:99]
    v_exp_f32 v184, v184
    v_mfma_f32_16x16x32_bf16 v[100:103], v[148:151], v[192:195], v[100:103]
    ds_read_b64_tr_b16 v[144:145], v232
    ds_read_b64_tr_b16 v[146:147], v232 offset:4096
    v_mfma_f32_16x16x32_bf16 v[104:107], v[152:155], v[192:195], v[104:107]
    v_exp_f32 v185, v185
    v_mfma_f32_16x16x32_bf16 v[108:111], v[156:159], v[192:195], v[108:111]
    ds_read_b64_tr_b16 v[148:149], v233
    ds_read_b64_tr_b16 v[150:151], v233 offset:4096
    v_mfma_f32_16x16x32_bf16 a[208:211], v[160:163], v[192:195], a[208:211]
    v_exp_f32 v186, v186
    v_mfma_f32_16x16x32_bf16 a[212:215], v[164:167], v[192:195], a[212:215]
    ds_read_b64_tr_b16 v[152:153], v234
    ds_read_b64_tr_b16 v[154:155], v234 offset:4096
    v_mfma_f32_16x16x32_bf16 a[216:219], v[168:171], v[192:195], a[216:219]
    v_exp_f32 v187, v187
    buffer_load_dword v255, v243, s[16:19], 0 offen
    v_mfma_f32_16x16x32_bf16 a[220:223], v[172:175], v[192:195], a[220:223]
    v_cvt_pk_bf16_f32 v196, v184, v185
    v_cvt_pk_bf16_f32 v197, v186, v187
    v_mfma_f32_16x16x32_bf16 a[248:251], a[252:255], v[192:195], a[248:251]
    v_exp_f32 v188, v188
    v_mfma_f32_16x16x32_bf16 v[176:179], v[112:115], a[16:19], v[204:207]
    ds_read_b64_tr_b16 v[156:157], v235
    ds_read_b64_tr_b16 v[158:159], v235 offset:4096
    v_mfma_f32_16x16x32_bf16 v[176:179], v[116:119], a[20:23], v[176:179]
    v_exp_f32 v189, v189
    v_mfma_f32_16x16x32_bf16 v[176:179], v[120:123], a[24:27], v[176:179]
    ds_read_b64_tr_b16 v[160:161], v236
    ds_read_b64_tr_b16 v[162:163], v236 offset:4096
    v_mfma_f32_16x16x32_bf16 v[176:179], v[124:127], a[28:31], v[176:179]
    v_exp_f32 v190, v190
    v_mfma_f32_16x16x32_bf16 v[180:183], v[128:131], a[16:19], v[204:207]
    ds_read_b64_tr_b16 v[164:165], v237
    ds_read_b64_tr_b16 v[166:167], v237 offset:4096
    v_mfma_f32_16x16x32_bf16 v[180:183], v[132:135], a[20:23], v[180:183]
    v_exp_f32 v191, v191
    v_mfma_f32_16x16x32_bf16 v[180:183], v[136:139], a[24:27], v[180:183]
    v_cvt_pk_bf16_f32 v198, v188, v189
    v_cvt_pk_bf16_f32 v199, v190, v191
    v_mfma_f32_16x16x32_bf16 v[180:183], v[140:143], a[28:31], v[180:183]
    ds_read_b64_tr_b16 v[168:169], v238
    ds_read_b64_tr_b16 v[170:171], v238 offset:4096
    s_waitcnt lgkmcnt(6)
    v_mfma_f32_16x16x32_bf16 v[0:3], v[144:147], v[196:199], v[0:3]
    v_exp_f32 v176, v176
    v_mfma_f32_16x16x32_bf16 v[4:7], v[148:151], v[196:199], v[4:7]
    ds_read_b64_tr_b16 v[172:173], v239
    ds_read_b64_tr_b16 v[174:175], v239 offset:4096
    v_mfma_f32_16x16x32_bf16 v[8:11], v[152:155], v[196:199], v[8:11]
    v_exp_f32 v177, v177
    v_mfma_f32_16x16x32_bf16 v[12:15], v[156:159], v[196:199], v[12:15]
    s_waitcnt lgkmcnt(4)
    v_mfma_f32_16x16x32_bf16 a[112:115], v[160:163], v[196:199], a[112:115]
    v_exp_f32 v178, v178
    v_mfma_f32_16x16x32_bf16 a[116:119], v[164:167], v[196:199], a[116:119]
    s_waitcnt lgkmcnt(0)
    v_mfma_f32_16x16x32_bf16 a[120:123], v[168:171], v[196:199], a[120:123]
    v_exp_f32 v179, v179
    v_mfma_f32_16x16x32_bf16 a[124:127], v[172:175], v[196:199], a[124:127]
    v_cvt_pk_bf16_f32 v192, v176, v177
    v_cvt_pk_bf16_f32 v193, v178, v179
    v_mfma_f32_16x16x32_bf16 a[224:227], a[252:255], v[196:199], a[224:227]
    v_exp_f32 v180, v180
    v_mfma_f32_16x16x32_bf16 v[184:187], v[112:115], a[32:35], v[208:211]
    v_mfma_f32_16x16x32_bf16 v[184:187], v[116:119], a[36:39], v[184:187]
    v_exp_f32 v181, v181
    v_mfma_f32_16x16x32_bf16 v[184:187], v[120:123], a[40:43], v[184:187]
    v_mfma_f32_16x16x32_bf16 v[184:187], v[124:127], a[44:47], v[184:187]
    v_exp_f32 v182, v182
    v_mfma_f32_16x16x32_bf16 v[188:191], v[128:131], a[32:35], v[208:211]
    v_mfma_f32_16x16x32_bf16 v[188:191], v[132:135], a[36:39], v[188:191]
    v_exp_f32 v183, v183
    v_mfma_f32_16x16x32_bf16 v[188:191], v[136:139], a[40:43], v[188:191]
    v_cvt_pk_bf16_f32 v194, v180, v181
    v_cvt_pk_bf16_f32 v195, v182, v183
    v_mfma_f32_16x16x32_bf16 v[188:191], v[140:143], a[44:47], v[188:191]
    v_mfma_f32_16x16x32_bf16 v[16:19], v[144:147], v[192:195], v[16:19]
    v_exp_f32 v184, v184
    v_mfma_f32_16x16x32_bf16 v[20:23], v[148:151], v[192:195], v[20:23]
    v_mfma_f32_16x16x32_bf16 v[24:27], v[152:155], v[192:195], v[24:27]
    v_exp_f32 v185, v185
    v_mfma_f32_16x16x32_bf16 v[28:31], v[156:159], v[192:195], v[28:31]
    v_mfma_f32_16x16x32_bf16 a[128:131], v[160:163], v[192:195], a[128:131]
    v_exp_f32 v186, v186
    v_mfma_f32_16x16x32_bf16 a[132:135], v[164:167], v[192:195], a[132:135]
    v_mfma_f32_16x16x32_bf16 a[136:139], v[168:171], v[192:195], a[136:139]
    v_exp_f32 v187, v187
    v_mfma_f32_16x16x32_bf16 a[140:143], v[172:175], v[192:195], a[140:143]
    v_cvt_pk_bf16_f32 v196, v184, v185
    v_cvt_pk_bf16_f32 v197, v186, v187
    v_mfma_f32_16x16x32_bf16 a[228:231], a[252:255], v[192:195], a[228:231]
    v_exp_f32 v188, v188
    v_mfma_f32_16x16x32_bf16 v[176:179], v[112:115], a[48:51], v[212:215]
    v_add_u32 v232, 4294934528, v232
    v_add_u32 v233, 4294934528, v233
    v_mfma_f32_16x16x32_bf16 v[176:179], v[116:119], a[52:55], v[176:179]
    v_exp_f32 v189, v189
    v_mfma_f32_16x16x32_bf16 v[176:179], v[120:123], a[56:59], v[176:179]
    v_mfma_f32_16x16x32_bf16 v[176:179], v[124:127], a[60:63], v[176:179]
    v_exp_f32 v190, v190
    v_mfma_f32_16x16x32_bf16 v[180:183], v[128:131], a[48:51], v[212:215]
    v_add_u32 v234, 4294934528, v234
    v_add_u32 v235, 4294934528, v235
    v_mfma_f32_16x16x32_bf16 v[180:183], v[132:135], a[52:55], v[180:183]
    v_exp_f32 v191, v191
    v_mfma_f32_16x16x32_bf16 v[180:183], v[136:139], a[56:59], v[180:183]
    v_cvt_pk_bf16_f32 v198, v188, v189
    v_cvt_pk_bf16_f32 v199, v190, v191
    v_mfma_f32_16x16x32_bf16 v[180:183], v[140:143], a[60:63], v[180:183]
    v_mfma_f32_16x16x32_bf16 v[32:35], v[144:147], v[196:199], v[32:35]
    v_exp_f32 v176, v176
    v_mfma_f32_16x16x32_bf16 v[36:39], v[148:151], v[196:199], v[36:39]
    v_add_u32 v236, 4294934528, v236
    v_add_u32 v237, 4294934528, v237
    v_mfma_f32_16x16x32_bf16 v[40:43], v[152:155], v[196:199], v[40:43]
    v_exp_f32 v177, v177
    v_mfma_f32_16x16x32_bf16 v[44:47], v[156:159], v[196:199], v[44:47]
    v_mfma_f32_16x16x32_bf16 a[144:147], v[160:163], v[196:199], a[144:147]
    v_exp_f32 v178, v178
    v_mfma_f32_16x16x32_bf16 a[148:151], v[164:167], v[196:199], a[148:151]
    v_mfma_f32_16x16x32_bf16 a[152:155], v[168:171], v[196:199], a[152:155]
    v_exp_f32 v179, v179
    buffer_load_dword v255, v243, s[16:19], 0 offen offset:128
    v_mfma_f32_16x16x32_bf16 a[156:159], v[172:175], v[196:199], a[156:159]
    v_cvt_pk_bf16_f32 v192, v176, v177
    v_cvt_pk_bf16_f32 v193, v178, v179
    v_mfma_f32_16x16x32_bf16 a[232:235], a[252:255], v[196:199], a[232:235]
    v_exp_f32 v180, v180
    v_mfma_f32_16x16x32_bf16 v[184:187], v[112:115], a[64:67], v[216:219]
    v_mfma_f32_16x16x32_bf16 v[184:187], v[116:119], a[68:71], v[184:187]
    v_exp_f32 v181, v181
    v_mfma_f32_16x16x32_bf16 v[184:187], v[120:123], a[72:75], v[184:187]
    v_mfma_f32_16x16x32_bf16 v[184:187], v[124:127], a[76:79], v[184:187]
    v_exp_f32 v182, v182
    v_mfma_f32_16x16x32_bf16 v[188:191], v[128:131], a[64:67], v[216:219]
    v_add_u32 v238, 4294934528, v238
    v_add_u32 v239, 4294934528, v239
    v_mfma_f32_16x16x32_bf16 v[188:191], v[132:135], a[68:71], v[188:191]
    v_exp_f32 v183, v183
    v_mfma_f32_16x16x32_bf16 v[188:191], v[136:139], a[72:75], v[188:191]
    v_cvt_pk_bf16_f32 v194, v180, v181
    v_cvt_pk_bf16_f32 v195, v182, v183
    v_mfma_f32_16x16x32_bf16 v[188:191], v[140:143], a[76:79], v[188:191]
    v_mfma_f32_16x16x32_bf16 v[48:51], v[144:147], v[192:195], v[48:51]
    v_exp_f32 v184, v184
    v_mfma_f32_16x16x32_bf16 v[52:55], v[148:151], v[192:195], v[52:55]
    v_add_u32 v228, 4294934528, v228
    v_add_u32 v229, 4294934528, v229
    v_mfma_f32_16x16x32_bf16 v[56:59], v[152:155], v[192:195], v[56:59]
    v_exp_f32 v185, v185
    v_mfma_f32_16x16x32_bf16 v[60:63], v[156:159], v[192:195], v[60:63]
    v_mfma_f32_16x16x32_bf16 a[160:163], v[160:163], v[192:195], a[160:163]
    v_exp_f32 v186, v186
    v_mfma_f32_16x16x32_bf16 a[164:167], v[164:167], v[192:195], a[164:167]
    v_mfma_f32_16x16x32_bf16 a[168:171], v[168:171], v[192:195], a[168:171]
    v_exp_f32 v187, v187
    v_mfma_f32_16x16x32_bf16 a[172:175], v[172:175], v[192:195], a[172:175]
    v_cvt_pk_bf16_f32 v196, v184, v185
    v_cvt_pk_bf16_f32 v197, v186, v187
    v_mfma_f32_16x16x32_bf16 a[236:239], a[252:255], v[192:195], a[236:239]
    v_exp_f32 v188, v188
    v_mfma_f32_16x16x32_bf16 v[176:179], v[112:115], a[80:83], v[220:223]
    v_mfma_f32_16x16x32_bf16 v[176:179], v[116:119], a[84:87], v[176:179]
    v_exp_f32 v189, v189
    v_mfma_f32_16x16x32_bf16 v[176:179], v[120:123], a[88:91], v[176:179]
    v_mfma_f32_16x16x32_bf16 v[176:179], v[124:127], a[92:95], v[176:179]
    v_exp_f32 v190, v190
    v_mfma_f32_16x16x32_bf16 v[180:183], v[128:131], a[80:83], v[220:223]
    v_add_u32 v230, 4294934528, v230
    v_add_u32 v231, 4294934528, v231
    v_mfma_f32_16x16x32_bf16 v[180:183], v[132:135], a[84:87], v[180:183]
    v_exp_f32 v191, v191
    v_mfma_f32_16x16x32_bf16 v[180:183], v[136:139], a[88:91], v[180:183]
    v_cvt_pk_bf16_f32 v198, v188, v189
    v_cvt_pk_bf16_f32 v199, v190, v191
    v_mfma_f32_16x16x32_bf16 v[180:183], v[140:143], a[92:95], v[180:183]
    v_mfma_f32_16x16x32_bf16 v[64:67], v[144:147], v[196:199], v[64:67]
    v_exp_f32 v176, v176
    v_mfma_f32_16x16x32_bf16 v[68:71], v[148:151], v[196:199], v[68:71]
    v_mfma_f32_16x16x32_bf16 v[72:75], v[152:155], v[196:199], v[72:75]
    v_exp_f32 v177, v177
    v_mfma_f32_16x16x32_bf16 v[76:79], v[156:159], v[196:199], v[76:79]
    v_mfma_f32_16x16x32_bf16 a[176:179], v[160:163], v[196:199], a[176:179]
    v_exp_f32 v178, v178
    v_mfma_f32_16x16x32_bf16 a[180:183], v[164:167], v[196:199], a[180:183]
    s_waitcnt vmcnt(10)
    s_barrier
    v_mfma_f32_16x16x32_bf16 a[184:187], v[168:171], v[196:199], a[184:187]
    v_exp_f32 v179, v179
    v_mfma_f32_16x16x32_bf16 a[188:191], v[172:175], v[196:199], a[188:191]
    v_cvt_pk_bf16_f32 v192, v176, v177
    v_cvt_pk_bf16_f32 v193, v178, v179
    v_mfma_f32_16x16x32_bf16 a[240:243], a[252:255], v[196:199], a[240:243]
    v_exp_f32 v180, v180
    v_mfma_f32_16x16x32_bf16 v[184:187], v[112:115], a[96:99], v[224:227]
    ds_read_b128 v[112:115], v228
    v_mfma_f32_16x16x32_bf16 v[184:187], v[116:119], a[100:103], v[184:187]
    v_exp_f32 v181, v181
    v_mfma_f32_16x16x32_bf16 v[184:187], v[120:123], a[104:107], v[184:187]
    ds_read_b128 v[116:119], v229
    ds_read_b128 v[120:123], v230
    v_mfma_f32_16x16x32_bf16 v[184:187], v[124:127], a[108:111], v[184:187]
    v_exp_f32 v182, v182
    v_mfma_f32_16x16x32_bf16 v[188:191], v[128:131], a[96:99], v[224:227]
    ds_read_b128 v[124:127], v231
    ds_read_b128 v[128:131], v228 offset:4096
    v_mfma_f32_16x16x32_bf16 v[188:191], v[132:135], a[100:103], v[188:191]
    v_exp_f32 v183, v183
    v_mfma_f32_16x16x32_bf16 v[188:191], v[136:139], a[104:107], v[188:191]
    v_cvt_pk_bf16_f32 v194, v180, v181
    v_cvt_pk_bf16_f32 v195, v182, v183
    v_mfma_f32_16x16x32_bf16 v[188:191], v[140:143], a[108:111], v[188:191]
    ds_read_b128 v[132:135], v229 offset:4096
    ds_read_b128 v[136:139], v230 offset:4096
    v_mfma_f32_16x16x32_bf16 v[80:83], v[144:147], v[192:195], v[80:83]
    v_exp_f32 v184, v184
    v_mfma_f32_16x16x32_bf16 v[84:87], v[148:151], v[192:195], v[84:87]
    ds_read_b128 v[140:143], v231 offset:4096
    v_mfma_f32_16x16x32_bf16 v[88:91], v[152:155], v[192:195], v[88:91]
    v_exp_f32 v185, v185
    v_mfma_f32_16x16x32_bf16 v[92:95], v[156:159], v[192:195], v[92:95]
    v_mfma_f32_16x16x32_bf16 a[192:195], v[160:163], v[192:195], a[192:195]
    v_exp_f32 v186, v186
    v_mfma_f32_16x16x32_bf16 a[196:199], v[164:167], v[192:195], a[196:199]
    s_waitcnt lgkmcnt(4)
    v_mfma_f32_16x16x32_bf16 a[200:203], v[168:171], v[192:195], a[200:203]
    v_exp_f32 v187, v187
    buffer_load_dword v255, v243, s[16:19], 0 offen offset:256
    v_mfma_f32_16x16x32_bf16 a[204:207], v[172:175], v[192:195], a[204:207]
    v_cvt_pk_bf16_f32 v196, v184, v185
    v_cvt_pk_bf16_f32 v197, v186, v187
    v_mfma_f32_16x16x32_bf16 a[244:247], a[252:255], v[192:195], a[244:247]
    v_exp_f32 v188, v188
    v_mfma_f32_16x16x32_bf16 v[176:179], v[112:115], a[0:3], v[200:203]
    v_mfma_f32_16x16x32_bf16 v[176:179], v[116:119], a[4:7], v[176:179]
    v_exp_f32 v189, v189
    v_mfma_f32_16x16x32_bf16 v[176:179], v[120:123], a[8:11], v[176:179]
    s_waitcnt lgkmcnt(0)
    v_mfma_f32_16x16x32_bf16 v[176:179], v[124:127], a[12:15], v[176:179]
    v_exp_f32 v190, v190
    v_mfma_f32_16x16x32_bf16 v[180:183], v[128:131], a[0:3], v[200:203]
    v_mfma_f32_16x16x32_bf16 v[180:183], v[132:135], a[4:7], v[180:183]
    v_exp_f32 v191, v191
    v_mfma_f32_16x16x32_bf16 v[180:183], v[136:139], a[8:11], v[180:183]
    v_cvt_pk_bf16_f32 v198, v188, v189
    v_cvt_pk_bf16_f32 v199, v190, v191
    v_mfma_f32_16x16x32_bf16 v[180:183], v[140:143], a[12:15], v[180:183]
    v_mfma_f32_16x16x32_bf16 v[96:99], v[144:147], v[196:199], v[96:99]
    v_exp_f32 v176, v176
    v_mfma_f32_16x16x32_bf16 v[100:103], v[148:151], v[196:199], v[100:103]
    ds_read_b64_tr_b16 v[144:145], v232
    ds_read_b64_tr_b16 v[146:147], v232 offset:4096
    v_mfma_f32_16x16x32_bf16 v[104:107], v[152:155], v[196:199], v[104:107]
    v_exp_f32 v177, v177
    v_mfma_f32_16x16x32_bf16 v[108:111], v[156:159], v[196:199], v[108:111]
    ds_read_b64_tr_b16 v[148:149], v233
    ds_read_b64_tr_b16 v[150:151], v233 offset:4096
    v_mfma_f32_16x16x32_bf16 a[208:211], v[160:163], v[196:199], a[208:211]
    v_exp_f32 v178, v178
    v_mfma_f32_16x16x32_bf16 a[212:215], v[164:167], v[196:199], a[212:215]
    ds_read_b64_tr_b16 v[152:153], v234
    ds_read_b64_tr_b16 v[154:155], v234 offset:4096
    v_mfma_f32_16x16x32_bf16 a[216:219], v[168:171], v[196:199], a[216:219]
    v_exp_f32 v179, v179
    v_mfma_f32_16x16x32_bf16 a[220:223], v[172:175], v[196:199], a[220:223]
    v_cvt_pk_bf16_f32 v192, v176, v177
    v_cvt_pk_bf16_f32 v193, v178, v179
    v_mfma_f32_16x16x32_bf16 a[248:251], a[252:255], v[196:199], a[248:251]
    v_exp_f32 v180, v180
    v_mfma_f32_16x16x32_bf16 v[184:187], v[112:115], a[16:19], v[204:207]
    ds_read_b64_tr_b16 v[156:157], v235
    ds_read_b64_tr_b16 v[158:159], v235 offset:4096
    v_mfma_f32_16x16x32_bf16 v[184:187], v[116:119], a[20:23], v[184:187]
    v_exp_f32 v181, v181
    v_mfma_f32_16x16x32_bf16 v[184:187], v[120:123], a[24:27], v[184:187]
    ds_read_b64_tr_b16 v[160:161], v236
    ds_read_b64_tr_b16 v[162:163], v236 offset:4096
    v_mfma_f32_16x16x32_bf16 v[184:187], v[124:127], a[28:31], v[184:187]
    v_exp_f32 v182, v182
    v_mfma_f32_16x16x32_bf16 v[188:191], v[128:131], a[16:19], v[204:207]
    ds_read_b64_tr_b16 v[164:165], v237
    ds_read_b64_tr_b16 v[166:167], v237 offset:4096
    v_mfma_f32_16x16x32_bf16 v[188:191], v[132:135], a[20:23], v[188:191]
    v_exp_f32 v183, v183
    v_mfma_f32_16x16x32_bf16 v[188:191], v[136:139], a[24:27], v[188:191]
    v_cvt_pk_bf16_f32 v194, v180, v181
    v_cvt_pk_bf16_f32 v195, v182, v183
    v_mfma_f32_16x16x32_bf16 v[188:191], v[140:143], a[28:31], v[188:191]
    ds_read_b64_tr_b16 v[168:169], v238
    ds_read_b64_tr_b16 v[170:171], v238 offset:4096
    s_waitcnt lgkmcnt(6)
    v_mfma_f32_16x16x32_bf16 v[0:3], v[144:147], v[192:195], v[0:3]
    v_exp_f32 v184, v184
    v_mfma_f32_16x16x32_bf16 v[4:7], v[148:151], v[192:195], v[4:7]
    ds_read_b64_tr_b16 v[172:173], v239
    ds_read_b64_tr_b16 v[174:175], v239 offset:4096
    v_mfma_f32_16x16x32_bf16 v[8:11], v[152:155], v[192:195], v[8:11]
    v_exp_f32 v185, v185
    v_mfma_f32_16x16x32_bf16 v[12:15], v[156:159], v[192:195], v[12:15]
    s_waitcnt lgkmcnt(4)
    v_mfma_f32_16x16x32_bf16 a[112:115], v[160:163], v[192:195], a[112:115]
    v_exp_f32 v186, v186
    v_mfma_f32_16x16x32_bf16 a[116:119], v[164:167], v[192:195], a[116:119]
    s_waitcnt lgkmcnt(0)
    v_mfma_f32_16x16x32_bf16 a[120:123], v[168:171], v[192:195], a[120:123]
    v_exp_f32 v187, v187
    v_mfma_f32_16x16x32_bf16 a[124:127], v[172:175], v[192:195], a[124:127]
    v_cvt_pk_bf16_f32 v196, v184, v185
    v_cvt_pk_bf16_f32 v197, v186, v187
    v_mfma_f32_16x16x32_bf16 a[224:227], a[252:255], v[192:195], a[224:227]
    v_exp_f32 v188, v188
    v_mfma_f32_16x16x32_bf16 v[176:179], v[112:115], a[32:35], v[208:211]
    v_mfma_f32_16x16x32_bf16 v[176:179], v[116:119], a[36:39], v[176:179]
    v_exp_f32 v189, v189
    v_mfma_f32_16x16x32_bf16 v[176:179], v[120:123], a[40:43], v[176:179]
    v_mfma_f32_16x16x32_bf16 v[176:179], v[124:127], a[44:47], v[176:179]
    v_exp_f32 v190, v190
    v_mfma_f32_16x16x32_bf16 v[180:183], v[128:131], a[32:35], v[208:211]
    v_mfma_f32_16x16x32_bf16 v[180:183], v[132:135], a[36:39], v[180:183]
    v_exp_f32 v191, v191
    v_mfma_f32_16x16x32_bf16 v[180:183], v[136:139], a[40:43], v[180:183]
    v_cvt_pk_bf16_f32 v198, v188, v189
    v_cvt_pk_bf16_f32 v199, v190, v191
    v_mfma_f32_16x16x32_bf16 v[180:183], v[140:143], a[44:47], v[180:183]
    v_mfma_f32_16x16x32_bf16 v[16:19], v[144:147], v[196:199], v[16:19]
    v_exp_f32 v176, v176
    v_mfma_f32_16x16x32_bf16 v[20:23], v[148:151], v[196:199], v[20:23]
    v_mfma_f32_16x16x32_bf16 v[24:27], v[152:155], v[196:199], v[24:27]
    v_exp_f32 v177, v177
    v_mfma_f32_16x16x32_bf16 v[28:31], v[156:159], v[196:199], v[28:31]
    v_mfma_f32_16x16x32_bf16 a[128:131], v[160:163], v[196:199], a[128:131]
    v_exp_f32 v178, v178
    v_mfma_f32_16x16x32_bf16 a[132:135], v[164:167], v[196:199], a[132:135]
    v_mfma_f32_16x16x32_bf16 a[136:139], v[168:171], v[196:199], a[136:139]
    v_exp_f32 v179, v179
    buffer_load_dword v255, v243, s[16:19], 0 offen offset:384
    v_mfma_f32_16x16x32_bf16 a[140:143], v[172:175], v[196:199], a[140:143]
    v_cvt_pk_bf16_f32 v192, v176, v177
    v_cvt_pk_bf16_f32 v193, v178, v179
    v_mfma_f32_16x16x32_bf16 a[228:231], a[252:255], v[196:199], a[228:231]
    v_exp_f32 v180, v180
    v_mfma_f32_16x16x32_bf16 v[184:187], v[112:115], a[48:51], v[212:215]
    v_add_u32 v232, 4294934528, v232
    v_add_u32 v233, 4294934528, v233
    v_mfma_f32_16x16x32_bf16 v[184:187], v[116:119], a[52:55], v[184:187]
    v_exp_f32 v181, v181
    v_mfma_f32_16x16x32_bf16 v[184:187], v[120:123], a[56:59], v[184:187]
    v_mfma_f32_16x16x32_bf16 v[184:187], v[124:127], a[60:63], v[184:187]
    v_exp_f32 v182, v182
    v_mfma_f32_16x16x32_bf16 v[188:191], v[128:131], a[48:51], v[212:215]
    v_add_u32 v234, 4294934528, v234
    v_add_u32 v235, 4294934528, v235
    v_mfma_f32_16x16x32_bf16 v[188:191], v[132:135], a[52:55], v[188:191]
    v_exp_f32 v183, v183
    v_mfma_f32_16x16x32_bf16 v[188:191], v[136:139], a[56:59], v[188:191]
    v_cvt_pk_bf16_f32 v194, v180, v181
    v_cvt_pk_bf16_f32 v195, v182, v183
    v_mfma_f32_16x16x32_bf16 v[188:191], v[140:143], a[60:63], v[188:191]
    v_mfma_f32_16x16x32_bf16 v[32:35], v[144:147], v[192:195], v[32:35]
    v_exp_f32 v184, v184
    v_mfma_f32_16x16x32_bf16 v[36:39], v[148:151], v[192:195], v[36:39]
    v_add_u32 v236, 4294934528, v236
    v_add_u32 v237, 4294934528, v237
    v_mfma_f32_16x16x32_bf16 v[40:43], v[152:155], v[192:195], v[40:43]
    v_exp_f32 v185, v185
    v_mfma_f32_16x16x32_bf16 v[44:47], v[156:159], v[192:195], v[44:47]
    v_mfma_f32_16x16x32_bf16 a[144:147], v[160:163], v[192:195], a[144:147]
    v_exp_f32 v186, v186
    v_mfma_f32_16x16x32_bf16 a[148:151], v[164:167], v[192:195], a[148:151]
    v_mfma_f32_16x16x32_bf16 a[152:155], v[168:171], v[192:195], a[152:155]
    v_exp_f32 v187, v187
    v_mfma_f32_16x16x32_bf16 a[156:159], v[172:175], v[192:195], a[156:159]
    v_cvt_pk_bf16_f32 v196, v184, v185
    v_cvt_pk_bf16_f32 v197, v186, v187
    v_mfma_f32_16x16x32_bf16 a[232:235], a[252:255], v[192:195], a[232:235]
    v_exp_f32 v188, v188
    v_mfma_f32_16x16x32_bf16 v[176:179], v[112:115], a[64:67], v[216:219]
    v_mfma_f32_16x16x32_bf16 v[176:179], v[116:119], a[68:71], v[176:179]
    v_exp_f32 v189, v189
    v_mfma_f32_16x16x32_bf16 v[176:179], v[120:123], a[72:75], v[176:179]
    v_mfma_f32_16x16x32_bf16 v[176:179], v[124:127], a[76:79], v[176:179]
    v_exp_f32 v190, v190
    v_mfma_f32_16x16x32_bf16 v[180:183], v[128:131], a[64:67], v[216:219]
    v_add_u32 v238, 4294934528, v238
    v_add_u32 v239, 4294934528, v239
    v_mfma_f32_16x16x32_bf16 v[180:183], v[132:135], a[68:71], v[180:183]
    v_exp_f32 v191, v191
    v_mfma_f32_16x16x32_bf16 v[180:183], v[136:139], a[72:75], v[180:183]
    v_cvt_pk_bf16_f32 v198, v188, v189
    v_cvt_pk_bf16_f32 v199, v190, v191
    v_mfma_f32_16x16x32_bf16 v[180:183], v[140:143], a[76:79], v[180:183]
    v_mfma_f32_16x16x32_bf16 v[48:51], v[144:147], v[196:199], v[48:51]
    v_exp_f32 v176, v176
    v_mfma_f32_16x16x32_bf16 v[52:55], v[148:151], v[196:199], v[52:55]
    v_add_u32 v228, 4294934528, v228
    v_add_u32 v229, 4294934528, v229
    v_mfma_f32_16x16x32_bf16 v[56:59], v[152:155], v[196:199], v[56:59]
    v_exp_f32 v177, v177
    v_mfma_f32_16x16x32_bf16 v[60:63], v[156:159], v[196:199], v[60:63]
    v_mfma_f32_16x16x32_bf16 a[160:163], v[160:163], v[196:199], a[160:163]
    v_exp_f32 v178, v178
    v_mfma_f32_16x16x32_bf16 a[164:167], v[164:167], v[196:199], a[164:167]
    v_mfma_f32_16x16x32_bf16 a[168:171], v[168:171], v[196:199], a[168:171]
    v_exp_f32 v179, v179
    v_mfma_f32_16x16x32_bf16 a[172:175], v[172:175], v[196:199], a[172:175]
    v_cvt_pk_bf16_f32 v192, v176, v177
    v_cvt_pk_bf16_f32 v193, v178, v179
    v_mfma_f32_16x16x32_bf16 a[236:239], a[252:255], v[196:199], a[236:239]
    v_exp_f32 v180, v180
    v_mfma_f32_16x16x32_bf16 v[184:187], v[112:115], a[80:83], v[220:223]
    v_mfma_f32_16x16x32_bf16 v[184:187], v[116:119], a[84:87], v[184:187]
    v_exp_f32 v181, v181
    v_mfma_f32_16x16x32_bf16 v[184:187], v[120:123], a[88:91], v[184:187]
    v_mfma_f32_16x16x32_bf16 v[184:187], v[124:127], a[92:95], v[184:187]
    v_exp_f32 v182, v182
    v_mfma_f32_16x16x32_bf16 v[188:191], v[128:131], a[80:83], v[220:223]
    v_add_u32 v230, 4294934528, v230
    v_add_u32 v231, 4294934528, v231
    v_mfma_f32_16x16x32_bf16 v[188:191], v[132:135], a[84:87], v[188:191]
    v_exp_f32 v183, v183
    v_mfma_f32_16x16x32_bf16 v[188:191], v[136:139], a[88:91], v[188:191]
    v_cvt_pk_bf16_f32 v194, v180, v181
    v_cvt_pk_bf16_f32 v195, v182, v183
    v_mfma_f32_16x16x32_bf16 v[188:191], v[140:143], a[92:95], v[188:191]
    v_mfma_f32_16x16x32_bf16 v[64:67], v[144:147], v[192:195], v[64:67]
    v_exp_f32 v184, v184
    v_mfma_f32_16x16x32_bf16 v[68:71], v[148:151], v[192:195], v[68:71]
    v_mfma_f32_16x16x32_bf16 v[72:75], v[152:155], v[192:195], v[72:75]
    v_exp_f32 v185, v185
    v_mfma_f32_16x16x32_bf16 v[76:79], v[156:159], v[192:195], v[76:79]
    v_mfma_f32_16x16x32_bf16 a[176:179], v[160:163], v[192:195], a[176:179]
    v_exp_f32 v186, v186
    v_mfma_f32_16x16x32_bf16 a[180:183], v[164:167], v[192:195], a[180:183]
    s_waitcnt vmcnt(4)
    s_barrier
    v_mfma_f32_16x16x32_bf16 a[184:187], v[168:171], v[192:195], a[184:187]
    v_exp_f32 v187, v187
    buffer_load_dword v255, v243, s[16:19], 0 offen offset:512
    v_mfma_f32_16x16x32_bf16 a[188:191], v[172:175], v[192:195], a[188:191]
    v_cvt_pk_bf16_f32 v196, v184, v185
    v_cvt_pk_bf16_f32 v197, v186, v187
    v_mfma_f32_16x16x32_bf16 a[240:243], a[252:255], v[192:195], a[240:243]
    v_exp_f32 v188, v188
    v_mfma_f32_16x16x32_bf16 v[176:179], v[112:115], a[96:99], v[224:227]
    ds_read_b128 v[112:115], v228
    v_mfma_f32_16x16x32_bf16 v[176:179], v[116:119], a[100:103], v[176:179]
    v_exp_f32 v189, v189
    v_mfma_f32_16x16x32_bf16 v[176:179], v[120:123], a[104:107], v[176:179]
    ds_read_b128 v[116:119], v229
    ds_read_b128 v[120:123], v230
    v_mfma_f32_16x16x32_bf16 v[176:179], v[124:127], a[108:111], v[176:179]
    v_exp_f32 v190, v190
    v_mfma_f32_16x16x32_bf16 v[180:183], v[128:131], a[96:99], v[224:227]
    ds_read_b128 v[124:127], v231
    ds_read_b128 v[128:131], v228 offset:4096
    v_mfma_f32_16x16x32_bf16 v[180:183], v[132:135], a[100:103], v[180:183]
    v_exp_f32 v191, v191
    v_mfma_f32_16x16x32_bf16 v[180:183], v[136:139], a[104:107], v[180:183]
    v_cvt_pk_bf16_f32 v198, v188, v189
    v_cvt_pk_bf16_f32 v199, v190, v191
    v_mfma_f32_16x16x32_bf16 v[180:183], v[140:143], a[108:111], v[180:183]
    ds_read_b128 v[132:135], v229 offset:4096
    ds_read_b128 v[136:139], v230 offset:4096
    v_mfma_f32_16x16x32_bf16 v[80:83], v[144:147], v[196:199], v[80:83]
    v_exp_f32 v176, v176
    v_mfma_f32_16x16x32_bf16 v[84:87], v[148:151], v[196:199], v[84:87]
    ds_read_b128 v[140:143], v231 offset:4096
    v_mfma_f32_16x16x32_bf16 v[88:91], v[152:155], v[196:199], v[88:91]
    v_exp_f32 v177, v177
    v_mfma_f32_16x16x32_bf16 v[92:95], v[156:159], v[196:199], v[92:95]
    v_mfma_f32_16x16x32_bf16 a[192:195], v[160:163], v[196:199], a[192:195]
    v_exp_f32 v178, v178
    v_mfma_f32_16x16x32_bf16 a[196:199], v[164:167], v[196:199], a[196:199]
    s_waitcnt lgkmcnt(4)
    v_mfma_f32_16x16x32_bf16 a[200:203], v[168:171], v[196:199], a[200:203]
    v_exp_f32 v179, v179
    v_mfma_f32_16x16x32_bf16 a[204:207], v[172:175], v[196:199], a[204:207]
    v_cvt_pk_bf16_f32 v192, v176, v177
    v_cvt_pk_bf16_f32 v193, v178, v179
    v_mfma_f32_16x16x32_bf16 a[244:247], a[252:255], v[196:199], a[244:247]
    v_exp_f32 v180, v180
    v_mfma_f32_16x16x32_bf16 v[184:187], v[112:115], a[0:3], v[200:203]
    v_mfma_f32_16x16x32_bf16 v[184:187], v[116:119], a[4:7], v[184:187]
    v_exp_f32 v181, v181
    v_mfma_f32_16x16x32_bf16 v[184:187], v[120:123], a[8:11], v[184:187]
    s_waitcnt lgkmcnt(0)
    v_mfma_f32_16x16x32_bf16 v[184:187], v[124:127], a[12:15], v[184:187]
    v_exp_f32 v182, v182
    v_mfma_f32_16x16x32_bf16 v[188:191], v[128:131], a[0:3], v[200:203]
    v_mfma_f32_16x16x32_bf16 v[188:191], v[132:135], a[4:7], v[188:191]
    v_exp_f32 v183, v183
    v_mfma_f32_16x16x32_bf16 v[188:191], v[136:139], a[8:11], v[188:191]
    v_cvt_pk_bf16_f32 v194, v180, v181
    v_cvt_pk_bf16_f32 v195, v182, v183
    v_mfma_f32_16x16x32_bf16 v[188:191], v[140:143], a[12:15], v[188:191]
    v_mfma_f32_16x16x32_bf16 v[96:99], v[144:147], v[192:195], v[96:99]
    v_exp_f32 v184, v184
    v_mfma_f32_16x16x32_bf16 v[100:103], v[148:151], v[192:195], v[100:103]
    ds_read_b64_tr_b16 v[144:145], v232
    ds_read_b64_tr_b16 v[146:147], v232 offset:4096
    v_mfma_f32_16x16x32_bf16 v[104:107], v[152:155], v[192:195], v[104:107]
    v_exp_f32 v185, v185
    v_mfma_f32_16x16x32_bf16 v[108:111], v[156:159], v[192:195], v[108:111]
    ds_read_b64_tr_b16 v[148:149], v233
    ds_read_b64_tr_b16 v[150:151], v233 offset:4096
    v_mfma_f32_16x16x32_bf16 a[208:211], v[160:163], v[192:195], a[208:211]
    v_exp_f32 v186, v186
    v_mfma_f32_16x16x32_bf16 a[212:215], v[164:167], v[192:195], a[212:215]
    ds_read_b64_tr_b16 v[152:153], v234
    ds_read_b64_tr_b16 v[154:155], v234 offset:4096
    v_mfma_f32_16x16x32_bf16 a[216:219], v[168:171], v[192:195], a[216:219]
    v_exp_f32 v187, v187
    v_mfma_f32_16x16x32_bf16 a[220:223], v[172:175], v[192:195], a[220:223]
    v_cvt_pk_bf16_f32 v196, v184, v185
    v_cvt_pk_bf16_f32 v197, v186, v187
    v_mfma_f32_16x16x32_bf16 a[248:251], a[252:255], v[192:195], a[248:251]
    v_exp_f32 v188, v188
    v_mfma_f32_16x16x32_bf16 v[176:179], v[112:115], a[16:19], v[204:207]
    ds_read_b64_tr_b16 v[156:157], v235
    ds_read_b64_tr_b16 v[158:159], v235 offset:4096
    v_mfma_f32_16x16x32_bf16 v[176:179], v[116:119], a[20:23], v[176:179]
    v_exp_f32 v189, v189
    v_mfma_f32_16x16x32_bf16 v[176:179], v[120:123], a[24:27], v[176:179]
    ds_read_b64_tr_b16 v[160:161], v236
    ds_read_b64_tr_b16 v[162:163], v236 offset:4096
    v_mfma_f32_16x16x32_bf16 v[176:179], v[124:127], a[28:31], v[176:179]
    v_exp_f32 v190, v190
    v_mfma_f32_16x16x32_bf16 v[180:183], v[128:131], a[16:19], v[204:207]
    ds_read_b64_tr_b16 v[164:165], v237
    ds_read_b64_tr_b16 v[166:167], v237 offset:4096
    v_mfma_f32_16x16x32_bf16 v[180:183], v[132:135], a[20:23], v[180:183]
    v_exp_f32 v191, v191
    v_mfma_f32_16x16x32_bf16 v[180:183], v[136:139], a[24:27], v[180:183]
    v_cvt_pk_bf16_f32 v198, v188, v189
    v_cvt_pk_bf16_f32 v199, v190, v191
    v_mfma_f32_16x16x32_bf16 v[180:183], v[140:143], a[28:31], v[180:183]
    ds_read_b64_tr_b16 v[168:169], v238
    ds_read_b64_tr_b16 v[170:171], v238 offset:4096
    s_waitcnt lgkmcnt(6)
    v_mfma_f32_16x16x32_bf16 v[0:3], v[144:147], v[196:199], v[0:3]
    v_exp_f32 v176, v176
    v_mfma_f32_16x16x32_bf16 v[4:7], v[148:151], v[196:199], v[4:7]
    ds_read_b64_tr_b16 v[172:173], v239
    ds_read_b64_tr_b16 v[174:175], v239 offset:4096
    v_mfma_f32_16x16x32_bf16 v[8:11], v[152:155], v[196:199], v[8:11]
    v_exp_f32 v177, v177
    v_mfma_f32_16x16x32_bf16 v[12:15], v[156:159], v[196:199], v[12:15]
    s_waitcnt lgkmcnt(4)
    v_and_b32 v243, 63, v242
    v_lshlrev_b32 v244, 4, v243
    v_lshlrev_b32 v243, 2, v243
    s_xor_b32 s52, s36, 1
    v_mfma_f32_16x16x32_bf16 a[112:115], v[160:163], v[196:199], a[112:115]
    v_exp_f32 v178, v178
    v_mfma_f32_16x16x32_bf16 a[116:119], v[164:167], v[196:199], a[116:119]
    s_waitcnt lgkmcnt(0)
    s_mul_i32 s49, s52, 40960
    v_add_u32 v228, s49, v244
    s_add_u32 s49, s49, 28672
    v_mfma_f32_16x16x32_bf16 a[120:123], v[168:171], v[196:199], a[120:123]
    v_exp_f32 v179, v179
    v_mfma_f32_16x16x32_bf16 a[124:127], v[172:175], v[196:199], a[124:127]
    v_cvt_pk_bf16_f32 v192, v176, v177
    v_cvt_pk_bf16_f32 v193, v178, v179
    v_mfma_f32_16x16x32_bf16 a[224:227], a[252:255], v[196:199], a[224:227]
    v_exp_f32 v180, v180
    v_mfma_f32_16x16x32_bf16 v[184:187], v[112:115], a[32:35], v[208:211]
    v_add_u32 v229, s49, v243
    s_mul_i32 s49, s36, 40960
    v_add_u32 v230, s49, v244
    v_mfma_f32_16x16x32_bf16 v[184:187], v[116:119], a[36:39], v[184:187]
    v_exp_f32 v181, v181
    v_mfma_f32_16x16x32_bf16 v[184:187], v[120:123], a[40:43], v[184:187]
    s_add_u32 s49, s49, 28672
    v_add_u32 v231, s49, v243
    s_mul_i32 s49, s45, 14
    s_mul_i32 s50, s37, 7
    v_mfma_f32_16x16x32_bf16 v[184:187], v[124:127], a[44:47], v[184:187]
    v_exp_f32 v182, v182
    v_mfma_f32_16x16x32_bf16 v[188:191], v[128:131], a[32:35], v[208:211]
    s_add_u32 s49, s49, s50
    s_mul_i32 s49, s49, 131072
    s_lshl_b32 s50, s46, 1
    v_mfma_f32_16x16x32_bf16 v[188:191], v[132:135], a[36:39], v[188:191]
    v_exp_f32 v183, v183
    v_mfma_f32_16x16x32_bf16 v[188:191], v[136:139], a[40:43], v[188:191]
    v_cvt_pk_bf16_f32 v194, v180, v181
    v_cvt_pk_bf16_f32 v195, v182, v183
    v_mfma_f32_16x16x32_bf16 v[188:191], v[140:143], a[44:47], v[188:191]
    s_add_u32 s50, s50, s38
    s_lshl_b32 s50, s50, 11
    s_add_u32 s53, s49, s50
    s_barrier
    v_mfma_f32_16x16x32_bf16 v[16:19], v[144:147], v[192:195], v[16:19]
    v_exp_f32 v184, v184
    v_mfma_f32_16x16x32_bf16 v[20:23], v[148:151], v[192:195], v[20:23]
    ds_write_b128 v228, a[112:115] offset:0
    v_mfma_f32_16x16x32_bf16 v[24:27], v[152:155], v[192:195], v[24:27]
    v_exp_f32 v185, v185
    v_mfma_f32_16x16x32_bf16 v[28:31], v[156:159], v[192:195], v[28:31]
    ds_write_b128 v228, a[116:119] offset:1024
    v_mfma_f32_16x16x32_bf16 a[128:131], v[160:163], v[192:195], a[128:131]
    v_exp_f32 v186, v186
    v_mfma_f32_16x16x32_bf16 a[132:135], v[164:167], v[192:195], a[132:135]
    ds_write_b128 v228, a[120:123] offset:2048
    v_mfma_f32_16x16x32_bf16 a[136:139], v[168:171], v[192:195], a[136:139]
    v_exp_f32 v187, v187
    v_mfma_f32_16x16x32_bf16 a[140:143], v[172:175], v[192:195], a[140:143]
    v_cvt_pk_bf16_f32 v196, v184, v185
    v_cvt_pk_bf16_f32 v197, v186, v187
    ds_write_b128 v228, a[124:127] offset:3072
    v_mfma_f32_16x16x32_bf16 a[228:231], a[252:255], v[192:195], a[228:231]
    v_exp_f32 v188, v188
    ds_write_b32 v229, a224 offset:0
    v_mfma_f32_16x16x32_bf16 v[176:179], v[112:115], a[48:51], v[212:215]
    ds_write_b128 v228, a[128:131] offset:4096
    v_mfma_f32_16x16x32_bf16 v[176:179], v[116:119], a[52:55], v[176:179]
    v_exp_f32 v189, v189
    v_mfma_f32_16x16x32_bf16 v[176:179], v[120:123], a[56:59], v[176:179]
    ds_write_b128 v228, a[132:135] offset:5120
    v_mfma_f32_16x16x32_bf16 v[176:179], v[124:127], a[60:63], v[176:179]
    v_exp_f32 v190, v190
    v_mfma_f32_16x16x32_bf16 v[180:183], v[128:131], a[48:51], v[212:215]
    ds_write_b128 v228, a[136:139] offset:6144
    v_mfma_f32_16x16x32_bf16 v[180:183], v[132:135], a[52:55], v[180:183]
    v_exp_f32 v191, v191
    v_mfma_f32_16x16x32_bf16 v[180:183], v[136:139], a[56:59], v[180:183]
    v_cvt_pk_bf16_f32 v198, v188, v189
    v_cvt_pk_bf16_f32 v199, v190, v191
    ds_write_b128 v228, a[140:143] offset:7168
    v_mfma_f32_16x16x32_bf16 v[180:183], v[140:143], a[60:63], v[180:183]
    ds_write_b32 v229, a228 offset:256
    v_mfma_f32_16x16x32_bf16 v[32:35], v[144:147], v[196:199], v[32:35]
    v_exp_f32 v176, v176
    s_add_u32 s101, s59, 0
    s_add_u32 m0, s100, 32768
    v_mfma_f32_16x16x32_bf16 v[36:39], v[148:151], v[196:199], v[36:39]
    buffer_load_dwordx4 v245, s[16:19], s101 offen lds
    v_mfma_f32_16x16x32_bf16 v[40:43], v[152:155], v[196:199], v[40:43]
    v_exp_f32 v177, v177
    v_mfma_f32_16x16x32_bf16 v[44:47], v[156:159], v[196:199], v[44:47]
    v_mfma_f32_16x16x32_bf16 a[144:147], v[160:163], v[196:199], a[144:147]
    v_exp_f32 v178, v178
    v_mfma_f32_16x16x32_bf16 a[148:151], v[164:167], v[196:199], a[148:151]
    buffer_load_dwordx4 v246, s[16:19], s101 offen offset:1024 lds
    v_mfma_f32_16x16x32_bf16 a[152:155], v[168:171], v[196:199], a[152:155]
    v_exp_f32 v179, v179
    v_mfma_f32_16x16x32_bf16 a[156:159], v[172:175], v[196:199], a[156:159]
    v_cvt_pk_bf16_f32 v192, v176, v177
    v_cvt_pk_bf16_f32 v193, v178, v179
    v_mfma_f32_16x16x32_bf16 a[232:235], a[252:255], v[196:199], a[232:235]
    v_exp_f32 v180, v180
    v_mfma_f32_16x16x32_bf16 v[184:187], v[112:115], a[64:67], v[216:219]
    ds_write_b128 v228, a[144:147] offset:8192
    buffer_load_dwordx4 v247, s[16:19], s101 offen offset:2048 lds
    v_mfma_f32_16x16x32_bf16 v[184:187], v[116:119], a[68:71], v[184:187]
    v_exp_f32 v181, v181
    v_mfma_f32_16x16x32_bf16 v[184:187], v[120:123], a[72:75], v[184:187]
    ds_write_b128 v228, a[148:151] offset:9216
    v_mfma_f32_16x16x32_bf16 v[184:187], v[124:127], a[76:79], v[184:187]
    v_exp_f32 v182, v182
    v_mfma_f32_16x16x32_bf16 v[188:191], v[128:131], a[64:67], v[216:219]
    ds_write_b128 v228, a[152:155] offset:10240
    v_mfma_f32_16x16x32_bf16 v[188:191], v[132:135], a[68:71], v[188:191]
    v_exp_f32 v183, v183
    buffer_load_dwordx4 v248, s[16:19], s101 offen offset:3072 lds
    v_mfma_f32_16x16x32_bf16 v[188:191], v[136:139], a[72:75], v[188:191]
    v_cvt_pk_bf16_f32 v194, v180, v181
    v_cvt_pk_bf16_f32 v195, v182, v183
    ds_write_b128 v228, a[156:159] offset:11264
    v_mfma_f32_16x16x32_bf16 v[188:191], v[140:143], a[76:79], v[188:191]
    ds_write_b32 v229, a232 offset:512
    v_mfma_f32_16x16x32_bf16 v[48:51], v[144:147], v[192:195], v[48:51]
    v_exp_f32 v184, v184
    s_add_u32 s101, s59, 36864
    s_add_u32 m0, s100, 36864
    v_mfma_f32_16x16x32_bf16 v[52:55], v[148:151], v[192:195], v[52:55]
    buffer_load_dwordx4 v245, s[16:19], s101 offen lds
    v_mfma_f32_16x16x32_bf16 v[56:59], v[152:155], v[192:195], v[56:59]
    v_exp_f32 v185, v185
    v_mfma_f32_16x16x32_bf16 v[60:63], v[156:159], v[192:195], v[60:63]
    v_mfma_f32_16x16x32_bf16 a[160:163], v[160:163], v[192:195], a[160:163]
    v_exp_f32 v186, v186
    v_mfma_f32_16x16x32_bf16 a[164:167], v[164:167], v[192:195], a[164:167]
    buffer_load_dwordx4 v246, s[16:19], s101 offen offset:1024 lds
    v_mfma_f32_16x16x32_bf16 a[168:171], v[168:171], v[192:195], a[168:171]
    v_exp_f32 v187, v187
    v_mfma_f32_16x16x32_bf16 a[172:175], v[172:175], v[192:195], a[172:175]
    v_cvt_pk_bf16_f32 v196, v184, v185
    v_cvt_pk_bf16_f32 v197, v186, v187
    v_mfma_f32_16x16x32_bf16 a[236:239], a[252:255], v[192:195], a[236:239]
    v_exp_f32 v188, v188
    v_mfma_f32_16x16x32_bf16 v[176:179], v[112:115], a[80:83], v[220:223]
    ds_write_b128 v228, a[160:163] offset:12288
    buffer_load_dwordx4 v247, s[16:19], s101 offen offset:2048 lds
    v_mfma_f32_16x16x32_bf16 v[176:179], v[116:119], a[84:87], v[176:179]
    v_exp_f32 v189, v189
    v_mfma_f32_16x16x32_bf16 v[176:179], v[120:123], a[88:91], v[176:179]
    ds_write_b128 v228, a[164:167] offset:13312
    v_mfma_f32_16x16x32_bf16 v[176:179], v[124:127], a[92:95], v[176:179]
    v_exp_f32 v190, v190
    v_mfma_f32_16x16x32_bf16 v[180:183], v[128:131], a[80:83], v[220:223]
    ds_write_b128 v228, a[168:171] offset:14336
    v_mfma_f32_16x16x32_bf16 v[180:183], v[132:135], a[84:87], v[180:183]
    v_exp_f32 v191, v191
    buffer_load_dwordx4 v248, s[16:19], s101 offen offset:3072 lds
    v_mfma_f32_16x16x32_bf16 v[180:183], v[136:139], a[88:91], v[180:183]
    v_cvt_pk_bf16_f32 v198, v188, v189
    v_cvt_pk_bf16_f32 v199, v190, v191
    ds_write_b128 v228, a[172:175] offset:15360
    v_mfma_f32_16x16x32_bf16 v[180:183], v[140:143], a[92:95], v[180:183]
    ds_write_b32 v229, a236 offset:768
    v_mfma_f32_16x16x32_bf16 v[64:67], v[144:147], v[196:199], v[64:67]
    v_exp_f32 v176, v176
    v_mfma_f32_16x16x32_bf16 v[68:71], v[148:151], v[196:199], v[68:71]
    v_mfma_f32_16x16x32_bf16 v[72:75], v[152:155], v[196:199], v[72:75]
    v_exp_f32 v177, v177
    v_mfma_f32_16x16x32_bf16 v[76:79], v[156:159], v[196:199], v[76:79]
    v_mfma_f32_16x16x32_bf16 a[176:179], v[160:163], v[196:199], a[176:179]
    v_exp_f32 v178, v178
    v_mfma_f32_16x16x32_bf16 a[180:183], v[164:167], v[196:199], a[180:183]
    s_waitcnt lgkmcnt(0)
    v_mfma_f32_16x16x32_bf16 a[184:187], v[168:171], v[196:199], a[184:187]
    v_exp_f32 v179, v179
    v_mfma_f32_16x16x32_bf16 a[188:191], v[172:175], v[196:199], a[188:191]
    v_cvt_pk_bf16_f32 v192, v176, v177
    v_cvt_pk_bf16_f32 v193, v178, v179
    s_barrier
    v_mfma_f32_16x16x32_bf16 a[240:243], a[252:255], v[196:199], a[240:243]
    v_exp_f32 v180, v180
    v_mfma_f32_16x16x32_bf16 v[184:187], v[112:115], a[96:99], v[224:227]
    ds_write_b128 v228, a[176:179] offset:16384
    v_mfma_f32_16x16x32_bf16 v[184:187], v[116:119], a[100:103], v[184:187]
    v_exp_f32 v181, v181
    v_mfma_f32_16x16x32_bf16 v[184:187], v[120:123], a[104:107], v[184:187]
    ds_write_b128 v228, a[180:183] offset:17408
    v_mfma_f32_16x16x32_bf16 v[184:187], v[124:127], a[108:111], v[184:187]
    v_exp_f32 v182, v182
    v_mfma_f32_16x16x32_bf16 v[188:191], v[128:131], a[96:99], v[224:227]
    ds_write_b128 v228, a[184:187] offset:18432
    v_mfma_f32_16x16x32_bf16 v[188:191], v[132:135], a[100:103], v[188:191]
    v_exp_f32 v183, v183
    v_mfma_f32_16x16x32_bf16 v[188:191], v[136:139], a[104:107], v[188:191]
    v_cvt_pk_bf16_f32 v194, v180, v181
    v_cvt_pk_bf16_f32 v195, v182, v183
    ds_write_b128 v228, a[188:191] offset:19456
    v_mfma_f32_16x16x32_bf16 v[188:191], v[140:143], a[108:111], v[188:191]
    ds_write_b32 v229, a240 offset:1024
    v_mfma_f32_16x16x32_bf16 v[80:83], v[144:147], v[192:195], v[80:83]
    v_exp_f32 v184, v184
    v_exp_f32 v185, v185
    v_mfma_f32_16x16x32_bf16 v[84:87], v[148:151], v[192:195], v[84:87]
    v_exp_f32 v186, v186
    v_exp_f32 v187, v187
    v_mfma_f32_16x16x32_bf16 v[88:91], v[152:155], v[192:195], v[88:91]
    v_exp_f32 v188, v188
    v_exp_f32 v189, v189
    v_cvt_pk_bf16_f32 v196, v184, v185
    v_mfma_f32_16x16x32_bf16 v[92:95], v[156:159], v[192:195], v[92:95]
    v_exp_f32 v190, v190
    v_exp_f32 v191, v191
    v_cvt_pk_bf16_f32 v197, v186, v187
    v_mfma_f32_16x16x32_bf16 a[192:195], v[160:163], v[192:195], a[192:195]
    v_cvt_pk_bf16_f32 v198, v188, v189
    v_mfma_f32_16x16x32_bf16 a[196:199], v[164:167], v[192:195], a[196:199]
    v_cvt_pk_bf16_f32 v199, v190, v191
    v_mfma_f32_16x16x32_bf16 a[200:203], v[168:171], v[192:195], a[200:203]
    v_mfma_f32_16x16x32_bf16 a[204:207], v[172:175], v[192:195], a[204:207]
    v_mfma_f32_16x16x32_bf16 a[244:247], a[252:255], v[192:195], a[244:247]
    v_mfma_f32_16x16x32_bf16 v[96:99], v[144:147], v[196:199], v[96:99]
    v_mfma_f32_16x16x32_bf16 v[100:103], v[148:151], v[196:199], v[100:103]
    ds_write_b128 v228, a[192:195] offset:20480
    v_mfma_f32_16x16x32_bf16 v[104:107], v[152:155], v[196:199], v[104:107]
    v_mfma_f32_16x16x32_bf16 v[108:111], v[156:159], v[196:199], v[108:111]
    ds_write_b128 v228, a[196:199] offset:21504
    v_mfma_f32_16x16x32_bf16 a[208:211], v[160:163], v[196:199], a[208:211]
    ds_write_b128 v228, a[200:203] offset:22528
    v_mfma_f32_16x16x32_bf16 a[212:215], v[164:167], v[196:199], a[212:215]
    v_mfma_f32_16x16x32_bf16 a[216:219], v[168:171], v[196:199], a[216:219]
    ds_write_b128 v228, a[204:207] offset:23552
    v_mfma_f32_16x16x32_bf16 a[220:223], v[172:175], v[196:199], a[220:223]
    ds_write_b32 v229, a244 offset:1280
    v_mfma_f32_16x16x32_bf16 a[248:251], a[252:255], v[196:199], a[248:251]
    ds_read_b128 v[112:115], v230 offset:0
    ds_read_b128 v[116:119], v230 offset:1024
    ds_read_b128 v[120:123], v230 offset:2048
    ds_read_b128 v[124:127], v230 offset:3072
    ds_read_b32 v217, v231 offset:0
    ds_read_b128 v[128:131], v230 offset:4096
    ds_read_b128 v[132:135], v230 offset:5120
    ds_read_b128 v[136:139], v230 offset:6144
    ds_read_b128 v[140:143], v230 offset:7168
    ds_read_b32 v219, v231 offset:256
    s_nop 7
    ds_write_b128 v228, a[208:211] offset:24576
    ds_write_b128 v228, a[212:215] offset:25600
    ds_write_b128 v228, a[216:219] offset:26624
    ds_write_b128 v228, a[220:223] offset:27648
    ds_write_b32 v229, a248 offset:1536
    ds_read_b128 v[144:147], v230 offset:8192
    ds_read_b128 v[148:151], v230 offset:9216
    ds_read_b128 v[152:155], v230 offset:10240
    ds_read_b128 v[156:159], v230 offset:11264
    ds_read_b32 v221, v231 offset:512
    ds_read_b128 v[160:163], v230 offset:12288
    ds_read_b128 v[164:167], v230 offset:13312
    ds_read_b128 v[168:171], v230 offset:14336
    ds_read_b128 v[172:175], v230 offset:15360
    ds_read_b32 v223, v231 offset:768
    s_mov_b32 s49, 0x33800000
    s_mov_b32 s50, 0x1b000000
    v_accvgpr_read_b32 v176, a224
    v_accvgpr_read_b32 v177, a228
    v_accvgpr_read_b32 v178, a232
    v_accvgpr_read_b32 v179, a236
    v_accvgpr_read_b32 v180, a240
    v_accvgpr_read_b32 v181, a244
    v_accvgpr_read_b32 v182, a248
    v_subrev_u32 v184, s49, v176
    v_subrev_u32 v185, s49, v177
    v_max_u32 v184, v184, v185
    v_subrev_u32 v185, s49, v178
    v_max_u32 v184, v184, v185
    v_subrev_u32 v185, s49, v179
    v_max_u32 v184, v184, v185
    v_subrev_u32 v185, s49, v180
    v_max_u32 v184, v184, v185
    v_subrev_u32 v185, s49, v181
    v_max_u32 v184, v184, v185
    v_subrev_u32 v185, s49, v182
    v_max_u32 v184, v184, v185
    v_cmp_lt_u32 vcc, s50, v184
    s_lshl_b32 s52, s36, 2
    s_add_u32 s52, s52, 30720
    s_cmp_lg_u64 vcc, 0
    s_cselect_b32 s51, 1, 0
    v_mov_b32 v186, s51
    v_and_b32 v187, 3, v242
    v_mul_u32_u24 v187, 40960, v187
    v_add_u32 v187, s52, v187
    ds_write_b32 v187, v186
    s_waitcnt lgkmcnt(15)
    v_accvgpr_read_b32 v216, a224
    v_add_f32 v216, v216, v217
    s_add_u32 s101, s59, 73728
    s_add_u32 m0, s100, 0
    s_nop 0
    buffer_load_dwordx4 v245, s[16:19], s101 offen lds
    v_rcp_f32 v216, v216
    v_pk_add_f32 v[0:1], v[0:1], v[112:113]
    v_pk_add_f32 v[2:3], v[2:3], v[114:115]
    v_pk_add_f32 v[4:5], v[4:5], v[116:117]
    v_pk_add_f32 v[6:7], v[6:7], v[118:119]
    v_pk_add_f32 v[8:9], v[8:9], v[120:121]
    v_pk_add_f32 v[10:11], v[10:11], v[122:123]
    buffer_load_dwordx4 v246, s[16:19], s101 offen offset:1024 lds
    v_pk_add_f32 v[12:13], v[12:13], v[124:125]
    v_pk_add_f32 v[14:15], v[14:15], v[126:127]
    v_pk_mul_f32 v[0:1], v[0:1], v[216:217] op_sel:[0,0] op_sel_hi:[1,0]
    v_pk_mul_f32 v[2:3], v[2:3], v[216:217] op_sel:[0,0] op_sel_hi:[1,0]
    v_pk_mul_f32 v[4:5], v[4:5], v[216:217] op_sel:[0,0] op_sel_hi:[1,0]
    v_pk_mul_f32 v[6:7], v[6:7], v[216:217] op_sel:[0,0] op_sel_hi:[1,0]
    buffer_load_dwordx4 v247, s[16:19], s101 offen offset:2048 lds
    v_pk_mul_f32 v[8:9], v[8:9], v[216:217] op_sel:[0,0] op_sel_hi:[1,0]
    v_pk_mul_f32 v[10:11], v[10:11], v[216:217] op_sel:[0,0] op_sel_hi:[1,0]
    v_pk_mul_f32 v[12:13], v[12:13], v[216:217] op_sel:[0,0] op_sel_hi:[1,0]
    v_pk_mul_f32 v[14:15], v[14:15], v[216:217] op_sel:[0,0] op_sel_hi:[1,0]
    v_cvt_pk_bf16_f32 v0, v0, v1
    v_cvt_pk_bf16_f32 v1, v2, v3
    v_cvt_pk_bf16_f32 v2, v4, v5
    buffer_load_dwordx4 v248, s[16:19], s101 offen offset:3072 lds
    v_cvt_pk_bf16_f32 v3, v6, v7
    v_cvt_pk_bf16_f32 v4, v8, v9
    v_cvt_pk_bf16_f32 v5, v10, v11
    v_cvt_pk_bf16_f32 v6, v12, v13
    v_cvt_pk_bf16_f32 v7, v14, v15
    buffer_store_dwordx4 v[0:3], v244, s[32:35], s53 offen sc1
    v_accvgpr_read_b32 v218, a228
    v_add_f32 v218, v218, v219
    s_add_u32 s101, s59, 110592
    s_add_u32 m0, s100, 4096
    s_nop 0
    buffer_load_dwordx4 v245, s[16:19], s101 offen lds
    v_rcp_f32 v218, v218
    v_pk_add_f32 v[16:17], v[16:17], v[128:129]
    v_pk_add_f32 v[18:19], v[18:19], v[130:131]
    v_pk_add_f32 v[20:21], v[20:21], v[132:133]
    v_pk_add_f32 v[22:23], v[22:23], v[134:135]
    v_pk_add_f32 v[24:25], v[24:25], v[136:137]
    v_pk_add_f32 v[26:27], v[26:27], v[138:139]
    buffer_load_dwordx4 v246, s[16:19], s101 offen offset:1024 lds
    v_pk_add_f32 v[28:29], v[28:29], v[140:141]
    v_pk_add_f32 v[30:31], v[30:31], v[142:143]
    v_pk_mul_f32 v[16:17], v[16:17], v[218:219] op_sel:[0,0] op_sel_hi:[1,0]
    v_pk_mul_f32 v[18:19], v[18:19], v[218:219] op_sel:[0,0] op_sel_hi:[1,0]
    v_pk_mul_f32 v[20:21], v[20:21], v[218:219] op_sel:[0,0] op_sel_hi:[1,0]
    v_pk_mul_f32 v[22:23], v[22:23], v[218:219] op_sel:[0,0] op_sel_hi:[1,0]
    v_pk_mul_f32 v[24:25], v[24:25], v[218:219] op_sel:[0,0] op_sel_hi:[1,0]
    buffer_load_dwordx4 v247, s[16:19], s101 offen offset:2048 lds
    v_pk_mul_f32 v[26:27], v[26:27], v[218:219] op_sel:[0,0] op_sel_hi:[1,0]
    v_pk_mul_f32 v[28:29], v[28:29], v[218:219] op_sel:[0,0] op_sel_hi:[1,0]
    v_pk_mul_f32 v[30:31], v[30:31], v[218:219] op_sel:[0,0] op_sel_hi:[1,0]
    v_cvt_pk_bf16_f32 v8, v16, v17
    v_cvt_pk_bf16_f32 v9, v18, v19
    v_cvt_pk_bf16_f32 v10, v20, v21
    v_cvt_pk_bf16_f32 v11, v22, v23
    buffer_load_dwordx4 v248, s[16:19], s101 offen offset:3072 lds
    v_cvt_pk_bf16_f32 v12, v24, v25
    v_cvt_pk_bf16_f32 v13, v26, v27
    v_cvt_pk_bf16_f32 v14, v28, v29
    v_cvt_pk_bf16_f32 v15, v30, v31
    buffer_store_dwordx4 v[4:7], v244, s[32:35], s53 offen offset:1024 sc1
    s_add_u32 s53, s53, 131072
    s_waitcnt lgkmcnt(6)
    v_accvgpr_read_b32 v220, a232
    v_add_f32 v220, v220, v221
    s_add_u32 s101, s59, 147456
    s_add_u32 m0, s100, 8192
    s_nop 0
    buffer_load_dwordx4 v245, s[16:19], s101 offen lds
    v_rcp_f32 v220, v220
    v_pk_add_f32 v[32:33], v[32:33], v[144:145]
    v_pk_add_f32 v[34:35], v[34:35], v[146:147]
    v_pk_add_f32 v[36:37], v[36:37], v[148:149]
    v_pk_add_f32 v[38:39], v[38:39], v[150:151]
    v_pk_add_f32 v[40:41], v[40:41], v[152:153]
    v_pk_add_f32 v[42:43], v[42:43], v[154:155]
    buffer_load_dwordx4 v246, s[16:19], s101 offen offset:1024 lds
    v_pk_add_f32 v[44:45], v[44:45], v[156:157]
    v_pk_add_f32 v[46:47], v[46:47], v[158:159]
    v_pk_mul_f32 v[32:33], v[32:33], v[220:221] op_sel:[0,0] op_sel_hi:[1,0]
    v_pk_mul_f32 v[34:35], v[34:35], v[220:221] op_sel:[0,0] op_sel_hi:[1,0]
    v_pk_mul_f32 v[36:37], v[36:37], v[220:221] op_sel:[0,0] op_sel_hi:[1,0]
    v_pk_mul_f32 v[38:39], v[38:39], v[220:221] op_sel:[0,0] op_sel_hi:[1,0]
    v_pk_mul_f32 v[40:41], v[40:41], v[220:221] op_sel:[0,0] op_sel_hi:[1,0]
    buffer_load_dwordx4 v247, s[16:19], s101 offen offset:2048 lds
    v_pk_mul_f32 v[42:43], v[42:43], v[220:221] op_sel:[0,0] op_sel_hi:[1,0]
    v_pk_mul_f32 v[44:45], v[44:45], v[220:221] op_sel:[0,0] op_sel_hi:[1,0]
    v_pk_mul_f32 v[46:47], v[46:47], v[220:221] op_sel:[0,0] op_sel_hi:[1,0]
    v_cvt_pk_bf16_f32 v16, v32, v33
    v_cvt_pk_bf16_f32 v17, v34, v35
    v_cvt_pk_bf16_f32 v18, v36, v37
    v_cvt_pk_bf16_f32 v19, v38, v39
    buffer_load_dwordx4 v248, s[16:19], s101 offen offset:3072 lds
    v_cvt_pk_bf16_f32 v20, v40, v41
    v_cvt_pk_bf16_f32 v21, v42, v43
    v_cvt_pk_bf16_f32 v22, v44, v45
    v_cvt_pk_bf16_f32 v23, v46, v47
    buffer_store_dwordx4 v[8:11], v244, s[32:35], s53 offen sc1
    buffer_store_dwordx4 v[12:15], v244, s[32:35], s53 offen offset:1024 sc1
    s_add_u32 s53, s53, 131072
    s_waitcnt lgkmcnt(1)
    v_accvgpr_read_b32 v222, a236
    v_add_f32 v222, v222, v223
    s_add_u32 s101, s59, 184320
    s_add_u32 m0, s100, 12288
    s_nop 0
    buffer_load_dwordx4 v245, s[16:19], s101 offen lds
    v_rcp_f32 v222, v222
    v_pk_add_f32 v[48:49], v[48:49], v[160:161]
    v_pk_add_f32 v[50:51], v[50:51], v[162:163]
    v_pk_add_f32 v[52:53], v[52:53], v[164:165]
    v_pk_add_f32 v[54:55], v[54:55], v[166:167]
    v_pk_add_f32 v[56:57], v[56:57], v[168:169]
    v_pk_add_f32 v[58:59], v[58:59], v[170:171]
    buffer_load_dwordx4 v246, s[16:19], s101 offen offset:1024 lds
    v_pk_add_f32 v[60:61], v[60:61], v[172:173]
    v_pk_add_f32 v[62:63], v[62:63], v[174:175]
    v_pk_mul_f32 v[48:49], v[48:49], v[222:223] op_sel:[0,0] op_sel_hi:[1,0]
    v_pk_mul_f32 v[50:51], v[50:51], v[222:223] op_sel:[0,0] op_sel_hi:[1,0]
    v_pk_mul_f32 v[52:53], v[52:53], v[222:223] op_sel:[0,0] op_sel_hi:[1,0]
    v_pk_mul_f32 v[54:55], v[54:55], v[222:223] op_sel:[0,0] op_sel_hi:[1,0]
    buffer_load_dwordx4 v247, s[16:19], s101 offen offset:2048 lds
    v_pk_mul_f32 v[56:57], v[56:57], v[222:223] op_sel:[0,0] op_sel_hi:[1,0]
    v_pk_mul_f32 v[58:59], v[58:59], v[222:223] op_sel:[0,0] op_sel_hi:[1,0]
    v_pk_mul_f32 v[60:61], v[60:61], v[222:223] op_sel:[0,0] op_sel_hi:[1,0]
    v_pk_mul_f32 v[62:63], v[62:63], v[222:223] op_sel:[0,0] op_sel_hi:[1,0]
    v_cvt_pk_bf16_f32 v24, v48, v49
    v_cvt_pk_bf16_f32 v25, v50, v51
    v_cvt_pk_bf16_f32 v26, v52, v53
    buffer_load_dwordx4 v248, s[16:19], s101 offen offset:3072 lds
    v_cvt_pk_bf16_f32 v27, v54, v55
    v_cvt_pk_bf16_f32 v28, v56, v57
    v_cvt_pk_bf16_f32 v29, v58, v59
    v_cvt_pk_bf16_f32 v30, v60, v61
    v_cvt_pk_bf16_f32 v31, v62, v63
    buffer_store_dwordx4 v[16:19], v244, s[32:35], s53 offen sc1
    s_waitcnt lgkmcnt(0)
    s_barrier
    s_mul_i32 s49, s36, 40960
    s_add_u32 s49, s49, 30720
    v_mov_b32 v187, s49
    ds_read_b128 v[196:199], v187
    ds_read_b128 v[112:115], v230 offset:16384
    ds_read_b128 v[116:119], v230 offset:17408
    ds_read_b128 v[120:123], v230 offset:18432
    ds_read_b128 v[124:127], v230 offset:19456
    ds_read_b32 v217, v231 offset:1024
    ds_read_b128 v[128:131], v230 offset:20480
    ds_read_b128 v[132:135], v230 offset:21504
    ds_read_b128 v[136:139], v230 offset:22528
    ds_read_b128 v[140:143], v230 offset:23552
    ds_read_b32 v219, v231 offset:1280
    ds_read_b128 v[144:147], v230 offset:24576
    ds_read_b128 v[148:151], v230 offset:25600
    ds_read_b128 v[152:155], v230 offset:26624
    ds_read_b128 v[156:159], v230 offset:27648
    ds_read_b32 v221, v231 offset:1536
    s_waitcnt lgkmcnt(15)
    v_or_b32 v196, v196, v197
    v_or_b32 v198, v198, v199
    v_or_b32 v196, v196, v198
    s_nop 1
    v_readfirstlane_b32 s49, v196
    s_xor_b32 s50, s48, 1
    s_and_b32 s49, s49, s50
    s_cmp_lg_u32 s49, 0
    s_cbranch_scc1 A_SLOW
    s_waitcnt lgkmcnt(10)
    v_accvgpr_read_b32 v216, a240
    v_add_f32 v216, v216, v217
    s_add_u32 s101, s59, 221184
    s_add_u32 m0, s100, 16384
    s_nop 0
    buffer_load_dwordx4 v245, s[16:19], s101 offen lds
    v_rcp_f32 v216, v216
    v_pk_add_f32 v[64:65], v[64:65], v[112:113]
    v_pk_add_f32 v[66:67], v[66:67], v[114:115]
    v_pk_add_f32 v[68:69], v[68:69], v[116:117]
    v_pk_add_f32 v[70:71], v[70:71], v[118:119]
    v_pk_add_f32 v[72:73], v[72:73], v[120:121]
    v_pk_add_f32 v[74:75], v[74:75], v[122:123]
    buffer_load_dwordx4 v246, s[16:19], s101 offen offset:1024 lds
    v_pk_add_f32 v[76:77], v[76:77], v[124:125]
    v_pk_add_f32 v[78:79], v[78:79], v[126:127]
    v_pk_mul_f32 v[64:65], v[64:65], v[216:217] op_sel:[0,0] op_sel_hi:[1,0]
    v_pk_mul_f32 v[66:67], v[66:67], v[216:217] op_sel:[0,0] op_sel_hi:[1,0]
    v_pk_mul_f32 v[68:69], v[68:69], v[216:217] op_sel:[0,0] op_sel_hi:[1,0]
    v_pk_mul_f32 v[70:71], v[70:71], v[216:217] op_sel:[0,0] op_sel_hi:[1,0]
    v_pk_mul_f32 v[72:73], v[72:73], v[216:217] op_sel:[0,0] op_sel_hi:[1,0]
    buffer_load_dwordx4 v247, s[16:19], s101 offen offset:2048 lds
    v_pk_mul_f32 v[74:75], v[74:75], v[216:217] op_sel:[0,0] op_sel_hi:[1,0]
    v_pk_mul_f32 v[76:77], v[76:77], v[216:217] op_sel:[0,0] op_sel_hi:[1,0]
    v_pk_mul_f32 v[78:79], v[78:79], v[216:217] op_sel:[0,0] op_sel_hi:[1,0]
    v_cvt_pk_bf16_f32 v32, v64, v65
    v_cvt_pk_bf16_f32 v33, v66, v67
    v_cvt_pk_bf16_f32 v34, v68, v69
    v_cvt_pk_bf16_f32 v35, v70, v71
    buffer_load_dwordx4 v248, s[16:19], s101 offen offset:3072 lds
    v_cvt_pk_bf16_f32 v36, v72, v73
    v_cvt_pk_bf16_f32 v37, v74, v75
    v_cvt_pk_bf16_f32 v38, v76, v77
    v_cvt_pk_bf16_f32 v39, v78, v79
    buffer_store_dwordx4 v[20:23], v244, s[32:35], s53 offen offset:1024 sc1
    s_add_u32 s53, s53, 131072
    buffer_store_dwordx4 v[24:27], v244, s[32:35], s53 offen sc1
    s_waitcnt lgkmcnt(5)
    v_accvgpr_read_b32 v218, a244
    v_add_f32 v218, v218, v219
    s_add_u32 s101, s59, 258048
    s_add_u32 m0, s100, 20480
    s_nop 0
    buffer_load_dwordx4 v245, s[16:19], s101 offen lds
    v_rcp_f32 v218, v218
    v_pk_add_f32 v[80:81], v[80:81], v[128:129]
    v_pk_add_f32 v[82:83], v[82:83], v[130:131]
    v_pk_add_f32 v[84:85], v[84:85], v[132:133]
    v_pk_add_f32 v[86:87], v[86:87], v[134:135]
    v_pk_add_f32 v[88:89], v[88:89], v[136:137]
    v_pk_add_f32 v[90:91], v[90:91], v[138:139]
    buffer_load_dwordx4 v246, s[16:19], s101 offen offset:1024 lds
    v_pk_add_f32 v[92:93], v[92:93], v[140:141]
    v_pk_add_f32 v[94:95], v[94:95], v[142:143]
    v_pk_mul_f32 v[80:81], v[80:81], v[218:219] op_sel:[0,0] op_sel_hi:[1,0]
    v_pk_mul_f32 v[82:83], v[82:83], v[218:219] op_sel:[0,0] op_sel_hi:[1,0]
    v_pk_mul_f32 v[84:85], v[84:85], v[218:219] op_sel:[0,0] op_sel_hi:[1,0]
    v_pk_mul_f32 v[86:87], v[86:87], v[218:219] op_sel:[0,0] op_sel_hi:[1,0]
    v_pk_mul_f32 v[88:89], v[88:89], v[218:219] op_sel:[0,0] op_sel_hi:[1,0]
    buffer_load_dwordx4 v247, s[16:19], s101 offen offset:2048 lds
    v_pk_mul_f32 v[90:91], v[90:91], v[218:219] op_sel:[0,0] op_sel_hi:[1,0]
    v_pk_mul_f32 v[92:93], v[92:93], v[218:219] op_sel:[0,0] op_sel_hi:[1,0]
    v_pk_mul_f32 v[94:95], v[94:95], v[218:219] op_sel:[0,0] op_sel_hi:[1,0]
    v_cvt_pk_bf16_f32 v40, v80, v81
    v_cvt_pk_bf16_f32 v41, v82, v83
    v_cvt_pk_bf16_f32 v42, v84, v85
    v_cvt_pk_bf16_f32 v43, v86, v87
    buffer_load_dwordx4 v248, s[16:19], s101 offen offset:3072 lds
    v_cvt_pk_bf16_f32 v44, v88, v89
    v_cvt_pk_bf16_f32 v45, v90, v91
    v_cvt_pk_bf16_f32 v46, v92, v93
    v_cvt_pk_bf16_f32 v47, v94, v95
    buffer_store_dwordx4 v[28:31], v244, s[32:35], s53 offen offset:1024 sc1
    s_add_u32 s53, s53, 131072
    s_waitcnt lgkmcnt(0)
    v_accvgpr_read_b32 v220, a248
    v_add_f32 v220, v220, v221
    s_add_u32 s101, s59, 294912
    s_add_u32 m0, s100, 24576
    s_nop 0
    buffer_load_dwordx4 v245, s[16:19], s101 offen lds
    v_rcp_f32 v220, v220
    v_pk_add_f32 v[96:97], v[96:97], v[144:145]
    v_pk_add_f32 v[98:99], v[98:99], v[146:147]
    v_pk_add_f32 v[100:101], v[100:101], v[148:149]
    buffer_load_dwordx4 v246, s[16:19], s101 offen offset:1024 lds
    v_pk_add_f32 v[102:103], v[102:103], v[150:151]
    v_pk_add_f32 v[104:105], v[104:105], v[152:153]
    v_pk_add_f32 v[106:107], v[106:107], v[154:155]
    buffer_load_dwordx4 v247, s[16:19], s101 offen offset:2048 lds
    v_pk_add_f32 v[108:109], v[108:109], v[156:157]
    v_pk_add_f32 v[110:111], v[110:111], v[158:159]
    v_pk_mul_f32 v[96:97], v[96:97], v[220:221] op_sel:[0,0] op_sel_hi:[1,0]
    v_pk_mul_f32 v[98:99], v[98:99], v[220:221] op_sel:[0,0] op_sel_hi:[1,0]
    buffer_load_dwordx4 v248, s[16:19], s101 offen offset:3072 lds
    v_pk_mul_f32 v[100:101], v[100:101], v[220:221] op_sel:[0,0] op_sel_hi:[1,0]
    v_pk_mul_f32 v[102:103], v[102:103], v[220:221] op_sel:[0,0] op_sel_hi:[1,0]
    v_pk_mul_f32 v[104:105], v[104:105], v[220:221] op_sel:[0,0] op_sel_hi:[1,0]
    s_add_u32 s101, s59, 331776
    s_add_u32 m0, s100, 28672
    s_nop 0
    buffer_load_dwordx4 v245, s[16:19], s101 offen lds
    v_pk_mul_f32 v[106:107], v[106:107], v[220:221] op_sel:[0,0] op_sel_hi:[1,0]
    v_pk_mul_f32 v[108:109], v[108:109], v[220:221] op_sel:[0,0] op_sel_hi:[1,0]
    v_pk_mul_f32 v[110:111], v[110:111], v[220:221] op_sel:[0,0] op_sel_hi:[1,0]
    v_cvt_pk_bf16_f32 v48, v96, v97
    buffer_load_dwordx4 v246, s[16:19], s101 offen offset:1024 lds
    v_cvt_pk_bf16_f32 v49, v98, v99
    v_cvt_pk_bf16_f32 v50, v100, v101
    v_cvt_pk_bf16_f32 v51, v102, v103
    buffer_load_dwordx4 v247, s[16:19], s101 offen offset:2048 lds
    v_cvt_pk_bf16_f32 v52, v104, v105
    v_cvt_pk_bf16_f32 v53, v106, v107
    v_cvt_pk_bf16_f32 v54, v108, v109
    v_cvt_pk_bf16_f32 v55, v110, v111
    buffer_load_dwordx4 v248, s[16:19], s101 offen offset:3072 lds
    buffer_store_dwordx4 v[32:35], v244, s[32:35], s53 offen sc1
    buffer_store_dwordx4 v[36:39], v244, s[32:35], s53 offen offset:1024 sc1
    s_add_u32 s53, s53, 131072
    s_waitcnt vmcnt(50)
    v_add_u32 v253, 131072, v244
    v_add_u32 v254, 262144, v244
    v_add_u32 v255, 393216, v244
    s_waitcnt vmcnt(46)
    ds_read_b64_tr_b16 a[0:1], v249 offset:32768
    ds_read_b64_tr_b16 a[2:3], v249 offset:34816
    ds_read_b64_tr_b16 a[4:5], v250 offset:32768
    ds_read_b64_tr_b16 a[6:7], v250 offset:34816
    ds_read_b64_tr_b16 a[8:9], v251 offset:32768
    ds_read_b64_tr_b16 a[10:11], v251 offset:34816
    ds_read_b64_tr_b16 a[12:13], v252 offset:32768
    ds_read_b64_tr_b16 a[14:15], v252 offset:34816
    buffer_store_dwordx4 v[40:43], v244, s[32:35], s53 offen sc1
    s_waitcnt vmcnt(43)
    ds_read_b64_tr_b16 a[16:17], v249 offset:36864
    ds_read_b64_tr_b16 a[18:19], v249 offset:38912
    ds_read_b64_tr_b16 a[20:21], v250 offset:36864
    ds_read_b64_tr_b16 a[22:23], v250 offset:38912
    ds_read_b64_tr_b16 a[24:25], v251 offset:36864
    ds_read_b64_tr_b16 a[26:27], v251 offset:38912
    ds_read_b64_tr_b16 a[28:29], v252 offset:36864
    ds_read_b64_tr_b16 a[30:31], v252 offset:38912
    s_waitcnt lgkmcnt(8)
    s_add_u32 s101, s59, 368640
    s_add_u32 m0, s100, 32768
    s_nop 0
    buffer_load_dwordx4 v245, s[16:19], s101 offen lds
    buffer_load_dwordx4 v246, s[16:19], s101 offen offset:1024 lds
    buffer_load_dwordx4 v247, s[16:19], s101 offen offset:2048 lds
    buffer_load_dwordx4 v248, s[16:19], s101 offen offset:3072 lds
    buffer_store_dwordx4 v[44:47], v244, s[32:35], s53 offen offset:1024 sc1
    s_add_u32 s53, s53, 131072
    s_waitcnt vmcnt(44)
    ds_read_b64_tr_b16 a[32:33], v249 offset:0
    ds_read_b64_tr_b16 a[34:35], v249 offset:2048
    ds_read_b64_tr_b16 a[36:37], v250 offset:0
    ds_read_b64_tr_b16 a[38:39], v250 offset:2048
    ds_read_b64_tr_b16 a[40:41], v251 offset:0
    ds_read_b64_tr_b16 a[42:43], v251 offset:2048
    ds_read_b64_tr_b16 a[44:45], v252 offset:0
    ds_read_b64_tr_b16 a[46:47], v252 offset:2048
    s_waitcnt lgkmcnt(8)
    s_add_u32 s101, s59, 405504
    s_add_u32 m0, s100, 36864
    s_nop 0
    buffer_load_dwordx4 v245, s[16:19], s101 offen lds
    buffer_load_dwordx4 v246, s[16:19], s101 offen offset:1024 lds
    buffer_load_dwordx4 v247, s[16:19], s101 offen offset:2048 lds
    buffer_load_dwordx4 v248, s[16:19], s101 offen offset:3072 lds
    buffer_store_dwordx4 v[48:51], v244, s[32:35], s53 offen sc1
    s_waitcnt vmcnt(44)
    ds_read_b64_tr_b16 a[48:49], v249 offset:4096
    ds_read_b64_tr_b16 a[50:51], v249 offset:6144
    ds_read_b64_tr_b16 a[52:53], v250 offset:4096
    ds_read_b64_tr_b16 a[54:55], v250 offset:6144
    ds_read_b64_tr_b16 a[56:57], v251 offset:4096
    ds_read_b64_tr_b16 a[58:59], v251 offset:6144
    ds_read_b64_tr_b16 a[60:61], v252 offset:4096
    ds_read_b64_tr_b16 a[62:63], v252 offset:6144
    s_waitcnt lgkmcnt(8)
    s_add_u32 s101, s59, 442368
    s_add_u32 m0, s100, 0
    s_nop 0
    buffer_load_dwordx4 v245, s[16:19], s101 offen lds
    buffer_load_dwordx4 v246, s[16:19], s101 offen offset:1024 lds
    buffer_load_dwordx4 v247, s[16:19], s101 offen offset:2048 lds
    buffer_load_dwordx4 v248, s[16:19], s101 offen offset:3072 lds
    buffer_store_dwordx4 v[52:55], v244, s[32:35], s53 offen offset:1024 sc1
    s_add_u32 s53, s53, 131072
    s_waitcnt vmcnt(44)
    ds_read_b64_tr_b16 a[64:65], v249 offset:8192
    ds_read_b64_tr_b16 a[66:67], v249 offset:10240
    ds_read_b64_tr_b16 a[68:69], v250 offset:8192
    ds_read_b64_tr_b16 a[70:71], v250 offset:10240
    ds_read_b64_tr_b16 a[72:73], v251 offset:8192
    ds_read_b64_tr_b16 a[74:75], v251 offset:10240
    ds_read_b64_tr_b16 a[76:77], v252 offset:8192
    ds_read_b64_tr_b16 a[78:79], v252 offset:10240
    s_waitcnt lgkmcnt(8)
    s_add_u32 s101, s59, 479232
    s_add_u32 m0, s100, 4096
    s_nop 0
    buffer_load_dwordx4 v245, s[16:19], s101 offen lds
    buffer_load_dwordx4 v246, s[16:19], s101 offen offset:1024 lds
    buffer_load_dwordx4 v247, s[16:19], s101 offen offset:2048 lds
    buffer_load_dwordx4 v248, s[16:19], s101 offen offset:3072 lds
    s_waitcnt vmcnt(42)
    ds_read_b64_tr_b16 a[80:81], v249 offset:12288
    ds_read_b64_tr_b16 a[82:83], v249 offset:14336
    ds_read_b64_tr_b16 a[84:85], v250 offset:12288
    ds_read_b64_tr_b16 a[86:87], v250 offset:14336
    ds_read_b64_tr_b16 a[88:89], v251 offset:12288
    ds_read_b64_tr_b16 a[90:91], v251 offset:14336
    ds_read_b64_tr_b16 a[92:93], v252 offset:12288
    ds_read_b64_tr_b16 a[94:95], v252 offset:14336
    s_waitcnt lgkmcnt(8)
    s_add_u32 s101, s59, 516096
    s_add_u32 m0, s100, 8192
    s_nop 0
    buffer_load_dwordx4 v245, s[16:19], s101 offen lds
    buffer_load_dwordx4 v246, s[16:19], s101 offen offset:1024 lds
    buffer_load_dwordx4 v247, s[16:19], s101 offen offset:2048 lds
    buffer_load_dwordx4 v248, s[16:19], s101 offen offset:3072 lds
    s_waitcnt vmcnt(8)
    s_barrier
    s_cmp_lg_u32 s36, 0
    s_cbranch_scc1 B_PUB
    s_lshl_b32 s49, s45, 5
    v_mov_b32 v176, s49
    v_mov_b32 v177, 1
    s_mov_b64 exec, 1
    global_atomic_add v176, v177, s[8:9]
    s_mov_b64 exec, -1
B_PUB:
    s_cmp_eq_u32 s58, 15
    s_cbranch_scc1 A_END
    ds_read_b64_tr_b16 a[96:97], v249 offset:16384
    ds_read_b64_tr_b16 a[98:99], v249 offset:18432
    ds_read_b64_tr_b16 a[100:101], v250 offset:16384
    ds_read_b64_tr_b16 a[102:103], v250 offset:18432
    ds_read_b64_tr_b16 a[104:105], v251 offset:16384
    ds_read_b64_tr_b16 a[106:107], v251 offset:18432
    ds_read_b64_tr_b16 a[108:109], v252 offset:16384
    ds_read_b64_tr_b16 a[110:111], v252 offset:18432
    s_waitcnt lgkmcnt(8)
    s_add_u32 s101, s59, 552960
    s_add_u32 m0, s100, 12288
    s_nop 0
    buffer_load_dwordx4 v245, s[16:19], s101 offen lds
    buffer_load_dwordx4 v246, s[16:19], s101 offen offset:1024 lds
    buffer_load_dwordx4 v247, s[16:19], s101 offen offset:2048 lds
    buffer_load_dwordx4 v248, s[16:19], s101 offen offset:3072 lds
    ds_read_b64_tr_b16 a[112:113], v249 offset:20480
    ds_read_b64_tr_b16 a[114:115], v249 offset:22528
    ds_read_b64_tr_b16 a[116:117], v250 offset:20480
    ds_read_b64_tr_b16 a[118:119], v250 offset:22528
    ds_read_b64_tr_b16 a[120:121], v251 offset:20480
    ds_read_b64_tr_b16 a[122:123], v251 offset:22528
    ds_read_b64_tr_b16 a[124:125], v252 offset:20480
    ds_read_b64_tr_b16 a[126:127], v252 offset:22528
    s_waitcnt lgkmcnt(8)
    s_add_u32 s101, s59, 589824
    s_add_u32 m0, s100, 16384
    s_nop 0
    buffer_load_dwordx4 v245, s[16:19], s101 offen lds
    buffer_load_dwordx4 v246, s[16:19], s101 offen offset:1024 lds
    buffer_load_dwordx4 v247, s[16:19], s101 offen offset:2048 lds
    buffer_load_dwordx4 v248, s[16:19], s101 offen offset:3072 lds
    ds_read_b64_tr_b16 a[128:129], v249 offset:24576
    ds_read_b64_tr_b16 a[130:131], v249 offset:26624
    ds_read_b64_tr_b16 a[132:133], v250 offset:24576
    ds_read_b64_tr_b16 a[134:135], v250 offset:26624
    ds_read_b64_tr_b16 a[136:137], v251 offset:24576
    ds_read_b64_tr_b16 a[138:139], v251 offset:26624
    ds_read_b64_tr_b16 a[140:141], v252 offset:24576
    ds_read_b64_tr_b16 a[142:143], v252 offset:26624
    s_waitcnt lgkmcnt(8)
    s_add_u32 s101, s59, 626688
    s_add_u32 m0, s100, 20480
    s_nop 0
    buffer_load_dwordx4 v245, s[16:19], s101 offen lds
    buffer_load_dwordx4 v246, s[16:19], s101 offen offset:1024 lds
    buffer_load_dwordx4 v247, s[16:19], s101 offen offset:2048 lds
    buffer_load_dwordx4 v248, s[16:19], s101 offen offset:3072 lds
    ds_read_b64_tr_b16 a[144:145], v249 offset:28672
    ds_read_b64_tr_b16 a[146:147], v249 offset:30720
    ds_read_b64_tr_b16 a[148:149], v250 offset:28672
    ds_read_b64_tr_b16 a[150:151], v250 offset:30720
    ds_read_b64_tr_b16 a[152:153], v251 offset:28672
    ds_read_b64_tr_b16 a[154:155], v251 offset:30720
    ds_read_b64_tr_b16 a[156:157], v252 offset:28672
    ds_read_b64_tr_b16 a[158:159], v252 offset:30720
    s_waitcnt lgkmcnt(8)
    s_add_u32 s101, s59, 663552
    s_add_u32 m0, s100, 24576
    s_nop 0
    buffer_load_dwordx4 v245, s[16:19], s101 offen lds
    buffer_load_dwordx4 v246, s[16:19], s101 offen offset:1024 lds
    buffer_load_dwordx4 v247, s[16:19], s101 offen offset:2048 lds
    buffer_load_dwordx4 v248, s[16:19], s101 offen offset:3072 lds
    ds_read_b64_tr_b16 a[160:161], v249 offset:32768
    ds_read_b64_tr_b16 a[162:163], v249 offset:34816
    ds_read_b64_tr_b16 a[164:165], v250 offset:32768
    ds_read_b64_tr_b16 a[166:167], v250 offset:34816
    ds_read_b64_tr_b16 a[168:169], v251 offset:32768
    ds_read_b64_tr_b16 a[170:171], v251 offset:34816
    ds_read_b64_tr_b16 a[172:173], v252 offset:32768
    ds_read_b64_tr_b16 a[174:175], v252 offset:34816
    s_waitcnt lgkmcnt(8)
    s_add_u32 s101, s59, 700416
    s_add_u32 m0, s100, 28672
    s_nop 0
    buffer_load_dwordx4 v245, s[16:19], s101 offen lds
    buffer_load_dwordx4 v246, s[16:19], s101 offen offset:1024 lds
    buffer_load_dwordx4 v247, s[16:19], s101 offen offset:2048 lds
    buffer_load_dwordx4 v248, s[16:19], s101 offen offset:3072 lds
    ds_read_b64_tr_b16 a[176:177], v249 offset:36864
    ds_read_b64_tr_b16 a[178:179], v249 offset:38912
    ds_read_b64_tr_b16 a[180:181], v250 offset:36864
    ds_read_b64_tr_b16 a[182:183], v250 offset:38912
    ds_read_b64_tr_b16 a[184:185], v251 offset:36864
    ds_read_b64_tr_b16 a[186:187], v251 offset:38912
    ds_read_b64_tr_b16 a[188:189], v252 offset:36864
    ds_read_b64_tr_b16 a[190:191], v252 offset:38912
    s_waitcnt lgkmcnt(8)
    s_add_u32 s101, s59, 737280
    s_add_u32 m0, s100, 32768
    s_nop 0
    buffer_load_dwordx4 v245, s[16:19], s101 offen lds
    buffer_load_dwordx4 v246, s[16:19], s101 offen offset:1024 lds
    buffer_load_dwordx4 v247, s[16:19], s101 offen offset:2048 lds
    buffer_load_dwordx4 v248, s[16:19], s101 offen offset:3072 lds
    ds_read_b64_tr_b16 a[192:193], v249 offset:0
    ds_read_b64_tr_b16 a[194:195], v249 offset:2048
    ds_read_b64_tr_b16 a[196:197], v250 offset:0
    ds_read_b64_tr_b16 a[198:199], v250 offset:2048
    ds_read_b64_tr_b16 a[200:201], v251 offset:0
    ds_read_b64_tr_b16 a[202:203], v251 offset:2048
    ds_read_b64_tr_b16 a[204:205], v252 offset:0
    ds_read_b64_tr_b16 a[206:207], v252 offset:2048
    s_waitcnt lgkmcnt(8)
    s_add_u32 s101, s59, 774144
    s_add_u32 m0, s100, 36864
    s_nop 0
    buffer_load_dwordx4 v245, s[16:19], s101 offen lds
    buffer_load_dwordx4 v246, s[16:19], s101 offen offset:1024 lds
    buffer_load_dwordx4 v247, s[16:19], s101 offen offset:2048 lds
    buffer_load_dwordx4 v248, s[16:19], s101 offen offset:3072 lds
    s_waitcnt vmcnt(32)
    ds_read_b64_tr_b16 a[208:209], v249 offset:4096
    ds_read_b64_tr_b16 a[210:211], v249 offset:6144
    ds_read_b64_tr_b16 a[212:213], v250 offset:4096
    ds_read_b64_tr_b16 a[214:215], v250 offset:6144
    ds_read_b64_tr_b16 a[216:217], v251 offset:4096
    ds_read_b64_tr_b16 a[218:219], v251 offset:6144
    ds_read_b64_tr_b16 a[220:221], v252 offset:4096
    ds_read_b64_tr_b16 a[222:223], v252 offset:6144
    s_waitcnt lgkmcnt(8)
    s_add_u32 s101, s59, 811008
    s_add_u32 m0, s100, 0
    s_nop 0
    buffer_load_dwordx4 v245, s[16:19], s101 offen lds
    buffer_load_dwordx4 v246, s[16:19], s101 offen offset:1024 lds
    buffer_load_dwordx4 v247, s[16:19], s101 offen offset:2048 lds
    buffer_load_dwordx4 v248, s[16:19], s101 offen offset:3072 lds
    s_waitcnt vmcnt(32)
    ds_read_b64_tr_b16 a[224:225], v249 offset:8192
    ds_read_b64_tr_b16 a[226:227], v249 offset:10240
    ds_read_b64_tr_b16 a[228:229], v250 offset:8192
    ds_read_b64_tr_b16 a[230:231], v250 offset:10240
    ds_read_b64_tr_b16 a[232:233], v251 offset:8192
    ds_read_b64_tr_b16 a[234:235], v251 offset:10240
    ds_read_b64_tr_b16 a[236:237], v252 offset:8192
    ds_read_b64_tr_b16 a[238:239], v252 offset:10240
    s_waitcnt lgkmcnt(8)
    s_add_u32 s101, s59, 847872
    s_add_u32 m0, s100, 4096
    s_nop 0
    buffer_load_dwordx4 v245, s[16:19], s101 offen lds
    buffer_load_dwordx4 v246, s[16:19], s101 offen offset:1024 lds
    buffer_load_dwordx4 v247, s[16:19], s101 offen offset:2048 lds
    buffer_load_dwordx4 v248, s[16:19], s101 offen offset:3072 lds
    s_waitcnt vmcnt(32)
    ds_read_b64_tr_b16 a[240:241], v249 offset:12288
    ds_read_b64_tr_b16 a[242:243], v249 offset:14336
    ds_read_b64_tr_b16 a[244:245], v250 offset:12288
    ds_read_b64_tr_b16 a[246:247], v250 offset:14336
    ds_read_b64_tr_b16 a[248:249], v251 offset:12288
    ds_read_b64_tr_b16 a[250:251], v251 offset:14336
    ds_read_b64_tr_b16 a[252:253], v252 offset:12288
    ds_read_b64_tr_b16 a[254:255], v252 offset:14336
    s_waitcnt lgkmcnt(8)
    s_add_u32 s101, s59, 884736
    s_add_u32 m0, s100, 8192
    s_nop 0
    buffer_load_dwordx4 v245, s[16:19], s101 offen lds
    buffer_load_dwordx4 v246, s[16:19], s101 offen offset:1024 lds
    buffer_load_dwordx4 v247, s[16:19], s101 offen offset:2048 lds
    buffer_load_dwordx4 v248, s[16:19], s101 offen offset:3072 lds
    s_waitcnt vmcnt(32)
    ds_read_b64_tr_b16 v[64:65], v249 offset:16384
    ds_read_b64_tr_b16 v[66:67], v249 offset:18432
    ds_read_b64_tr_b16 v[68:69], v250 offset:16384
    ds_read_b64_tr_b16 v[70:71], v250 offset:18432
    ds_read_b64_tr_b16 v[72:73], v251 offset:16384
    ds_read_b64_tr_b16 v[74:75], v251 offset:18432
    ds_read_b64_tr_b16 v[76:77], v252 offset:16384
    ds_read_b64_tr_b16 v[78:79], v252 offset:18432
    s_waitcnt lgkmcnt(8)
    s_add_u32 s101, s59, 921600
    s_add_u32 m0, s100, 12288
    s_nop 0
    buffer_load_dwordx4 v245, s[16:19], s101 offen lds
    buffer_load_dwordx4 v246, s[16:19], s101 offen offset:1024 lds
    buffer_load_dwordx4 v247, s[16:19], s101 offen offset:2048 lds
    buffer_load_dwordx4 v248, s[16:19], s101 offen offset:3072 lds
    s_waitcnt vmcnt(32)
    ds_read_b64_tr_b16 v[80:81], v249 offset:20480
    ds_read_b64_tr_b16 v[82:83], v249 offset:22528
    ds_read_b64_tr_b16 v[84:85], v250 offset:20480
    ds_read_b64_tr_b16 v[86:87], v250 offset:22528
    ds_read_b64_tr_b16 v[88:89], v251 offset:20480
    ds_read_b64_tr_b16 v[90:91], v251 offset:22528
    ds_read_b64_tr_b16 v[92:93], v252 offset:20480
    ds_read_b64_tr_b16 v[94:95], v252 offset:22528
    s_waitcnt lgkmcnt(8)
    s_add_u32 s101, s59, 958464
    s_add_u32 m0, s100, 16384
    s_nop 0
    buffer_load_dwordx4 v245, s[16:19], s101 offen lds
    buffer_load_dwordx4 v246, s[16:19], s101 offen offset:1024 lds
    buffer_load_dwordx4 v247, s[16:19], s101 offen offset:2048 lds
    buffer_load_dwordx4 v248, s[16:19], s101 offen offset:3072 lds
    s_waitcnt vmcnt(32)
    ds_read_b64_tr_b16 v[96:97], v249 offset:24576
    ds_read_b64_tr_b16 v[98:99], v249 offset:26624
    ds_read_b64_tr_b16 v[100:101], v250 offset:24576
    ds_read_b64_tr_b16 v[102:103], v250 offset:26624
    ds_read_b64_tr_b16 v[104:105], v251 offset:24576
    ds_read_b64_tr_b16 v[106:107], v251 offset:26624
    ds_read_b64_tr_b16 v[108:109], v252 offset:24576
    ds_read_b64_tr_b16 v[110:111], v252 offset:26624
    s_waitcnt lgkmcnt(8)
    s_add_u32 s101, s59, 995328
    s_add_u32 m0, s100, 20480
    s_nop 0
    buffer_load_dwordx4 v245, s[16:19], s101 offen lds
    buffer_load_dwordx4 v246, s[16:19], s101 offen offset:1024 lds
    buffer_load_dwordx4 v247, s[16:19], s101 offen offset:2048 lds
    buffer_load_dwordx4 v248, s[16:19], s101 offen offset:3072 lds
    v_and_b32 v240, 63, v242
    v_lshlrev_b32 v240, 2, v240
    s_cmp_eq_u32 s36, 0
    s_cselect_b64 exec, -1, 0
    global_load_dword v241, v240, s[8:9] sc1
    s_mov_b64 exec, -1
    s_waitcnt vmcnt(33)
    ds_read_b64_tr_b16 v[112:113], v249 offset:28672
    ds_read_b64_tr_b16 v[114:115], v249 offset:30720
    ds_read_b64_tr_b16 v[116:117], v250 offset:28672
    ds_read_b64_tr_b16 v[118:119], v250 offset:30720
    ds_read_b64_tr_b16 v[120:121], v251 offset:28672
    ds_read_b64_tr_b16 v[122:123], v251 offset:30720
    ds_read_b64_tr_b16 v[124:125], v252 offset:28672
    ds_read_b64_tr_b16 v[126:127], v252 offset:30720
    s_waitcnt lgkmcnt(8)
    s_add_u32 s101, s59, 1032192
    s_add_u32 m0, s100, 24576
    s_nop 0
    buffer_load_dwordx4 v245, s[16:19], s101 offen lds
    buffer_load_dwordx4 v246, s[16:19], s101 offen offset:1024 lds
    buffer_load_dwordx4 v247, s[16:19], s101 offen offset:2048 lds
    buffer_load_dwordx4 v248, s[16:19], s101 offen offset:3072 lds
    s_waitcnt lgkmcnt(0)
    s_add_u32 s101, s59, 1069056
    s_add_u32 m0, s100, 28672
    s_nop 0
    buffer_load_dwordx4 v245, s[16:19], s101 offen lds
    buffer_load_dwordx4 v246, s[16:19], s101 offen offset:1024 lds
    buffer_load_dwordx4 v247, s[16:19], s101 offen offset:2048 lds
    buffer_load_dwordx4 v248, s[16:19], s101 offen offset:3072 lds
    s_waitcnt vmcnt(37)
    ds_read_b64_tr_b16 v[128:129], v249 offset:32768
    ds_read_b64_tr_b16 v[130:131], v249 offset:34816
    ds_read_b64_tr_b16 v[132:133], v250 offset:32768
    ds_read_b64_tr_b16 v[134:135], v250 offset:34816
    ds_read_b64_tr_b16 v[136:137], v251 offset:32768
    ds_read_b64_tr_b16 v[138:139], v251 offset:34816
    ds_read_b64_tr_b16 v[140:141], v252 offset:32768
    ds_read_b64_tr_b16 v[142:143], v252 offset:34816
    s_waitcnt vmcnt(33)
    ds_read_b64_tr_b16 v[144:145], v249 offset:36864
    ds_read_b64_tr_b16 v[146:147], v249 offset:38912
    ds_read_b64_tr_b16 v[148:149], v250 offset:36864
    ds_read_b64_tr_b16 v[150:151], v250 offset:38912
    ds_read_b64_tr_b16 v[152:153], v251 offset:36864
    ds_read_b64_tr_b16 v[154:155], v251 offset:38912
    ds_read_b64_tr_b16 v[156:157], v252 offset:36864
    ds_read_b64_tr_b16 v[158:159], v252 offset:38912
    s_waitcnt lgkmcnt(8)
    s_add_u32 s101, s59, 1105920
    s_add_u32 m0, s100, 32768
    s_nop 0
    buffer_load_dwordx4 v245, s[16:19], s101 offen lds
    buffer_load_dwordx4 v246, s[16:19], s101 offen offset:1024 lds
    buffer_load_dwordx4 v247, s[16:19], s101 offen offset:2048 lds
    buffer_load_dwordx4 v248, s[16:19], s101 offen offset:3072 lds
    s_waitcnt lgkmcnt(0)
    s_add_u32 s101, s59, 1142784
    s_add_u32 m0, s100, 36864
    s_nop 0
    buffer_load_dwordx4 v245, s[16:19], s101 offen lds
    buffer_load_dwordx4 v246, s[16:19], s101 offen offset:1024 lds
    buffer_load_dwordx4 v247, s[16:19], s101 offen offset:2048 lds
    buffer_load_dwordx4 v248, s[16:19], s101 offen offset:3072 lds
    s_cmp_lg_u32 s36, 0
    s_cbranch_scc1 B_GO
    s_waitcnt vmcnt(16)
    v_readlane_b32 s49, v241, s11
    v_readlane_b32 s50, v241, s3
    s_min_u32 s49, s49, s50
    s_cmp_ge_u32 s49, 32
    s_cbranch_scc1 B_GO
    s_mov_b32 s47, 200000
B_POLL:
    global_load_dword v241, v240, s[8:9] sc1
    s_waitcnt vmcnt(0)
    v_readlane_b32 s49, v241, s11
    v_readlane_b32 s50, v241, s3
    s_min_u32 s49, s49, s50
    s_cmp_ge_u32 s49, 32
    s_cbranch_scc1 B_GO
    s_sub_u32 s47, s47, 1
    s_cmp_eq_u32 s47, 0
    s_cbranch_scc1 B_GO
    s_sleep 1
    s_branch B_POLL
B_GO:
    s_barrier
    s_add_u32 s42, s10, 20480
    buffer_load_dwordx4 v[160:163], v244, s[32:35], s42 offen sc1
    buffer_load_dwordx4 v[164:167], v253, s[32:35], s42 offen sc1
    buffer_load_dwordx4 v[168:171], v254, s[32:35], s42 offen sc1
    buffer_load_dwordx4 v[172:175], v255, s[32:35], s42 offen sc1
    s_add_u32 s42, s10, 21504
    buffer_load_dwordx4 v[176:179], v244, s[32:35], s42 offen sc1
    buffer_load_dwordx4 v[180:183], v253, s[32:35], s42 offen sc1
    buffer_load_dwordx4 v[184:187], v254, s[32:35], s42 offen sc1
    buffer_load_dwordx4 v[188:191], v255, s[32:35], s42 offen sc1
    s_add_u32 s42, s10, 22528
    buffer_load_dwordx4 v[192:195], v244, s[32:35], s42 offen sc1
    buffer_load_dwordx4 v[196:199], v253, s[32:35], s42 offen sc1
    buffer_load_dwordx4 v[200:203], v254, s[32:35], s42 offen sc1
    buffer_load_dwordx4 v[204:207], v255, s[32:35], s42 offen sc1
    s_add_u32 s42, s10, 23552
    buffer_load_dwordx4 v[208:211], v244, s[32:35], s42 offen sc1
    buffer_load_dwordx4 v[212:215], v253, s[32:35], s42 offen sc1
    buffer_load_dwordx4 v[216:219], v254, s[32:35], s42 offen sc1
    buffer_load_dwordx4 v[220:223], v255, s[32:35], s42 offen sc1
    s_waitcnt vmcnt(15)
    v_mfma_f32_16x16x32_bf16 v[0:3], v[128:131], v[160:163], 0
    s_add_u32 s42, s10, 24576
    v_mfma_f32_16x16x32_bf16 v[4:7], v[132:135], v[160:163], 0
    v_mfma_f32_16x16x32_bf16 v[8:11], v[136:139], v[160:163], 0
    v_mfma_f32_16x16x32_bf16 v[12:15], v[140:143], v[160:163], 0
    buffer_load_dwordx4 v[160:163], v244, s[32:35], s42 offen sc1
    s_waitcnt vmcnt(15)
    v_mfma_f32_16x16x32_bf16 v[16:19], v[128:131], v[164:167], 0
    v_mfma_f32_16x16x32_bf16 v[20:23], v[132:135], v[164:167], 0
    v_mfma_f32_16x16x32_bf16 v[24:27], v[136:139], v[164:167], 0
    v_mfma_f32_16x16x32_bf16 v[28:31], v[140:143], v[164:167], 0
    buffer_load_dwordx4 v[164:167], v253, s[32:35], s42 offen sc1
    s_waitcnt vmcnt(15)
    v_mfma_f32_16x16x32_bf16 v[32:35], v[128:131], v[168:171], 0
    v_mfma_f32_16x16x32_bf16 v[36:39], v[132:135], v[168:171], 0
    v_mfma_f32_16x16x32_bf16 v[40:43], v[136:139], v[168:171], 0
    v_mfma_f32_16x16x32_bf16 v[44:47], v[140:143], v[168:171], 0
    buffer_load_dwordx4 v[168:171], v254, s[32:35], s42 offen sc1
    s_waitcnt vmcnt(15)
    v_mfma_f32_16x16x32_bf16 v[48:51], v[128:131], v[172:175], 0
    v_mfma_f32_16x16x32_bf16 v[52:55], v[132:135], v[172:175], 0
    v_mfma_f32_16x16x32_bf16 v[56:59], v[136:139], v[172:175], 0
    v_mfma_f32_16x16x32_bf16 v[60:63], v[140:143], v[172:175], 0
    buffer_load_dwordx4 v[172:175], v255, s[32:35], s42 offen sc1
    s_waitcnt vmcnt(15)
    v_mfma_f32_16x16x32_bf16 v[0:3], v[144:147], v[176:179], v[0:3]
    s_add_u32 s42, s10, 25600
    v_mfma_f32_16x16x32_bf16 v[4:7], v[148:151], v[176:179], v[4:7]
    ds_read_b64_tr_b16 v[128:129], v249 offset:0
    v_mfma_f32_16x16x32_bf16 v[8:11], v[152:155], v[176:179], v[8:11]
    ds_read_b64_tr_b16 v[130:131], v249 offset:2048
    v_mfma_f32_16x16x32_bf16 v[12:15], v[156:159], v[176:179], v[12:15]
    buffer_load_dwordx4 v[176:179], v244, s[32:35], s42 offen sc1
    ds_read_b64_tr_b16 v[132:133], v250 offset:0
    s_waitcnt vmcnt(15)
    v_mfma_f32_16x16x32_bf16 v[16:19], v[144:147], v[180:183], v[16:19]
    ds_read_b64_tr_b16 v[134:135], v250 offset:2048
    v_mfma_f32_16x16x32_bf16 v[20:23], v[148:151], v[180:183], v[20:23]
    ds_read_b64_tr_b16 v[136:137], v251 offset:0
    v_mfma_f32_16x16x32_bf16 v[24:27], v[152:155], v[180:183], v[24:27]
    ds_read_b64_tr_b16 v[138:139], v251 offset:2048
    v_mfma_f32_16x16x32_bf16 v[28:31], v[156:159], v[180:183], v[28:31]
    buffer_load_dwordx4 v[180:183], v253, s[32:35], s42 offen sc1
    ds_read_b64_tr_b16 v[140:141], v252 offset:0
    s_waitcnt vmcnt(15)
    v_mfma_f32_16x16x32_bf16 v[32:35], v[144:147], v[184:187], v[32:35]
    ds_read_b64_tr_b16 v[142:143], v252 offset:2048
    v_mfma_f32_16x16x32_bf16 v[36:39], v[148:151], v[184:187], v[36:39]
    v_mfma_f32_16x16x32_bf16 v[40:43], v[152:155], v[184:187], v[40:43]
    v_mfma_f32_16x16x32_bf16 v[44:47], v[156:159], v[184:187], v[44:47]
    buffer_load_dwordx4 v[184:187], v254, s[32:35], s42 offen sc1
    s_waitcnt vmcnt(15)
    v_mfma_f32_16x16x32_bf16 v[48:51], v[144:147], v[188:191], v[48:51]
    v_mfma_f32_16x16x32_bf16 v[52:55], v[148:151], v[188:191], v[52:55]
    v_mfma_f32_16x16x32_bf16 v[56:59], v[152:155], v[188:191], v[56:59]
    v_mfma_f32_16x16x32_bf16 v[60:63], v[156:159], v[188:191], v[60:63]
    buffer_load_dwordx4 v[188:191], v255, s[32:35], s42 offen sc1
    s_waitcnt lgkmcnt(0)
    s_waitcnt vmcnt(15)
    v_mfma_f32_16x16x32_bf16 v[0:3], v[128:131], v[192:195], v[0:3]
    s_add_u32 s42, s10, 26624
    v_mfma_f32_16x16x32_bf16 v[4:7], v[132:135], v[192:195], v[4:7]
    ds_read_b64_tr_b16 v[144:145], v249 offset:4096
    v_mfma_f32_16x16x32_bf16 v[8:11], v[136:139], v[192:195], v[8:11]
    ds_read_b64_tr_b16 v[146:147], v249 offset:6144
    v_mfma_f32_16x16x32_bf16 v[12:15], v[140:143], v[192:195], v[12:15]
    buffer_load_dwordx4 v[192:195], v244, s[32:35], s42 offen sc1
    ds_read_b64_tr_b16 v[148:149], v250 offset:4096
    s_waitcnt vmcnt(15)
    v_mfma_f32_16x16x32_bf16 v[16:19], v[128:131], v[196:199], v[16:19]
    ds_read_b64_tr_b16 v[150:151], v250 offset:6144
    v_mfma_f32_16x16x32_bf16 v[20:23], v[132:135], v[196:199], v[20:23]
    ds_read_b64_tr_b16 v[152:153], v251 offset:4096
    v_mfma_f32_16x16x32_bf16 v[24:27], v[136:139], v[196:199], v[24:27]
    ds_read_b64_tr_b16 v[154:155], v251 offset:6144
    v_mfma_f32_16x16x32_bf16 v[28:31], v[140:143], v[196:199], v[28:31]
    buffer_load_dwordx4 v[196:199], v253, s[32:35], s42 offen sc1
    ds_read_b64_tr_b16 v[156:157], v252 offset:4096
    s_waitcnt vmcnt(15)
    v_mfma_f32_16x16x32_bf16 v[32:35], v[128:131], v[200:203], v[32:35]
    ds_read_b64_tr_b16 v[158:159], v252 offset:6144
    v_mfma_f32_16x16x32_bf16 v[36:39], v[132:135], v[200:203], v[36:39]
    v_mfma_f32_16x16x32_bf16 v[40:43], v[136:139], v[200:203], v[40:43]
    v_mfma_f32_16x16x32_bf16 v[44:47], v[140:143], v[200:203], v[44:47]
    buffer_load_dwordx4 v[200:203], v254, s[32:35], s42 offen sc1
    s_waitcnt vmcnt(15)
    v_mfma_f32_16x16x32_bf16 v[48:51], v[128:131], v[204:207], v[48:51]
    v_mfma_f32_16x16x32_bf16 v[52:55], v[132:135], v[204:207], v[52:55]
    v_mfma_f32_16x16x32_bf16 v[56:59], v[136:139], v[204:207], v[56:59]
    v_mfma_f32_16x16x32_bf16 v[60:63], v[140:143], v[204:207], v[60:63]
    buffer_load_dwordx4 v[204:207], v255, s[32:35], s42 offen sc1
    s_waitcnt lgkmcnt(0)
    s_waitcnt vmcnt(15)
    v_mfma_f32_16x16x32_bf16 v[0:3], v[144:147], v[208:211], v[0:3]
    s_add_u32 s42, s10, 27648
    v_mfma_f32_16x16x32_bf16 v[4:7], v[148:151], v[208:211], v[4:7]
    ds_read_b64_tr_b16 v[128:129], v249 offset:8192
    v_mfma_f32_16x16x32_bf16 v[8:11], v[152:155], v[208:211], v[8:11]
    ds_read_b64_tr_b16 v[130:131], v249 offset:10240
    v_mfma_f32_16x16x32_bf16 v[12:15], v[156:159], v[208:211], v[12:15]
    buffer_load_dwordx4 v[208:211], v244, s[32:35], s42 offen sc1
    ds_read_b64_tr_b16 v[132:133], v250 offset:8192
    s_waitcnt vmcnt(15)
    v_mfma_f32_16x16x32_bf16 v[16:19], v[144:147], v[212:215], v[16:19]
    ds_read_b64_tr_b16 v[134:135], v250 offset:10240
    v_mfma_f32_16x16x32_bf16 v[20:23], v[148:151], v[212:215], v[20:23]
    ds_read_b64_tr_b16 v[136:137], v251 offset:8192
    v_mfma_f32_16x16x32_bf16 v[24:27], v[152:155], v[212:215], v[24:27]
    ds_read_b64_tr_b16 v[138:139], v251 offset:10240
    v_mfma_f32_16x16x32_bf16 v[28:31], v[156:159], v[212:215], v[28:31]
    buffer_load_dwordx4 v[212:215], v253, s[32:35], s42 offen sc1
    ds_read_b64_tr_b16 v[140:141], v252 offset:8192
    s_waitcnt vmcnt(15)
    v_mfma_f32_16x16x32_bf16 v[32:35], v[144:147], v[216:219], v[32:35]
    ds_read_b64_tr_b16 v[142:143], v252 offset:10240
    v_mfma_f32_16x16x32_bf16 v[36:39], v[148:151], v[216:219], v[36:39]
    v_mfma_f32_16x16x32_bf16 v[40:43], v[152:155], v[216:219], v[40:43]
    v_mfma_f32_16x16x32_bf16 v[44:47], v[156:159], v[216:219], v[44:47]
    buffer_load_dwordx4 v[216:219], v254, s[32:35], s42 offen sc1
    s_waitcnt vmcnt(15)
    v_mfma_f32_16x16x32_bf16 v[48:51], v[144:147], v[220:223], v[48:51]
    v_mfma_f32_16x16x32_bf16 v[52:55], v[148:151], v[220:223], v[52:55]
    v_mfma_f32_16x16x32_bf16 v[56:59], v[152:155], v[220:223], v[56:59]
    v_mfma_f32_16x16x32_bf16 v[60:63], v[156:159], v[220:223], v[60:63]
    buffer_load_dwordx4 v[220:223], v255, s[32:35], s42 offen sc1
    s_waitcnt lgkmcnt(0)
    s_waitcnt vmcnt(15)
    v_mfma_f32_16x16x32_bf16 v[0:3], v[128:131], v[160:163], v[0:3]
    s_add_u32 s42, s10, 28672
    v_mfma_f32_16x16x32_bf16 v[4:7], v[132:135], v[160:163], v[4:7]
    ds_read_b64_tr_b16 v[144:145], v249 offset:12288
    v_mfma_f32_16x16x32_bf16 v[8:11], v[136:139], v[160:163], v[8:11]
    ds_read_b64_tr_b16 v[146:147], v249 offset:14336
    v_mfma_f32_16x16x32_bf16 v[12:15], v[140:143], v[160:163], v[12:15]
    buffer_load_dwordx4 v[160:163], v244, s[32:35], s42 offen sc1
    ds_read_b64_tr_b16 v[148:149], v250 offset:12288
    s_waitcnt vmcnt(15)
    v_mfma_f32_16x16x32_bf16 v[16:19], v[128:131], v[164:167], v[16:19]
    ds_read_b64_tr_b16 v[150:151], v250 offset:14336
    v_mfma_f32_16x16x32_bf16 v[20:23], v[132:135], v[164:167], v[20:23]
    ds_read_b64_tr_b16 v[152:153], v251 offset:12288
    v_mfma_f32_16x16x32_bf16 v[24:27], v[136:139], v[164:167], v[24:27]
    ds_read_b64_tr_b16 v[154:155], v251 offset:14336
    v_mfma_f32_16x16x32_bf16 v[28:31], v[140:143], v[164:167], v[28:31]
    buffer_load_dwordx4 v[164:167], v253, s[32:35], s42 offen sc1
    ds_read_b64_tr_b16 v[156:157], v252 offset:12288
    s_waitcnt vmcnt(15)
    v_mfma_f32_16x16x32_bf16 v[32:35], v[128:131], v[168:171], v[32:35]
    ds_read_b64_tr_b16 v[158:159], v252 offset:14336
    v_mfma_f32_16x16x32_bf16 v[36:39], v[132:135], v[168:171], v[36:39]
    v_mfma_f32_16x16x32_bf16 v[40:43], v[136:139], v[168:171], v[40:43]
    v_mfma_f32_16x16x32_bf16 v[44:47], v[140:143], v[168:171], v[44:47]
    buffer_load_dwordx4 v[168:171], v254, s[32:35], s42 offen sc1
    s_waitcnt vmcnt(15)
    v_mfma_f32_16x16x32_bf16 v[48:51], v[128:131], v[172:175], v[48:51]
    v_mfma_f32_16x16x32_bf16 v[52:55], v[132:135], v[172:175], v[52:55]
    v_mfma_f32_16x16x32_bf16 v[56:59], v[136:139], v[172:175], v[56:59]
    v_mfma_f32_16x16x32_bf16 v[60:63], v[140:143], v[172:175], v[60:63]
    buffer_load_dwordx4 v[172:175], v255, s[32:35], s42 offen sc1
    s_waitcnt lgkmcnt(0)
    s_waitcnt vmcnt(15)
    v_mfma_f32_16x16x32_bf16 v[0:3], v[144:147], v[176:179], v[0:3]
    s_add_u32 s42, s10, 29696
    v_mfma_f32_16x16x32_bf16 v[4:7], v[148:151], v[176:179], v[4:7]
    ds_read_b64_tr_b16 v[128:129], v249 offset:16384
    v_mfma_f32_16x16x32_bf16 v[8:11], v[152:155], v[176:179], v[8:11]
    ds_read_b64_tr_b16 v[130:131], v249 offset:18432
    v_mfma_f32_16x16x32_bf16 v[12:15], v[156:159], v[176:179], v[12:15]
    buffer_load_dwordx4 v[176:179], v244, s[32:35], s42 offen sc1
    ds_read_b64_tr_b16 v[132:133], v250 offset:16384
    s_waitcnt vmcnt(15)
    v_mfma_f32_16x16x32_bf16 v[16:19], v[144:147], v[180:183], v[16:19]
    ds_read_b64_tr_b16 v[134:135], v250 offset:18432
    v_mfma_f32_16x16x32_bf16 v[20:23], v[148:151], v[180:183], v[20:23]
    ds_read_b64_tr_b16 v[136:137], v251 offset:16384
    v_mfma_f32_16x16x32_bf16 v[24:27], v[152:155], v[180:183], v[24:27]
    ds_read_b64_tr_b16 v[138:139], v251 offset:18432
    v_mfma_f32_16x16x32_bf16 v[28:31], v[156:159], v[180:183], v[28:31]
    buffer_load_dwordx4 v[180:183], v253, s[32:35], s42 offen sc1
    ds_read_b64_tr_b16 v[140:141], v252 offset:16384
    s_waitcnt vmcnt(15)
    v_mfma_f32_16x16x32_bf16 v[32:35], v[144:147], v[184:187], v[32:35]
    ds_read_b64_tr_b16 v[142:143], v252 offset:18432
    v_mfma_f32_16x16x32_bf16 v[36:39], v[148:151], v[184:187], v[36:39]
    v_mfma_f32_16x16x32_bf16 v[40:43], v[152:155], v[184:187], v[40:43]
    v_mfma_f32_16x16x32_bf16 v[44:47], v[156:159], v[184:187], v[44:47]
    buffer_load_dwordx4 v[184:187], v254, s[32:35], s42 offen sc1
    s_waitcnt vmcnt(15)
    v_mfma_f32_16x16x32_bf16 v[48:51], v[144:147], v[188:191], v[48:51]
    v_mfma_f32_16x16x32_bf16 v[52:55], v[148:151], v[188:191], v[52:55]
    v_mfma_f32_16x16x32_bf16 v[56:59], v[152:155], v[188:191], v[56:59]
    v_mfma_f32_16x16x32_bf16 v[60:63], v[156:159], v[188:191], v[60:63]
    buffer_load_dwordx4 v[188:191], v255, s[32:35], s42 offen sc1
    s_waitcnt lgkmcnt(0)
    s_waitcnt vmcnt(15)
    v_mfma_f32_16x16x32_bf16 v[0:3], v[128:131], v[192:195], v[0:3]
    s_add_u32 s42, s10, 0
    v_mfma_f32_16x16x32_bf16 v[4:7], v[132:135], v[192:195], v[4:7]
    ds_read_b64_tr_b16 v[144:145], v249 offset:20480
    v_mfma_f32_16x16x32_bf16 v[8:11], v[136:139], v[192:195], v[8:11]
    ds_read_b64_tr_b16 v[146:147], v249 offset:22528
    v_mfma_f32_16x16x32_bf16 v[12:15], v[140:143], v[192:195], v[12:15]
    buffer_load_dwordx4 v[192:195], v244, s[32:35], s42 offen sc1
    ds_read_b64_tr_b16 v[148:149], v250 offset:20480
    s_waitcnt vmcnt(15)
    v_mfma_f32_16x16x32_bf16 v[16:19], v[128:131], v[196:199], v[16:19]
    ds_read_b64_tr_b16 v[150:151], v250 offset:22528
    v_mfma_f32_16x16x32_bf16 v[20:23], v[132:135], v[196:199], v[20:23]
    ds_read_b64_tr_b16 v[152:153], v251 offset:20480
    v_mfma_f32_16x16x32_bf16 v[24:27], v[136:139], v[196:199], v[24:27]
    ds_read_b64_tr_b16 v[154:155], v251 offset:22528
    v_mfma_f32_16x16x32_bf16 v[28:31], v[140:143], v[196:199], v[28:31]
    buffer_load_dwordx4 v[196:199], v253, s[32:35], s42 offen sc1
    ds_read_b64_tr_b16 v[156:157], v252 offset:20480
    s_waitcnt vmcnt(15)
    v_mfma_f32_16x16x32_bf16 v[32:35], v[128:131], v[200:203], v[32:35]
    ds_read_b64_tr_b16 v[158:159], v252 offset:22528
    v_mfma_f32_16x16x32_bf16 v[36:39], v[132:135], v[200:203], v[36:39]
    v_mfma_f32_16x16x32_bf16 v[40:43], v[136:139], v[200:203], v[40:43]
    v_mfma_f32_16x16x32_bf16 v[44:47], v[140:143], v[200:203], v[44:47]
    buffer_load_dwordx4 v[200:203], v254, s[32:35], s42 offen sc1
    s_waitcnt vmcnt(15)
    v_mfma_f32_16x16x32_bf16 v[48:51], v[128:131], v[204:207], v[48:51]
    v_mfma_f32_16x16x32_bf16 v[52:55], v[132:135], v[204:207], v[52:55]
    v_mfma_f32_16x16x32_bf16 v[56:59], v[136:139], v[204:207], v[56:59]
    v_mfma_f32_16x16x32_bf16 v[60:63], v[140:143], v[204:207], v[60:63]
    buffer_load_dwordx4 v[204:207], v255, s[32:35], s42 offen sc1
    s_waitcnt lgkmcnt(0)
    s_waitcnt vmcnt(15)
    v_mfma_f32_16x16x32_bf16 v[0:3], v[144:147], v[208:211], v[0:3]
    s_add_u32 s42, s10, 1024
    v_mfma_f32_16x16x32_bf16 v[4:7], v[148:151], v[208:211], v[4:7]
    ds_read_b64_tr_b16 v[128:129], v249 offset:24576
    v_mfma_f32_16x16x32_bf16 v[8:11], v[152:155], v[208:211], v[8:11]
    ds_read_b64_tr_b16 v[130:131], v249 offset:26624
    v_mfma_f32_16x16x32_bf16 v[12:15], v[156:159], v[208:211], v[12:15]
    buffer_load_dwordx4 v[208:211], v244, s[32:35], s42 offen sc1
    ds_read_b64_tr_b16 v[132:133], v250 offset:24576
    s_waitcnt vmcnt(15)
    v_mfma_f32_16x16x32_bf16 v[16:19], v[144:147], v[212:215], v[16:19]
    ds_read_b64_tr_b16 v[134:135], v250 offset:26624
    v_mfma_f32_16x16x32_bf16 v[20:23], v[148:151], v[212:215], v[20:23]
    ds_read_b64_tr_b16 v[136:137], v251 offset:24576
    v_mfma_f32_16x16x32_bf16 v[24:27], v[152:155], v[212:215], v[24:27]
    ds_read_b64_tr_b16 v[138:139], v251 offset:26624
    v_mfma_f32_16x16x32_bf16 v[28:31], v[156:159], v[212:215], v[28:31]
    buffer_load_dwordx4 v[212:215], v253, s[32:35], s42 offen sc1
    ds_read_b64_tr_b16 v[140:141], v252 offset:24576
    s_waitcnt vmcnt(15)
    v_mfma_f32_16x16x32_bf16 v[32:35], v[144:147], v[216:219], v[32:35]
    ds_read_b64_tr_b16 v[142:143], v252 offset:26624
    v_mfma_f32_16x16x32_bf16 v[36:39], v[148:151], v[216:219], v[36:39]
    v_mfma_f32_16x16x32_bf16 v[40:43], v[152:155], v[216:219], v[40:43]
    v_mfma_f32_16x16x32_bf16 v[44:47], v[156:159], v[216:219], v[44:47]
    buffer_load_dwordx4 v[216:219], v254, s[32:35], s42 offen sc1
    s_waitcnt vmcnt(15)
    v_mfma_f32_16x16x32_bf16 v[48:51], v[144:147], v[220:223], v[48:51]
    v_mfma_f32_16x16x32_bf16 v[52:55], v[148:151], v[220:223], v[52:55]
    v_mfma_f32_16x16x32_bf16 v[56:59], v[152:155], v[220:223], v[56:59]
    v_mfma_f32_16x16x32_bf16 v[60:63], v[156:159], v[220:223], v[60:63]
    buffer_load_dwordx4 v[220:223], v255, s[32:35], s42 offen sc1
    s_waitcnt lgkmcnt(0)
    s_waitcnt vmcnt(15)
    v_mfma_f32_16x16x32_bf16 v[0:3], v[128:131], v[160:163], v[0:3]
    s_add_u32 s42, s10, 2048
    v_mfma_f32_16x16x32_bf16 v[4:7], v[132:135], v[160:163], v[4:7]
    ds_read_b64_tr_b16 v[144:145], v249 offset:28672
    v_mfma_f32_16x16x32_bf16 v[8:11], v[136:139], v[160:163], v[8:11]
    ds_read_b64_tr_b16 v[146:147], v249 offset:30720
    v_mfma_f32_16x16x32_bf16 v[12:15], v[140:143], v[160:163], v[12:15]
    buffer_load_dwordx4 v[160:163], v244, s[32:35], s42 offen sc1
    ds_read_b64_tr_b16 v[148:149], v250 offset:28672
    s_waitcnt vmcnt(15)
    v_mfma_f32_16x16x32_bf16 v[16:19], v[128:131], v[164:167], v[16:19]
    ds_read_b64_tr_b16 v[150:151], v250 offset:30720
    v_mfma_f32_16x16x32_bf16 v[20:23], v[132:135], v[164:167], v[20:23]
    ds_read_b64_tr_b16 v[152:153], v251 offset:28672
    v_mfma_f32_16x16x32_bf16 v[24:27], v[136:139], v[164:167], v[24:27]
    ds_read_b64_tr_b16 v[154:155], v251 offset:30720
    v_mfma_f32_16x16x32_bf16 v[28:31], v[140:143], v[164:167], v[28:31]
    buffer_load_dwordx4 v[164:167], v253, s[32:35], s42 offen sc1
    ds_read_b64_tr_b16 v[156:157], v252 offset:28672
    s_waitcnt vmcnt(15)
    v_mfma_f32_16x16x32_bf16 v[32:35], v[128:131], v[168:171], v[32:35]
    ds_read_b64_tr_b16 v[158:159], v252 offset:30720
    v_mfma_f32_16x16x32_bf16 v[36:39], v[132:135], v[168:171], v[36:39]
    v_mfma_f32_16x16x32_bf16 v[40:43], v[136:139], v[168:171], v[40:43]
    v_mfma_f32_16x16x32_bf16 v[44:47], v[140:143], v[168:171], v[44:47]
    buffer_load_dwordx4 v[168:171], v254, s[32:35], s42 offen sc1
    s_waitcnt vmcnt(15)
    v_mfma_f32_16x16x32_bf16 v[48:51], v[128:131], v[172:175], v[48:51]
    v_mfma_f32_16x16x32_bf16 v[52:55], v[132:135], v[172:175], v[52:55]
    v_mfma_f32_16x16x32_bf16 v[56:59], v[136:139], v[172:175], v[56:59]
    v_mfma_f32_16x16x32_bf16 v[60:63], v[140:143], v[172:175], v[60:63]
    buffer_load_dwordx4 v[172:175], v255, s[32:35], s42 offen sc1
    s_waitcnt lgkmcnt(0)
    s_waitcnt vmcnt(15)
    v_mfma_f32_16x16x32_bf16 v[0:3], v[144:147], v[176:179], v[0:3]
    s_add_u32 s42, s10, 3072
    v_mfma_f32_16x16x32_bf16 v[4:7], v[148:151], v[176:179], v[4:7]
    v_mfma_f32_16x16x32_bf16 v[8:11], v[152:155], v[176:179], v[8:11]
    v_mfma_f32_16x16x32_bf16 v[12:15], v[156:159], v[176:179], v[12:15]
    buffer_load_dwordx4 v[176:179], v244, s[32:35], s42 offen sc1
    s_waitcnt vmcnt(15)
    v_mfma_f32_16x16x32_bf16 v[16:19], v[144:147], v[180:183], v[16:19]
    v_mfma_f32_16x16x32_bf16 v[20:23], v[148:151], v[180:183], v[20:23]
    v_mfma_f32_16x16x32_bf16 v[24:27], v[152:155], v[180:183], v[24:27]
    v_mfma_f32_16x16x32_bf16 v[28:31], v[156:159], v[180:183], v[28:31]
    buffer_load_dwordx4 v[180:183], v253, s[32:35], s42 offen sc1
    s_waitcnt vmcnt(15)
    v_mfma_f32_16x16x32_bf16 v[32:35], v[144:147], v[184:187], v[32:35]
    v_mfma_f32_16x16x32_bf16 v[36:39], v[148:151], v[184:187], v[36:39]
    v_mfma_f32_16x16x32_bf16 v[40:43], v[152:155], v[184:187], v[40:43]
    v_mfma_f32_16x16x32_bf16 v[44:47], v[156:159], v[184:187], v[44:47]
    buffer_load_dwordx4 v[184:187], v254, s[32:35], s42 offen sc1
    s_waitcnt vmcnt(15)
    v_mfma_f32_16x16x32_bf16 v[48:51], v[144:147], v[188:191], v[48:51]
    v_mfma_f32_16x16x32_bf16 v[52:55], v[148:151], v[188:191], v[52:55]
    v_mfma_f32_16x16x32_bf16 v[56:59], v[152:155], v[188:191], v[56:59]
    v_mfma_f32_16x16x32_bf16 v[60:63], v[156:159], v[188:191], v[60:63]
    buffer_load_dwordx4 v[188:191], v255, s[32:35], s42 offen sc1
    s_waitcnt vmcnt(15)
    v_mfma_f32_16x16x32_bf16 v[0:3], a[0:3], v[192:195], v[0:3]
    s_add_u32 s42, s10, 4096
    v_mfma_f32_16x16x32_bf16 v[4:7], a[4:7], v[192:195], v[4:7]
    v_mfma_f32_16x16x32_bf16 v[8:11], a[8:11], v[192:195], v[8:11]
    v_mfma_f32_16x16x32_bf16 v[12:15], a[12:15], v[192:195], v[12:15]
    buffer_load_dwordx4 v[192:195], v244, s[32:35], s42 offen sc1
    s_waitcnt vmcnt(15)
    v_mfma_f32_16x16x32_bf16 v[16:19], a[0:3], v[196:199], v[16:19]
    v_mfma_f32_16x16x32_bf16 v[20:23], a[4:7], v[196:199], v[20:23]
    v_mfma_f32_16x16x32_bf16 v[24:27], a[8:11], v[196:199], v[24:27]
    v_mfma_f32_16x16x32_bf16 v[28:31], a[12:15], v[196:199], v[28:31]
    buffer_load_dwordx4 v[196:199], v253, s[32:35], s42 offen sc1
    s_waitcnt vmcnt(15)
    v_mfma_f32_16x16x32_bf16 v[32:35], a[0:3], v[200:203], v[32:35]
    v_mfma_f32_16x16x32_bf16 v[36:39], a[4:7], v[200:203], v[36:39]
    v_mfma_f32_16x16x32_bf16 v[40:43], a[8:11], v[200:203], v[40:43]
    v_mfma_f32_16x16x32_bf16 v[44:47], a[12:15], v[200:203], v[44:47]
    buffer_load_dwordx4 v[200:203], v254, s[32:35], s42 offen sc1
    s_waitcnt vmcnt(15)
    v_mfma_f32_16x16x32_bf16 v[48:51], a[0:3], v[204:207], v[48:51]
    v_mfma_f32_16x16x32_bf16 v[52:55], a[4:7], v[204:207], v[52:55]
    v_mfma_f32_16x16x32_bf16 v[56:59], a[8:11], v[204:207], v[56:59]
    v_mfma_f32_16x16x32_bf16 v[60:63], a[12:15], v[204:207], v[60:63]
    buffer_load_dwordx4 v[204:207], v255, s[32:35], s42 offen sc1
    s_waitcnt vmcnt(15)
    v_mfma_f32_16x16x32_bf16 v[0:3], a[16:19], v[208:211], v[0:3]
    s_add_u32 s42, s10, 5120
    v_mfma_f32_16x16x32_bf16 v[4:7], a[20:23], v[208:211], v[4:7]
    v_mfma_f32_16x16x32_bf16 v[8:11], a[24:27], v[208:211], v[8:11]
    v_mfma_f32_16x16x32_bf16 v[12:15], a[28:31], v[208:211], v[12:15]
    buffer_load_dwordx4 v[208:211], v244, s[32:35], s42 offen sc1
    s_waitcnt vmcnt(15)
    v_mfma_f32_16x16x32_bf16 v[16:19], a[16:19], v[212:215], v[16:19]
    v_mfma_f32_16x16x32_bf16 v[20:23], a[20:23], v[212:215], v[20:23]
    v_mfma_f32_16x16x32_bf16 v[24:27], a[24:27], v[212:215], v[24:27]
    v_mfma_f32_16x16x32_bf16 v[28:31], a[28:31], v[212:215], v[28:31]
    buffer_load_dwordx4 v[212:215], v253, s[32:35], s42 offen sc1
    s_waitcnt vmcnt(15)
    v_mfma_f32_16x16x32_bf16 v[32:35], a[16:19], v[216:219], v[32:35]
    v_mfma_f32_16x16x32_bf16 v[36:39], a[20:23], v[216:219], v[36:39]
    v_mfma_f32_16x16x32_bf16 v[40:43], a[24:27], v[216:219], v[40:43]
    v_mfma_f32_16x16x32_bf16 v[44:47], a[28:31], v[216:219], v[44:47]
    buffer_load_dwordx4 v[216:219], v254, s[32:35], s42 offen sc1
    s_waitcnt vmcnt(15)
    v_mfma_f32_16x16x32_bf16 v[48:51], a[16:19], v[220:223], v[48:51]
    v_mfma_f32_16x16x32_bf16 v[52:55], a[20:23], v[220:223], v[52:55]
    v_mfma_f32_16x16x32_bf16 v[56:59], a[24:27], v[220:223], v[56:59]
    v_mfma_f32_16x16x32_bf16 v[60:63], a[28:31], v[220:223], v[60:63]
    buffer_load_dwordx4 v[220:223], v255, s[32:35], s42 offen sc1
    s_waitcnt vmcnt(15)
    v_mfma_f32_16x16x32_bf16 v[0:3], a[32:35], v[160:163], v[0:3]
    s_add_u32 s42, s10, 6144
    v_mfma_f32_16x16x32_bf16 v[4:7], a[36:39], v[160:163], v[4:7]
    v_mfma_f32_16x16x32_bf16 v[8:11], a[40:43], v[160:163], v[8:11]
    v_mfma_f32_16x16x32_bf16 v[12:15], a[44:47], v[160:163], v[12:15]
    buffer_load_dwordx4 v[160:163], v244, s[32:35], s42 offen sc1
    s_waitcnt vmcnt(15)
    v_mfma_f32_16x16x32_bf16 v[16:19], a[32:35], v[164:167], v[16:19]
    v_mfma_f32_16x16x32_bf16 v[20:23], a[36:39], v[164:167], v[20:23]
    v_mfma_f32_16x16x32_bf16 v[24:27], a[40:43], v[164:167], v[24:27]
    v_mfma_f32_16x16x32_bf16 v[28:31], a[44:47], v[164:167], v[28:31]
    buffer_load_dwordx4 v[164:167], v253, s[32:35], s42 offen sc1
    s_waitcnt vmcnt(15)
    v_mfma_f32_16x16x32_bf16 v[32:35], a[32:35], v[168:171], v[32:35]
    v_mfma_f32_16x16x32_bf16 v[36:39], a[36:39], v[168:171], v[36:39]
    v_mfma_f32_16x16x32_bf16 v[40:43], a[40:43], v[168:171], v[40:43]
    v_mfma_f32_16x16x32_bf16 v[44:47], a[44:47], v[168:171], v[44:47]
    buffer_load_dwordx4 v[168:171], v254, s[32:35], s42 offen sc1
    s_waitcnt vmcnt(15)
    v_mfma_f32_16x16x32_bf16 v[48:51], a[32:35], v[172:175], v[48:51]
    v_mfma_f32_16x16x32_bf16 v[52:55], a[36:39], v[172:175], v[52:55]
    v_mfma_f32_16x16x32_bf16 v[56:59], a[40:43], v[172:175], v[56:59]
    v_mfma_f32_16x16x32_bf16 v[60:63], a[44:47], v[172:175], v[60:63]
    buffer_load_dwordx4 v[172:175], v255, s[32:35], s42 offen sc1
    s_waitcnt vmcnt(15)
    v_mfma_f32_16x16x32_bf16 v[0:3], a[48:51], v[176:179], v[0:3]
    s_add_u32 s42, s10, 7168
    v_mfma_f32_16x16x32_bf16 v[4:7], a[52:55], v[176:179], v[4:7]
    v_mfma_f32_16x16x32_bf16 v[8:11], a[56:59], v[176:179], v[8:11]
    v_mfma_f32_16x16x32_bf16 v[12:15], a[60:63], v[176:179], v[12:15]
    buffer_load_dwordx4 v[176:179], v244, s[32:35], s42 offen sc1
    s_waitcnt vmcnt(15)
    v_mfma_f32_16x16x32_bf16 v[16:19], a[48:51], v[180:183], v[16:19]
    v_mfma_f32_16x16x32_bf16 v[20:23], a[52:55], v[180:183], v[20:23]
    v_mfma_f32_16x16x32_bf16 v[24:27], a[56:59], v[180:183], v[24:27]
    v_mfma_f32_16x16x32_bf16 v[28:31], a[60:63], v[180:183], v[28:31]
    buffer_load_dwordx4 v[180:183], v253, s[32:35], s42 offen sc1
    s_waitcnt vmcnt(15)
    v_mfma_f32_16x16x32_bf16 v[32:35], a[48:51], v[184:187], v[32:35]
    v_mfma_f32_16x16x32_bf16 v[36:39], a[52:55], v[184:187], v[36:39]
    v_mfma_f32_16x16x32_bf16 v[40:43], a[56:59], v[184:187], v[40:43]
    v_mfma_f32_16x16x32_bf16 v[44:47], a[60:63], v[184:187], v[44:47]
    buffer_load_dwordx4 v[184:187], v254, s[32:35], s42 offen sc1
    s_waitcnt vmcnt(15)
    v_mfma_f32_16x16x32_bf16 v[48:51], a[48:51], v[188:191], v[48:51]
    v_mfma_f32_16x16x32_bf16 v[52:55], a[52:55], v[188:191], v[52:55]
    v_mfma_f32_16x16x32_bf16 v[56:59], a[56:59], v[188:191], v[56:59]
    v_mfma_f32_16x16x32_bf16 v[60:63], a[60:63], v[188:191], v[60:63]
    buffer_load_dwordx4 v[188:191], v255, s[32:35], s42 offen sc1
    s_waitcnt vmcnt(15)
    v_mfma_f32_16x16x32_bf16 v[0:3], a[64:67], v[192:195], v[0:3]
    s_add_u32 s42, s10, 8192
    v_mfma_f32_16x16x32_bf16 v[4:7], a[68:71], v[192:195], v[4:7]
    v_mfma_f32_16x16x32_bf16 v[8:11], a[72:75], v[192:195], v[8:11]
    v_mfma_f32_16x16x32_bf16 v[12:15], a[76:79], v[192:195], v[12:15]
    buffer_load_dwordx4 v[192:195], v244, s[32:35], s42 offen sc1
    s_waitcnt vmcnt(15)
    v_mfma_f32_16x16x32_bf16 v[16:19], a[64:67], v[196:199], v[16:19]
    v_mfma_f32_16x16x32_bf16 v[20:23], a[68:71], v[196:199], v[20:23]
    v_mfma_f32_16x16x32_bf16 v[24:27], a[72:75], v[196:199], v[24:27]
    v_mfma_f32_16x16x32_bf16 v[28:31], a[76:79], v[196:199], v[28:31]
    buffer_load_dwordx4 v[196:199], v253, s[32:35], s42 offen sc1
    s_waitcnt vmcnt(15)
    v_mfma_f32_16x16x32_bf16 v[32:35], a[64:67], v[200:203], v[32:35]
    v_mfma_f32_16x16x32_bf16 v[36:39], a[68:71], v[200:203], v[36:39]
    v_mfma_f32_16x16x32_bf16 v[40:43], a[72:75], v[200:203], v[40:43]
    v_mfma_f32_16x16x32_bf16 v[44:47], a[76:79], v[200:203], v[44:47]
    buffer_load_dwordx4 v[200:203], v254, s[32:35], s42 offen sc1
    s_waitcnt vmcnt(15)
    v_mfma_f32_16x16x32_bf16 v[48:51], a[64:67], v[204:207], v[48:51]
    v_mfma_f32_16x16x32_bf16 v[52:55], a[68:71], v[204:207], v[52:55]
    v_mfma_f32_16x16x32_bf16 v[56:59], a[72:75], v[204:207], v[56:59]
    v_mfma_f32_16x16x32_bf16 v[60:63], a[76:79], v[204:207], v[60:63]
    buffer_load_dwordx4 v[204:207], v255, s[32:35], s42 offen sc1
    s_waitcnt vmcnt(15)
    v_mfma_f32_16x16x32_bf16 v[0:3], a[80:83], v[208:211], v[0:3]
    s_add_u32 s42, s10, 9216
    v_mfma_f32_16x16x32_bf16 v[4:7], a[84:87], v[208:211], v[4:7]
    v_mfma_f32_16x16x32_bf16 v[8:11], a[88:91], v[208:211], v[8:11]
    v_mfma_f32_16x16x32_bf16 v[12:15], a[92:95], v[208:211], v[12:15]
    buffer_load_dwordx4 v[208:211], v244, s[32:35], s42 offen sc1
    s_waitcnt vmcnt(15)
    v_mfma_f32_16x16x32_bf16 v[16:19], a[80:83], v[212:215], v[16:19]
    v_mfma_f32_16x16x32_bf16 v[20:23], a[84:87], v[212:215], v[20:23]
    v_mfma_f32_16x16x32_bf16 v[24:27], a[88:91], v[212:215], v[24:27]
    v_mfma_f32_16x16x32_bf16 v[28:31], a[92:95], v[212:215], v[28:31]
    buffer_load_dwordx4 v[212:215], v253, s[32:35], s42 offen sc1
    s_waitcnt vmcnt(15)
    v_mfma_f32_16x16x32_bf16 v[32:35], a[80:83], v[216:219], v[32:35]
    v_mfma_f32_16x16x32_bf16 v[36:39], a[84:87], v[216:219], v[36:39]
    v_mfma_f32_16x16x32_bf16 v[40:43], a[88:91], v[216:219], v[40:43]
    v_mfma_f32_16x16x32_bf16 v[44:47], a[92:95], v[216:219], v[44:47]
    buffer_load_dwordx4 v[216:219], v254, s[32:35], s42 offen sc1
    s_waitcnt vmcnt(15)
    v_mfma_f32_16x16x32_bf16 v[48:51], a[80:83], v[220:223], v[48:51]
    v_mfma_f32_16x16x32_bf16 v[52:55], a[84:87], v[220:223], v[52:55]
    v_mfma_f32_16x16x32_bf16 v[56:59], a[88:91], v[220:223], v[56:59]
    v_mfma_f32_16x16x32_bf16 v[60:63], a[92:95], v[220:223], v[60:63]
    buffer_load_dwordx4 v[220:223], v255, s[32:35], s42 offen sc1
    s_waitcnt vmcnt(15)
    v_mfma_f32_16x16x32_bf16 v[0:3], a[96:99], v[160:163], v[0:3]
    s_add_u32 s42, s10, 10240
    v_mfma_f32_16x16x32_bf16 v[4:7], a[100:103], v[160:163], v[4:7]
    v_mfma_f32_16x16x32_bf16 v[8:11], a[104:107], v[160:163], v[8:11]
    v_mfma_f32_16x16x32_bf16 v[12:15], a[108:111], v[160:163], v[12:15]
    buffer_load_dwordx4 v[160:163], v244, s[32:35], s42 offen sc1
    s_waitcnt vmcnt(15)
    v_mfma_f32_16x16x32_bf16 v[16:19], a[96:99], v[164:167], v[16:19]
    v_mfma_f32_16x16x32_bf16 v[20:23], a[100:103], v[164:167], v[20:23]
    v_mfma_f32_16x16x32_bf16 v[24:27], a[104:107], v[164:167], v[24:27]
    v_mfma_f32_16x16x32_bf16 v[28:31], a[108:111], v[164:167], v[28:31]
    buffer_load_dwordx4 v[164:167], v253, s[32:35], s42 offen sc1
    s_waitcnt vmcnt(15)
    v_mfma_f32_16x16x32_bf16 v[32:35], a[96:99], v[168:171], v[32:35]
    v_mfma_f32_16x16x32_bf16 v[36:39], a[100:103], v[168:171], v[36:39]
    v_mfma_f32_16x16x32_bf16 v[40:43], a[104:107], v[168:171], v[40:43]
    v_mfma_f32_16x16x32_bf16 v[44:47], a[108:111], v[168:171], v[44:47]
    buffer_load_dwordx4 v[168:171], v254, s[32:35], s42 offen sc1
    s_waitcnt vmcnt(15)
    v_mfma_f32_16x16x32_bf16 v[48:51], a[96:99], v[172:175], v[48:51]
    v_mfma_f32_16x16x32_bf16 v[52:55], a[100:103], v[172:175], v[52:55]
    v_mfma_f32_16x16x32_bf16 v[56:59], a[104:107], v[172:175], v[56:59]
    v_mfma_f32_16x16x32_bf16 v[60:63], a[108:111], v[172:175], v[60:63]
    buffer_load_dwordx4 v[172:175], v255, s[32:35], s42 offen sc1
    s_waitcnt vmcnt(15)
    v_mfma_f32_16x16x32_bf16 v[0:3], a[112:115], v[176:179], v[0:3]
    s_add_u32 s42, s10, 11264
    v_mfma_f32_16x16x32_bf16 v[4:7], a[116:119], v[176:179], v[4:7]
    v_mfma_f32_16x16x32_bf16 v[8:11], a[120:123], v[176:179], v[8:11]
    v_mfma_f32_16x16x32_bf16 v[12:15], a[124:127], v[176:179], v[12:15]
    buffer_load_dwordx4 v[176:179], v244, s[32:35], s42 offen sc1
    s_waitcnt vmcnt(15)
    v_mfma_f32_16x16x32_bf16 v[16:19], a[112:115], v[180:183], v[16:19]
    v_mfma_f32_16x16x32_bf16 v[20:23], a[116:119], v[180:183], v[20:23]
    v_mfma_f32_16x16x32_bf16 v[24:27], a[120:123], v[180:183], v[24:27]
    v_mfma_f32_16x16x32_bf16 v[28:31], a[124:127], v[180:183], v[28:31]
    buffer_load_dwordx4 v[180:183], v253, s[32:35], s42 offen sc1
    s_waitcnt vmcnt(15)
    v_mfma_f32_16x16x32_bf16 v[32:35], a[112:115], v[184:187], v[32:35]
    v_mfma_f32_16x16x32_bf16 v[36:39], a[116:119], v[184:187], v[36:39]
    v_mfma_f32_16x16x32_bf16 v[40:43], a[120:123], v[184:187], v[40:43]
    v_mfma_f32_16x16x32_bf16 v[44:47], a[124:127], v[184:187], v[44:47]
    buffer_load_dwordx4 v[184:187], v254, s[32:35], s42 offen sc1
    s_waitcnt vmcnt(15)
    v_mfma_f32_16x16x32_bf16 v[48:51], a[112:115], v[188:191], v[48:51]
    v_mfma_f32_16x16x32_bf16 v[52:55], a[116:119], v[188:191], v[52:55]
    v_mfma_f32_16x16x32_bf16 v[56:59], a[120:123], v[188:191], v[56:59]
    v_mfma_f32_16x16x32_bf16 v[60:63], a[124:127], v[188:191], v[60:63]
    buffer_load_dwordx4 v[188:191], v255, s[32:35], s42 offen sc1
    s_waitcnt vmcnt(15)
    v_mfma_f32_16x16x32_bf16 v[0:3], a[128:131], v[192:195], v[0:3]
    s_add_u32 s42, s10, 12288
    v_mfma_f32_16x16x32_bf16 v[4:7], a[132:135], v[192:195], v[4:7]
    v_mfma_f32_16x16x32_bf16 v[8:11], a[136:139], v[192:195], v[8:11]
    v_mfma_f32_16x16x32_bf16 v[12:15], a[140:143], v[192:195], v[12:15]
    buffer_load_dwordx4 v[192:195], v244, s[32:35], s42 offen sc1
    s_waitcnt vmcnt(15)
    v_mfma_f32_16x16x32_bf16 v[16:19], a[128:131], v[196:199], v[16:19]
    v_mfma_f32_16x16x32_bf16 v[20:23], a[132:135], v[196:199], v[20:23]
    v_mfma_f32_16x16x32_bf16 v[24:27], a[136:139], v[196:199], v[24:27]
    v_mfma_f32_16x16x32_bf16 v[28:31], a[140:143], v[196:199], v[28:31]
    buffer_load_dwordx4 v[196:199], v253, s[32:35], s42 offen sc1
    s_waitcnt vmcnt(15)
    v_mfma_f32_16x16x32_bf16 v[32:35], a[128:131], v[200:203], v[32:35]
    v_mfma_f32_16x16x32_bf16 v[36:39], a[132:135], v[200:203], v[36:39]
    v_mfma_f32_16x16x32_bf16 v[40:43], a[136:139], v[200:203], v[40:43]
    v_mfma_f32_16x16x32_bf16 v[44:47], a[140:143], v[200:203], v[44:47]
    buffer_load_dwordx4 v[200:203], v254, s[32:35], s42 offen sc1
    s_waitcnt vmcnt(15)
    v_mfma_f32_16x16x32_bf16 v[48:51], a[128:131], v[204:207], v[48:51]
    v_mfma_f32_16x16x32_bf16 v[52:55], a[132:135], v[204:207], v[52:55]
    v_mfma_f32_16x16x32_bf16 v[56:59], a[136:139], v[204:207], v[56:59]
    v_mfma_f32_16x16x32_bf16 v[60:63], a[140:143], v[204:207], v[60:63]
    buffer_load_dwordx4 v[204:207], v255, s[32:35], s42 offen sc1
    s_waitcnt vmcnt(15)
    v_mfma_f32_16x16x32_bf16 v[0:3], a[144:147], v[208:211], v[0:3]
    s_add_u32 s42, s10, 13312
    v_mfma_f32_16x16x32_bf16 v[4:7], a[148:151], v[208:211], v[4:7]
    v_mfma_f32_16x16x32_bf16 v[8:11], a[152:155], v[208:211], v[8:11]
    v_mfma_f32_16x16x32_bf16 v[12:15], a[156:159], v[208:211], v[12:15]
    buffer_load_dwordx4 v[208:211], v244, s[32:35], s42 offen sc1
    s_waitcnt vmcnt(15)
    v_mfma_f32_16x16x32_bf16 v[16:19], a[144:147], v[212:215], v[16:19]
    v_mfma_f32_16x16x32_bf16 v[20:23], a[148:151], v[212:215], v[20:23]
    v_mfma_f32_16x16x32_bf16 v[24:27], a[152:155], v[212:215], v[24:27]
    v_mfma_f32_16x16x32_bf16 v[28:31], a[156:159], v[212:215], v[28:31]
    buffer_load_dwordx4 v[212:215], v253, s[32:35], s42 offen sc1
    s_waitcnt vmcnt(15)
    v_mfma_f32_16x16x32_bf16 v[32:35], a[144:147], v[216:219], v[32:35]
    v_mfma_f32_16x16x32_bf16 v[36:39], a[148:151], v[216:219], v[36:39]
    v_mfma_f32_16x16x32_bf16 v[40:43], a[152:155], v[216:219], v[40:43]
    v_mfma_f32_16x16x32_bf16 v[44:47], a[156:159], v[216:219], v[44:47]
    buffer_load_dwordx4 v[216:219], v254, s[32:35], s42 offen sc1
    s_waitcnt vmcnt(15)
    v_mfma_f32_16x16x32_bf16 v[48:51], a[144:147], v[220:223], v[48:51]
    v_mfma_f32_16x16x32_bf16 v[52:55], a[148:151], v[220:223], v[52:55]
    v_mfma_f32_16x16x32_bf16 v[56:59], a[152:155], v[220:223], v[56:59]
    v_mfma_f32_16x16x32_bf16 v[60:63], a[156:159], v[220:223], v[60:63]
    buffer_load_dwordx4 v[220:223], v255, s[32:35], s42 offen sc1
    s_waitcnt vmcnt(15)
    v_mfma_f32_16x16x32_bf16 v[0:3], a[160:163], v[160:163], v[0:3]
    s_add_u32 s42, s10, 14336
    v_mfma_f32_16x16x32_bf16 v[4:7], a[164:167], v[160:163], v[4:7]
    v_mfma_f32_16x16x32_bf16 v[8:11], a[168:171], v[160:163], v[8:11]
    v_mfma_f32_16x16x32_bf16 v[12:15], a[172:175], v[160:163], v[12:15]
    buffer_load_dwordx4 v[160:163], v244, s[32:35], s42 offen sc1
    s_waitcnt vmcnt(15)
    v_mfma_f32_16x16x32_bf16 v[16:19], a[160:163], v[164:167], v[16:19]
    v_mfma_f32_16x16x32_bf16 v[20:23], a[164:167], v[164:167], v[20:23]
    v_mfma_f32_16x16x32_bf16 v[24:27], a[168:171], v[164:167], v[24:27]
    v_mfma_f32_16x16x32_bf16 v[28:31], a[172:175], v[164:167], v[28:31]
    buffer_load_dwordx4 v[164:167], v253, s[32:35], s42 offen sc1
    s_waitcnt vmcnt(15)
    v_mfma_f32_16x16x32_bf16 v[32:35], a[160:163], v[168:171], v[32:35]
    v_mfma_f32_16x16x32_bf16 v[36:39], a[164:167], v[168:171], v[36:39]
    v_mfma_f32_16x16x32_bf16 v[40:43], a[168:171], v[168:171], v[40:43]
    v_mfma_f32_16x16x32_bf16 v[44:47], a[172:175], v[168:171], v[44:47]
    buffer_load_dwordx4 v[168:171], v254, s[32:35], s42 offen sc1
    s_waitcnt vmcnt(15)
    v_mfma_f32_16x16x32_bf16 v[48:51], a[160:163], v[172:175], v[48:51]
    v_mfma_f32_16x16x32_bf16 v[52:55], a[164:167], v[172:175], v[52:55]
    v_mfma_f32_16x16x32_bf16 v[56:59], a[168:171], v[172:175], v[56:59]
    v_mfma_f32_16x16x32_bf16 v[60:63], a[172:175], v[172:175], v[60:63]
    buffer_load_dwordx4 v[172:175], v255, s[32:35], s42 offen sc1
    s_waitcnt vmcnt(15)
    v_mfma_f32_16x16x32_bf16 v[0:3], a[176:179], v[176:179], v[0:3]
    s_add_u32 s42, s10, 15360
    v_mfma_f32_16x16x32_bf16 v[4:7], a[180:183], v[176:179], v[4:7]
    v_mfma_f32_16x16x32_bf16 v[8:11], a[184:187], v[176:179], v[8:11]
    v_mfma_f32_16x16x32_bf16 v[12:15], a[188:191], v[176:179], v[12:15]
    buffer_load_dwordx4 v[176:179], v244, s[32:35], s42 offen sc1
    s_waitcnt vmcnt(15)
    v_mfma_f32_16x16x32_bf16 v[16:19], a[176:179], v[180:183], v[16:19]
    v_mfma_f32_16x16x32_bf16 v[20:23], a[180:183], v[180:183], v[20:23]
    v_mfma_f32_16x16x32_bf16 v[24:27], a[184:187], v[180:183], v[24:27]
    v_mfma_f32_16x16x32_bf16 v[28:31], a[188:191], v[180:183], v[28:31]
    buffer_load_dwordx4 v[180:183], v253, s[32:35], s42 offen sc1
    s_waitcnt vmcnt(15)
    v_mfma_f32_16x16x32_bf16 v[32:35], a[176:179], v[184:187], v[32:35]
    v_mfma_f32_16x16x32_bf16 v[36:39], a[180:183], v[184:187], v[36:39]
    v_mfma_f32_16x16x32_bf16 v[40:43], a[184:187], v[184:187], v[40:43]
    v_mfma_f32_16x16x32_bf16 v[44:47], a[188:191], v[184:187], v[44:47]
    buffer_load_dwordx4 v[184:187], v254, s[32:35], s42 offen sc1
    s_waitcnt vmcnt(15)
    v_mfma_f32_16x16x32_bf16 v[48:51], a[176:179], v[188:191], v[48:51]
    v_mfma_f32_16x16x32_bf16 v[52:55], a[180:183], v[188:191], v[52:55]
    v_mfma_f32_16x16x32_bf16 v[56:59], a[184:187], v[188:191], v[56:59]
    v_mfma_f32_16x16x32_bf16 v[60:63], a[188:191], v[188:191], v[60:63]
    buffer_load_dwordx4 v[188:191], v255, s[32:35], s42 offen sc1
    s_waitcnt vmcnt(15)
    v_mfma_f32_16x16x32_bf16 v[0:3], a[192:195], v[192:195], v[0:3]
    s_add_u32 s42, s10, 16384
    v_mfma_f32_16x16x32_bf16 v[4:7], a[196:199], v[192:195], v[4:7]
    v_mfma_f32_16x16x32_bf16 v[8:11], a[200:203], v[192:195], v[8:11]
    v_mfma_f32_16x16x32_bf16 v[12:15], a[204:207], v[192:195], v[12:15]
    buffer_load_dwordx4 v[192:195], v244, s[32:35], s42 offen sc1
    s_waitcnt vmcnt(15)
    v_mfma_f32_16x16x32_bf16 v[16:19], a[192:195], v[196:199], v[16:19]
    v_mfma_f32_16x16x32_bf16 v[20:23], a[196:199], v[196:199], v[20:23]
    v_mfma_f32_16x16x32_bf16 v[24:27], a[200:203], v[196:199], v[24:27]
    v_mfma_f32_16x16x32_bf16 v[28:31], a[204:207], v[196:199], v[28:31]
    buffer_load_dwordx4 v[196:199], v253, s[32:35], s42 offen sc1
    s_waitcnt vmcnt(15)
    v_mfma_f32_16x16x32_bf16 v[32:35], a[192:195], v[200:203], v[32:35]
    v_mfma_f32_16x16x32_bf16 v[36:39], a[196:199], v[200:203], v[36:39]
    v_mfma_f32_16x16x32_bf16 v[40:43], a[200:203], v[200:203], v[40:43]
    v_mfma_f32_16x16x32_bf16 v[44:47], a[204:207], v[200:203], v[44:47]
    buffer_load_dwordx4 v[200:203], v254, s[32:35], s42 offen sc1
    s_waitcnt vmcnt(15)
    v_mfma_f32_16x16x32_bf16 v[48:51], a[192:195], v[204:207], v[48:51]
    v_mfma_f32_16x16x32_bf16 v[52:55], a[196:199], v[204:207], v[52:55]
    v_mfma_f32_16x16x32_bf16 v[56:59], a[200:203], v[204:207], v[56:59]
    v_mfma_f32_16x16x32_bf16 v[60:63], a[204:207], v[204:207], v[60:63]
    buffer_load_dwordx4 v[204:207], v255, s[32:35], s42 offen sc1
    s_waitcnt vmcnt(15)
    v_mfma_f32_16x16x32_bf16 v[0:3], a[208:211], v[208:211], v[0:3]
    s_add_u32 s42, s10, 17408
    v_mfma_f32_16x16x32_bf16 v[4:7], a[212:215], v[208:211], v[4:7]
    v_mfma_f32_16x16x32_bf16 v[8:11], a[216:219], v[208:211], v[8:11]
    v_mfma_f32_16x16x32_bf16 v[12:15], a[220:223], v[208:211], v[12:15]
    buffer_load_dwordx4 v[208:211], v244, s[32:35], s42 offen sc1
    s_waitcnt vmcnt(15)
    v_mfma_f32_16x16x32_bf16 v[16:19], a[208:211], v[212:215], v[16:19]
    v_mfma_f32_16x16x32_bf16 v[20:23], a[212:215], v[212:215], v[20:23]
    v_mfma_f32_16x16x32_bf16 v[24:27], a[216:219], v[212:215], v[24:27]
    v_mfma_f32_16x16x32_bf16 v[28:31], a[220:223], v[212:215], v[28:31]
    buffer_load_dwordx4 v[212:215], v253, s[32:35], s42 offen sc1
    s_waitcnt vmcnt(15)
    v_mfma_f32_16x16x32_bf16 v[32:35], a[208:211], v[216:219], v[32:35]
    v_mfma_f32_16x16x32_bf16 v[36:39], a[212:215], v[216:219], v[36:39]
    v_mfma_f32_16x16x32_bf16 v[40:43], a[216:219], v[216:219], v[40:43]
    v_mfma_f32_16x16x32_bf16 v[44:47], a[220:223], v[216:219], v[44:47]
    buffer_load_dwordx4 v[216:219], v254, s[32:35], s42 offen sc1
    s_waitcnt vmcnt(15)
    v_mfma_f32_16x16x32_bf16 v[48:51], a[208:211], v[220:223], v[48:51]
    v_mfma_f32_16x16x32_bf16 v[52:55], a[212:215], v[220:223], v[52:55]
    v_mfma_f32_16x16x32_bf16 v[56:59], a[216:219], v[220:223], v[56:59]
    v_mfma_f32_16x16x32_bf16 v[60:63], a[220:223], v[220:223], v[60:63]
    buffer_load_dwordx4 v[220:223], v255, s[32:35], s42 offen sc1
    s_waitcnt vmcnt(15)
    v_mfma_f32_16x16x32_bf16 v[0:3], a[224:227], v[160:163], v[0:3]
    s_add_u32 s42, s10, 18432
    v_mfma_f32_16x16x32_bf16 v[4:7], a[228:231], v[160:163], v[4:7]
    v_mfma_f32_16x16x32_bf16 v[8:11], a[232:235], v[160:163], v[8:11]
    v_mfma_f32_16x16x32_bf16 v[12:15], a[236:239], v[160:163], v[12:15]
    buffer_load_dwordx4 v[160:163], v244, s[32:35], s42 offen sc1
    s_waitcnt vmcnt(15)
    v_mfma_f32_16x16x32_bf16 v[16:19], a[224:227], v[164:167], v[16:19]
    v_mfma_f32_16x16x32_bf16 v[20:23], a[228:231], v[164:167], v[20:23]
    v_mfma_f32_16x16x32_bf16 v[24:27], a[232:235], v[164:167], v[24:27]
    v_mfma_f32_16x16x32_bf16 v[28:31], a[236:239], v[164:167], v[28:31]
    buffer_load_dwordx4 v[164:167], v253, s[32:35], s42 offen sc1
    s_waitcnt vmcnt(15)
    v_mfma_f32_16x16x32_bf16 v[32:35], a[224:227], v[168:171], v[32:35]
    v_mfma_f32_16x16x32_bf16 v[36:39], a[228:231], v[168:171], v[36:39]
    v_mfma_f32_16x16x32_bf16 v[40:43], a[232:235], v[168:171], v[40:43]
    v_mfma_f32_16x16x32_bf16 v[44:47], a[236:239], v[168:171], v[44:47]
    buffer_load_dwordx4 v[168:171], v254, s[32:35], s42 offen sc1
    s_waitcnt vmcnt(15)
    v_mfma_f32_16x16x32_bf16 v[48:51], a[224:227], v[172:175], v[48:51]
    v_mfma_f32_16x16x32_bf16 v[52:55], a[228:231], v[172:175], v[52:55]
    v_mfma_f32_16x16x32_bf16 v[56:59], a[232:235], v[172:175], v[56:59]
    v_mfma_f32_16x16x32_bf16 v[60:63], a[236:239], v[172:175], v[60:63]
    buffer_load_dwordx4 v[172:175], v255, s[32:35], s42 offen sc1
    s_waitcnt vmcnt(15)
    v_mfma_f32_16x16x32_bf16 v[0:3], a[240:243], v[176:179], v[0:3]
    s_add_u32 s42, s10, 19456
    v_mfma_f32_16x16x32_bf16 v[4:7], a[244:247], v[176:179], v[4:7]
    v_mfma_f32_16x16x32_bf16 v[8:11], a[248:251], v[176:179], v[8:11]
    v_mfma_f32_16x16x32_bf16 v[12:15], a[252:255], v[176:179], v[12:15]
    buffer_load_dwordx4 v[176:179], v244, s[32:35], s42 offen sc1
    s_waitcnt vmcnt(15)
    v_mfma_f32_16x16x32_bf16 v[16:19], a[240:243], v[180:183], v[16:19]
    v_mfma_f32_16x16x32_bf16 v[20:23], a[244:247], v[180:183], v[20:23]
    v_mfma_f32_16x16x32_bf16 v[24:27], a[248:251], v[180:183], v[24:27]
    v_mfma_f32_16x16x32_bf16 v[28:31], a[252:255], v[180:183], v[28:31]
    buffer_load_dwordx4 v[180:183], v253, s[32:35], s42 offen sc1
    s_waitcnt vmcnt(15)
    v_mfma_f32_16x16x32_bf16 v[32:35], a[240:243], v[184:187], v[32:35]
    v_mfma_f32_16x16x32_bf16 v[36:39], a[244:247], v[184:187], v[36:39]
    v_mfma_f32_16x16x32_bf16 v[40:43], a[248:251], v[184:187], v[40:43]
    v_mfma_f32_16x16x32_bf16 v[44:47], a[252:255], v[184:187], v[44:47]
    buffer_load_dwordx4 v[184:187], v254, s[32:35], s42 offen sc1
    s_waitcnt vmcnt(15)
    v_mfma_f32_16x16x32_bf16 v[48:51], a[240:243], v[188:191], v[48:51]
    v_mfma_f32_16x16x32_bf16 v[52:55], a[244:247], v[188:191], v[52:55]
    v_mfma_f32_16x16x32_bf16 v[56:59], a[248:251], v[188:191], v[56:59]
    v_mfma_f32_16x16x32_bf16 v[60:63], a[252:255], v[188:191], v[60:63]
    buffer_load_dwordx4 v[188:191], v255, s[32:35], s42 offen sc1
    s_waitcnt vmcnt(15)
    v_mfma_f32_16x16x32_bf16 v[0:3], v[64:67], v[192:195], v[0:3]
    s_add_u32 s42, s10, 30720
    v_mfma_f32_16x16x32_bf16 v[4:7], v[68:71], v[192:195], v[4:7]
    v_mfma_f32_16x16x32_bf16 v[8:11], v[72:75], v[192:195], v[8:11]
    v_mfma_f32_16x16x32_bf16 v[12:15], v[76:79], v[192:195], v[12:15]
    buffer_load_dwordx4 v[192:195], v244, s[32:35], s42 offen sc1
    s_waitcnt vmcnt(15)
    v_mfma_f32_16x16x32_bf16 v[16:19], v[64:67], v[196:199], v[16:19]
    v_mfma_f32_16x16x32_bf16 v[20:23], v[68:71], v[196:199], v[20:23]
    v_mfma_f32_16x16x32_bf16 v[24:27], v[72:75], v[196:199], v[24:27]
    v_mfma_f32_16x16x32_bf16 v[28:31], v[76:79], v[196:199], v[28:31]
    buffer_load_dwordx4 v[196:199], v253, s[32:35], s42 offen sc1
    s_waitcnt vmcnt(15)
    v_mfma_f32_16x16x32_bf16 v[32:35], v[64:67], v[200:203], v[32:35]
    v_mfma_f32_16x16x32_bf16 v[36:39], v[68:71], v[200:203], v[36:39]
    v_mfma_f32_16x16x32_bf16 v[40:43], v[72:75], v[200:203], v[40:43]
    v_mfma_f32_16x16x32_bf16 v[44:47], v[76:79], v[200:203], v[44:47]
    buffer_load_dwordx4 v[200:203], v254, s[32:35], s42 offen sc1
    s_waitcnt vmcnt(15)
    v_mfma_f32_16x16x32_bf16 v[48:51], v[64:67], v[204:207], v[48:51]
    v_mfma_f32_16x16x32_bf16 v[52:55], v[68:71], v[204:207], v[52:55]
    v_mfma_f32_16x16x32_bf16 v[56:59], v[72:75], v[204:207], v[56:59]
    v_mfma_f32_16x16x32_bf16 v[60:63], v[76:79], v[204:207], v[60:63]
    buffer_load_dwordx4 v[204:207], v255, s[32:35], s42 offen sc1
    s_waitcnt vmcnt(15)
    v_mfma_f32_16x16x32_bf16 v[0:3], v[80:83], v[208:211], v[0:3]
    s_add_u32 s42, s10, 31744
    v_mfma_f32_16x16x32_bf16 v[4:7], v[84:87], v[208:211], v[4:7]
    v_mfma_f32_16x16x32_bf16 v[8:11], v[88:91], v[208:211], v[8:11]
    v_mfma_f32_16x16x32_bf16 v[12:15], v[92:95], v[208:211], v[12:15]
    buffer_load_dwordx4 v[208:211], v244, s[32:35], s42 offen sc1
    s_waitcnt vmcnt(15)
    v_mfma_f32_16x16x32_bf16 v[16:19], v[80:83], v[212:215], v[16:19]
    v_mfma_f32_16x16x32_bf16 v[20:23], v[84:87], v[212:215], v[20:23]
    v_mfma_f32_16x16x32_bf16 v[24:27], v[88:91], v[212:215], v[24:27]
    v_mfma_f32_16x16x32_bf16 v[28:31], v[92:95], v[212:215], v[28:31]
    buffer_load_dwordx4 v[212:215], v253, s[32:35], s42 offen sc1
    s_waitcnt vmcnt(15)
    v_mfma_f32_16x16x32_bf16 v[32:35], v[80:83], v[216:219], v[32:35]
    v_mfma_f32_16x16x32_bf16 v[36:39], v[84:87], v[216:219], v[36:39]
    v_mfma_f32_16x16x32_bf16 v[40:43], v[88:91], v[216:219], v[40:43]
    v_mfma_f32_16x16x32_bf16 v[44:47], v[92:95], v[216:219], v[44:47]
    buffer_load_dwordx4 v[216:219], v254, s[32:35], s42 offen sc1
    s_waitcnt vmcnt(15)
    v_mfma_f32_16x16x32_bf16 v[48:51], v[80:83], v[220:223], v[48:51]
    v_mfma_f32_16x16x32_bf16 v[52:55], v[84:87], v[220:223], v[52:55]
    v_mfma_f32_16x16x32_bf16 v[56:59], v[88:91], v[220:223], v[56:59]
    v_mfma_f32_16x16x32_bf16 v[60:63], v[92:95], v[220:223], v[60:63]
    buffer_load_dwordx4 v[220:223], v255, s[32:35], s42 offen sc1
    s_waitcnt vmcnt(15)
    v_mfma_f32_16x16x32_bf16 v[0:3], v[96:99], v[160:163], v[0:3]
    v_mfma_f32_16x16x32_bf16 v[4:7], v[100:103], v[160:163], v[4:7]
    v_mfma_f32_16x16x32_bf16 v[8:11], v[104:107], v[160:163], v[8:11]
    v_mfma_f32_16x16x32_bf16 v[12:15], v[108:111], v[160:163], v[12:15]
    s_waitcnt vmcnt(14)
    v_mfma_f32_16x16x32_bf16 v[16:19], v[96:99], v[164:167], v[16:19]
    v_mfma_f32_16x16x32_bf16 v[20:23], v[100:103], v[164:167], v[20:23]
    v_mfma_f32_16x16x32_bf16 v[24:27], v[104:107], v[164:167], v[24:27]
    v_mfma_f32_16x16x32_bf16 v[28:31], v[108:111], v[164:167], v[28:31]
    s_waitcnt vmcnt(13)
    v_mfma_f32_16x16x32_bf16 v[32:35], v[96:99], v[168:171], v[32:35]
    v_mfma_f32_16x16x32_bf16 v[36:39], v[100:103], v[168:171], v[36:39]
    v_mfma_f32_16x16x32_bf16 v[40:43], v[104:107], v[168:171], v[40:43]
    v_mfma_f32_16x16x32_bf16 v[44:47], v[108:111], v[168:171], v[44:47]
    s_waitcnt vmcnt(12)
    v_mfma_f32_16x16x32_bf16 v[48:51], v[96:99], v[172:175], v[48:51]
    v_mfma_f32_16x16x32_bf16 v[52:55], v[100:103], v[172:175], v[52:55]
    v_mfma_f32_16x16x32_bf16 v[56:59], v[104:107], v[172:175], v[56:59]
    v_mfma_f32_16x16x32_bf16 v[60:63], v[108:111], v[172:175], v[60:63]
    s_waitcnt vmcnt(11)
    v_mfma_f32_16x16x32_bf16 v[0:3], v[112:115], v[176:179], v[0:3]
    v_mfma_f32_16x16x32_bf16 v[4:7], v[116:119], v[176:179], v[4:7]
    ds_read_b64_tr_b16 v[128:129], v249 offset:32768
    v_mfma_f32_16x16x32_bf16 v[8:11], v[120:123], v[176:179], v[8:11]
    ds_read_b64_tr_b16 v[130:131], v249 offset:34816
    v_mfma_f32_16x16x32_bf16 v[12:15], v[124:127], v[176:179], v[12:15]
    ds_read_b64_tr_b16 v[132:133], v250 offset:32768
    s_waitcnt vmcnt(10)
    v_mfma_f32_16x16x32_bf16 v[16:19], v[112:115], v[180:183], v[16:19]
    ds_read_b64_tr_b16 v[134:135], v250 offset:34816
    v_mfma_f32_16x16x32_bf16 v[20:23], v[116:119], v[180:183], v[20:23]
    ds_read_b64_tr_b16 v[136:137], v251 offset:32768
    v_mfma_f32_16x16x32_bf16 v[24:27], v[120:123], v[180:183], v[24:27]
    ds_read_b64_tr_b16 v[138:139], v251 offset:34816
    v_mfma_f32_16x16x32_bf16 v[28:31], v[124:127], v[180:183], v[28:31]
    ds_read_b64_tr_b16 v[140:141], v252 offset:32768
    s_waitcnt vmcnt(9)
    v_mfma_f32_16x16x32_bf16 v[32:35], v[112:115], v[184:187], v[32:35]
    ds_read_b64_tr_b16 v[142:143], v252 offset:34816
    v_mfma_f32_16x16x32_bf16 v[36:39], v[116:119], v[184:187], v[36:39]
    v_mfma_f32_16x16x32_bf16 v[40:43], v[120:123], v[184:187], v[40:43]
    v_mfma_f32_16x16x32_bf16 v[44:47], v[124:127], v[184:187], v[44:47]
    s_waitcnt vmcnt(8)
    v_mfma_f32_16x16x32_bf16 v[48:51], v[112:115], v[188:191], v[48:51]
    v_mfma_f32_16x16x32_bf16 v[52:55], v[116:119], v[188:191], v[52:55]
    v_mfma_f32_16x16x32_bf16 v[56:59], v[120:123], v[188:191], v[56:59]
    v_mfma_f32_16x16x32_bf16 v[60:63], v[124:127], v[188:191], v[60:63]
    s_waitcnt lgkmcnt(0)
    s_waitcnt vmcnt(7)
    v_mfma_f32_16x16x32_bf16 v[0:3], v[128:131], v[192:195], v[0:3]
    v_mfma_f32_16x16x32_bf16 v[4:7], v[132:135], v[192:195], v[4:7]
    ds_read_b64_tr_b16 v[144:145], v249 offset:36864
    v_mfma_f32_16x16x32_bf16 v[8:11], v[136:139], v[192:195], v[8:11]
    ds_read_b64_tr_b16 v[146:147], v249 offset:38912
    v_mfma_f32_16x16x32_bf16 v[12:15], v[140:143], v[192:195], v[12:15]
    ds_read_b64_tr_b16 v[148:149], v250 offset:36864
    s_waitcnt vmcnt(6)
    v_mfma_f32_16x16x32_bf16 v[16:19], v[128:131], v[196:199], v[16:19]
    ds_read_b64_tr_b16 v[150:151], v250 offset:38912
    v_mfma_f32_16x16x32_bf16 v[20:23], v[132:135], v[196:199], v[20:23]
    ds_read_b64_tr_b16 v[152:153], v251 offset:36864
    v_mfma_f32_16x16x32_bf16 v[24:27], v[136:139], v[196:199], v[24:27]
    ds_read_b64_tr_b16 v[154:155], v251 offset:38912
    v_mfma_f32_16x16x32_bf16 v[28:31], v[140:143], v[196:199], v[28:31]
    ds_read_b64_tr_b16 v[156:157], v252 offset:36864
    s_waitcnt vmcnt(5)
    v_mfma_f32_16x16x32_bf16 v[32:35], v[128:131], v[200:203], v[32:35]
    ds_read_b64_tr_b16 v[158:159], v252 offset:38912
    v_and_b32 v68, 63, v242
    s_mul_i32 s49, s36, 40960
    v_mfma_f32_16x16x32_bf16 v[36:39], v[132:135], v[200:203], v[36:39]
    v_lshlrev_b32 v65, 4, v68
    v_add_u32 v64, s49, v65
    v_mfma_f32_16x16x32_bf16 v[40:43], v[136:139], v[200:203], v[40:43]
    v_add_u32 v66, 81920, v65
    s_lshl_b32 s49, s57, 6
    v_mfma_f32_16x16x32_bf16 v[44:47], v[140:143], v[200:203], v[44:47]
    s_lshl_b32 s50, s36, 4
    s_add_u32 s49, s49, s50
    s_waitcnt vmcnt(4)
    v_mfma_f32_16x16x32_bf16 v[48:51], v[128:131], v[204:207], v[48:51]
    v_and_b32 v69, 15, v68
    v_add_u32 v69, s49, v69
    v_mfma_f32_16x16x32_bf16 v[52:55], v[132:135], v[204:207], v[52:55]
    v_mul_u32_u24 v69, 1152, v69
    v_and_b32 v67, 16, v68
    v_mfma_f32_16x16x32_bf16 v[56:59], v[136:139], v[204:207], v[56:59]
    v_lshlrev_b32 v67, 1, v67
    v_add_u32 v69, v69, v67
    v_mfma_f32_16x16x32_bf16 v[60:63], v[140:143], v[204:207], v[60:63]
    v_lshrrev_b32 v68, 5, v68
    v_lshlrev_b32 v68, 4, v68
    v_add_u32 v67, v69, v68
    s_lshl_b32 s50, s58, 7
    s_cmp_eq_u32 s36, 0
    s_cbranch_scc1 B_RED0
    s_cmp_eq_u32 s36, 1
    s_cbranch_scc1 B_RED1
    s_cmp_eq_u32 s36, 2
    s_cbranch_scc1 B_RED2
    s_waitcnt lgkmcnt(0)
    s_waitcnt vmcnt(3)
    v_mfma_f32_16x16x32_bf16 v[0:3], v[144:147], v[208:211], v[0:3]
    v_mfma_f32_16x16x32_bf16 v[4:7], v[148:151], v[208:211], v[4:7]
    v_mfma_f32_16x16x32_bf16 v[8:11], v[152:155], v[208:211], v[8:11]
    v_mfma_f32_16x16x32_bf16 v[12:15], v[156:159], v[208:211], v[12:15]
    s_waitcnt vmcnt(2)
    v_mfma_f32_16x16x32_bf16 v[16:19], v[144:147], v[212:215], v[16:19]
    v_mfma_f32_16x16x32_bf16 v[20:23], v[148:151], v[212:215], v[20:23]
    ds_write_b128 v64, v[0:3] offset:0
    v_mfma_f32_16x16x32_bf16 v[24:27], v[152:155], v[212:215], v[24:27]
    ds_write_b128 v64, v[4:7] offset:1024
    v_mfma_f32_16x16x32_bf16 v[28:31], v[156:159], v[212:215], v[28:31]
    ds_write_b128 v64, v[8:11] offset:2048
    s_waitcnt vmcnt(1)
    v_mfma_f32_16x16x32_bf16 v[32:35], v[144:147], v[216:219], v[32:35]
    ds_write_b128 v64, v[12:15] offset:3072
    v_mfma_f32_16x16x32_bf16 v[36:39], v[148:151], v[216:219], v[36:39]
    ds_write_b128 v64, v[16:19] offset:4096
    v_mfma_f32_16x16x32_bf16 v[40:43], v[152:155], v[216:219], v[40:43]
    ds_write_b128 v64, v[20:23] offset:5120
    v_mfma_f32_16x16x32_bf16 v[44:47], v[156:159], v[216:219], v[44:47]
    ds_write_b128 v64, v[24:27] offset:6144
    s_waitcnt vmcnt(0)
    v_mfma_f32_16x16x32_bf16 v[48:51], v[144:147], v[220:223], v[48:51]
    ds_write_b128 v64, v[28:31] offset:7168
    v_mfma_f32_16x16x32_bf16 v[52:55], v[148:151], v[220:223], v[52:55]
    ds_write_b128 v64, v[32:35] offset:8192
    v_mfma_f32_16x16x32_bf16 v[56:59], v[152:155], v[220:223], v[56:59]
    ds_write_b128 v64, v[36:39] offset:9216
    v_mfma_f32_16x16x32_bf16 v[60:63], v[156:159], v[220:223], v[60:63]
    ds_write_b128 v64, v[40:43] offset:10240
    ds_write_b128 v64, v[44:47] offset:11264
    s_waitcnt lgkmcnt(0)
    s_barrier
    ds_read_b128 v[96:99], v65 offset:12288
    ds_read_b128 v[100:103], v65 offset:53248
    ds_read_b128 v[104:107], v66 offset:12288
    ds_read_b128 v[108:111], v65 offset:13312
    ds_read_b128 v[112:115], v65 offset:54272
    ds_read_b128 v[116:119], v66 offset:13312
    ds_read_b128 v[120:123], v65 offset:14336
    ds_read_b128 v[124:127], v65 offset:55296
    ds_read_b128 v[128:131], v66 offset:14336
    ds_read_b128 v[132:135], v65 offset:15360
    ds_read_b128 v[136:139], v65 offset:56320
    ds_read_b128 v[140:143], v66 offset:15360
    s_waitcnt lgkmcnt(9)
    v_pk_add_f32 v[100:101], v[100:101], v[104:105]
    v_pk_add_f32 v[102:103], v[102:103], v[106:107]
    v_pk_add_f32 v[48:49], v[48:49], v[96:97]
    v_pk_add_f32 v[50:51], v[50:51], v[98:99]
    v_pk_add_f32 v[48:49], v[48:49], v[100:101]
    v_pk_add_f32 v[50:51], v[50:51], v[102:103]
    v_cvt_pk_bf16_f32 v72, v48, v49
    v_cvt_pk_bf16_f32 v73, v50, v51
    s_waitcnt lgkmcnt(6)
    v_pk_add_f32 v[112:113], v[112:113], v[116:117]
    v_pk_add_f32 v[114:115], v[114:115], v[118:119]
    v_pk_add_f32 v[52:53], v[52:53], v[108:109]
    v_pk_add_f32 v[54:55], v[54:55], v[110:111]
    v_pk_add_f32 v[52:53], v[52:53], v[112:113]
    v_pk_add_f32 v[54:55], v[54:55], v[114:115]
    v_cvt_pk_bf16_f32 v74, v52, v53
    v_cvt_pk_bf16_f32 v75, v54, v55
    s_nop 1
    v_permlane16_swap_b32 v72, v74
    v_permlane16_swap_b32 v73, v75
    s_nop 1
    buffer_store_dwordx4 v[72:75], v67, s[20:23], s50 offen offset:0
    s_waitcnt lgkmcnt(3)
    v_pk_add_f32 v[124:125], v[124:125], v[128:129]
    v_pk_add_f32 v[126:127], v[126:127], v[130:131]
    v_pk_add_f32 v[56:57], v[56:57], v[120:121]
    v_pk_add_f32 v[58:59], v[58:59], v[122:123]
    v_pk_add_f32 v[56:57], v[56:57], v[124:125]
    v_pk_add_f32 v[58:59], v[58:59], v[126:127]
    v_cvt_pk_bf16_f32 v76, v56, v57
    v_cvt_pk_bf16_f32 v77, v58, v59
    s_waitcnt lgkmcnt(0)
    v_pk_add_f32 v[136:137], v[136:137], v[140:141]
    v_pk_add_f32 v[138:139], v[138:139], v[142:143]
    v_pk_add_f32 v[60:61], v[60:61], v[132:133]
    v_pk_add_f32 v[62:63], v[62:63], v[134:135]
    v_pk_add_f32 v[60:61], v[60:61], v[136:137]
    v_pk_add_f32 v[62:63], v[62:63], v[138:139]
    v_cvt_pk_bf16_f32 v78, v60, v61
    v_cvt_pk_bf16_f32 v79, v62, v63
    s_nop 1
    v_permlane16_swap_b32 v76, v78
    v_permlane16_swap_b32 v77, v79
    s_nop 1
    buffer_store_dwordx4 v[76:79], v67, s[20:23], s50 offen offset:64
    s_branch B_REDE
B_RED0:
    s_waitcnt lgkmcnt(0)
    s_waitcnt vmcnt(2)
    v_mfma_f32_16x16x32_bf16 v[16:19], v[144:147], v[212:215], v[16:19]
    v_mfma_f32_16x16x32_bf16 v[20:23], v[148:151], v[212:215], v[20:23]
    v_mfma_f32_16x16x32_bf16 v[24:27], v[152:155], v[212:215], v[24:27]
    v_mfma_f32_16x16x32_bf16 v[28:31], v[156:159], v[212:215], v[28:31]
    s_waitcnt vmcnt(1)
    v_mfma_f32_16x16x32_bf16 v[32:35], v[144:147], v[216:219], v[32:35]
    v_mfma_f32_16x16x32_bf16 v[36:39], v[148:151], v[216:219], v[36:39]
    ds_write_b128 v64, v[16:19] offset:4096
    v_mfma_f32_16x16x32_bf16 v[40:43], v[152:155], v[216:219], v[40:43]
    ds_write_b128 v64, v[20:23] offset:5120
    v_mfma_f32_16x16x32_bf16 v[44:47], v[156:159], v[216:219], v[44:47]
    ds_write_b128 v64, v[24:27] offset:6144
    s_waitcnt vmcnt(0)
    v_mfma_f32_16x16x32_bf16 v[48:51], v[144:147], v[220:223], v[48:51]
    ds_write_b128 v64, v[28:31] offset:7168
    v_mfma_f32_16x16x32_bf16 v[52:55], v[148:151], v[220:223], v[52:55]
    ds_write_b128 v64, v[32:35] offset:8192
    v_mfma_f32_16x16x32_bf16 v[56:59], v[152:155], v[220:223], v[56:59]
    ds_write_b128 v64, v[36:39] offset:9216
    v_mfma_f32_16x16x32_bf16 v[60:63], v[156:159], v[220:223], v[60:63]
    ds_write_b128 v64, v[40:43] offset:10240
    v_mfma_f32_16x16x32_bf16 v[0:3], v[144:147], v[208:211], v[0:3]
    ds_write_b128 v64, v[44:47] offset:11264
    v_mfma_f32_16x16x32_bf16 v[4:7], v[148:151], v[208:211], v[4:7]
    ds_write_b128 v64, v[48:51] offset:12288
    v_mfma_f32_16x16x32_bf16 v[8:11], v[152:155], v[208:211], v[8:11]
    ds_write_b128 v64, v[52:55] offset:13312
    v_mfma_f32_16x16x32_bf16 v[12:15], v[156:159], v[208:211], v[12:15]
    ds_write_b128 v64, v[56:59] offset:14336
    ds_write_b128 v64, v[60:63] offset:15360
    s_waitcnt lgkmcnt(0)
    s_barrier
    ds_read_b128 v[96:99], v65 offset:40960
    ds_read_b128 v[100:103], v66 offset:0
    ds_read_b128 v[104:107], v66 offset:40960
    ds_read_b128 v[108:111], v65 offset:41984
    ds_read_b128 v[112:115], v66 offset:1024
    ds_read_b128 v[116:119], v66 offset:41984
    ds_read_b128 v[120:123], v65 offset:43008
    ds_read_b128 v[124:127], v66 offset:2048
    ds_read_b128 v[128:131], v66 offset:43008
    ds_read_b128 v[132:135], v65 offset:44032
    ds_read_b128 v[136:139], v66 offset:3072
    ds_read_b128 v[140:143], v66 offset:44032
    s_waitcnt lgkmcnt(9)
    v_pk_add_f32 v[100:101], v[100:101], v[104:105]
    v_pk_add_f32 v[102:103], v[102:103], v[106:107]
    v_pk_add_f32 v[0:1], v[0:1], v[96:97]
    v_pk_add_f32 v[2:3], v[2:3], v[98:99]
    v_pk_add_f32 v[0:1], v[0:1], v[100:101]
    v_pk_add_f32 v[2:3], v[2:3], v[102:103]
    v_cvt_pk_bf16_f32 v72, v0, v1
    v_cvt_pk_bf16_f32 v73, v2, v3
    s_waitcnt lgkmcnt(6)
    v_pk_add_f32 v[112:113], v[112:113], v[116:117]
    v_pk_add_f32 v[114:115], v[114:115], v[118:119]
    v_pk_add_f32 v[4:5], v[4:5], v[108:109]
    v_pk_add_f32 v[6:7], v[6:7], v[110:111]
    v_pk_add_f32 v[4:5], v[4:5], v[112:113]
    v_pk_add_f32 v[6:7], v[6:7], v[114:115]
    v_cvt_pk_bf16_f32 v74, v4, v5
    v_cvt_pk_bf16_f32 v75, v6, v7
    s_nop 1
    v_permlane16_swap_b32 v72, v74
    v_permlane16_swap_b32 v73, v75
    s_nop 1
    buffer_store_dwordx4 v[72:75], v67, s[20:23], s50 offen offset:0
    s_waitcnt lgkmcnt(3)
    v_pk_add_f32 v[124:125], v[124:125], v[128:129]
    v_pk_add_f32 v[126:127], v[126:127], v[130:131]
    v_pk_add_f32 v[8:9], v[8:9], v[120:121]
    v_pk_add_f32 v[10:11], v[10:11], v[122:123]
    v_pk_add_f32 v[8:9], v[8:9], v[124:125]
    v_pk_add_f32 v[10:11], v[10:11], v[126:127]
    v_cvt_pk_bf16_f32 v76, v8, v9
    v_cvt_pk_bf16_f32 v77, v10, v11
    s_waitcnt lgkmcnt(0)
    v_pk_add_f32 v[136:137], v[136:137], v[140:141]
    v_pk_add_f32 v[138:139], v[138:139], v[142:143]
    v_pk_add_f32 v[12:13], v[12:13], v[132:133]
    v_pk_add_f32 v[14:15], v[14:15], v[134:135]
    v_pk_add_f32 v[12:13], v[12:13], v[136:137]
    v_pk_add_f32 v[14:15], v[14:15], v[138:139]
    v_cvt_pk_bf16_f32 v78, v12, v13
    v_cvt_pk_bf16_f32 v79, v14, v15
    s_nop 1
    v_permlane16_swap_b32 v76, v78
    v_permlane16_swap_b32 v77, v79
    s_nop 1
    buffer_store_dwordx4 v[76:79], v67, s[20:23], s50 offen offset:64
    s_branch B_REDE
B_RED1:
    s_waitcnt lgkmcnt(0)
    s_waitcnt vmcnt(3)
    v_mfma_f32_16x16x32_bf16 v[0:3], v[144:147], v[208:211], v[0:3]
    v_mfma_f32_16x16x32_bf16 v[4:7], v[148:151], v[208:211], v[4:7]
    v_mfma_f32_16x16x32_bf16 v[8:11], v[152:155], v[208:211], v[8:11]
    v_mfma_f32_16x16x32_bf16 v[12:15], v[156:159], v[208:211], v[12:15]
    s_waitcnt vmcnt(1)
    v_mfma_f32_16x16x32_bf16 v[32:35], v[144:147], v[216:219], v[32:35]
    v_mfma_f32_16x16x32_bf16 v[36:39], v[148:151], v[216:219], v[36:39]
    ds_write_b128 v64, v[0:3] offset:0
    v_mfma_f32_16x16x32_bf16 v[40:43], v[152:155], v[216:219], v[40:43]
    ds_write_b128 v64, v[4:7] offset:1024
    v_mfma_f32_16x16x32_bf16 v[44:47], v[156:159], v[216:219], v[44:47]
    ds_write_b128 v64, v[8:11] offset:2048
    s_waitcnt vmcnt(0)
    v_mfma_f32_16x16x32_bf16 v[48:51], v[144:147], v[220:223], v[48:51]
    ds_write_b128 v64, v[12:15] offset:3072
    v_mfma_f32_16x16x32_bf16 v[52:55], v[148:151], v[220:223], v[52:55]
    ds_write_b128 v64, v[32:35] offset:8192
    v_mfma_f32_16x16x32_bf16 v[56:59], v[152:155], v[220:223], v[56:59]
    ds_write_b128 v64, v[36:39] offset:9216
    v_mfma_f32_16x16x32_bf16 v[60:63], v[156:159], v[220:223], v[60:63]
    ds_write_b128 v64, v[40:43] offset:10240
    v_mfma_f32_16x16x32_bf16 v[16:19], v[144:147], v[212:215], v[16:19]
    ds_write_b128 v64, v[44:47] offset:11264
    v_mfma_f32_16x16x32_bf16 v[20:23], v[148:151], v[212:215], v[20:23]
    ds_write_b128 v64, v[48:51] offset:12288
    v_mfma_f32_16x16x32_bf16 v[24:27], v[152:155], v[212:215], v[24:27]
    ds_write_b128 v64, v[52:55] offset:13312
    v_mfma_f32_16x16x32_bf16 v[28:31], v[156:159], v[212:215], v[28:31]
    ds_write_b128 v64, v[56:59] offset:14336
    ds_write_b128 v64, v[60:63] offset:15360
    s_waitcnt lgkmcnt(0)
    s_barrier
    ds_read_b128 v[96:99], v65 offset:4096
    ds_read_b128 v[100:103], v66 offset:4096
    ds_read_b128 v[104:107], v66 offset:45056
    ds_read_b128 v[108:111], v65 offset:5120
    ds_read_b128 v[112:115], v66 offset:5120
    ds_read_b128 v[116:119], v66 offset:46080
    ds_read_b128 v[120:123], v65 offset:6144
    ds_read_b128 v[124:127], v66 offset:6144
    ds_read_b128 v[128:131], v66 offset:47104
    ds_read_b128 v[132:135], v65 offset:7168
    ds_read_b128 v[136:139], v66 offset:7168
    ds_read_b128 v[140:143], v66 offset:48128
    s_waitcnt lgkmcnt(9)
    v_pk_add_f32 v[100:101], v[100:101], v[104:105]
    v_pk_add_f32 v[102:103], v[102:103], v[106:107]
    v_pk_add_f32 v[16:17], v[16:17], v[96:97]
    v_pk_add_f32 v[18:19], v[18:19], v[98:99]
    v_pk_add_f32 v[16:17], v[16:17], v[100:101]
    v_pk_add_f32 v[18:19], v[18:19], v[102:103]
    v_cvt_pk_bf16_f32 v72, v16, v17
    v_cvt_pk_bf16_f32 v73, v18, v19
    s_waitcnt lgkmcnt(6)
    v_pk_add_f32 v[112:113], v[112:113], v[116:117]
    v_pk_add_f32 v[114:115], v[114:115], v[118:119]
    v_pk_add_f32 v[20:21], v[20:21], v[108:109]
    v_pk_add_f32 v[22:23], v[22:23], v[110:111]
    v_pk_add_f32 v[20:21], v[20:21], v[112:113]
    v_pk_add_f32 v[22:23], v[22:23], v[114:115]
    v_cvt_pk_bf16_f32 v74, v20, v21
    v_cvt_pk_bf16_f32 v75, v22, v23
    s_nop 1
    v_permlane16_swap_b32 v72, v74
    v_permlane16_swap_b32 v73, v75
    s_nop 1
    buffer_store_dwordx4 v[72:75], v67, s[20:23], s50 offen offset:0
    s_waitcnt lgkmcnt(3)
    v_pk_add_f32 v[124:125], v[124:125], v[128:129]
    v_pk_add_f32 v[126:127], v[126:127], v[130:131]
    v_pk_add_f32 v[24:25], v[24:25], v[120:121]
    v_pk_add_f32 v[26:27], v[26:27], v[122:123]
    v_pk_add_f32 v[24:25], v[24:25], v[124:125]
    v_pk_add_f32 v[26:27], v[26:27], v[126:127]
    v_cvt_pk_bf16_f32 v76, v24, v25
    v_cvt_pk_bf16_f32 v77, v26, v27
    s_waitcnt lgkmcnt(0)
    v_pk_add_f32 v[136:137], v[136:137], v[140:141]
    v_pk_add_f32 v[138:139], v[138:139], v[142:143]
    v_pk_add_f32 v[28:29], v[28:29], v[132:133]
    v_pk_add_f32 v[30:31], v[30:31], v[134:135]
    v_pk_add_f32 v[28:29], v[28:29], v[136:137]
    v_pk_add_f32 v[30:31], v[30:31], v[138:139]
    v_cvt_pk_bf16_f32 v78, v28, v29
    v_cvt_pk_bf16_f32 v79, v30, v31
    s_nop 1
    v_permlane16_swap_b32 v76, v78
    v_permlane16_swap_b32 v77, v79
    s_nop 1
    buffer_store_dwordx4 v[76:79], v67, s[20:23], s50 offen offset:64
    s_branch B_REDE
B_RED2:
    s_waitcnt lgkmcnt(0)
    s_waitcnt vmcnt(3)
    v_mfma_f32_16x16x32_bf16 v[0:3], v[144:147], v[208:211], v[0:3]
    v_mfma_f32_16x16x32_bf16 v[4:7], v[148:151], v[208:211], v[4:7]
    v_mfma_f32_16x16x32_bf16 v[8:11], v[152:155], v[208:211], v[8:11]
    v_mfma_f32_16x16x32_bf16 v[12:15], v[156:159], v[208:211], v[12:15]
    s_waitcnt vmcnt(2)
    v_mfma_f32_16x16x32_bf16 v[16:19], v[144:147], v[212:215], v[16:19]
    v_mfma_f32_16x16x32_bf16 v[20:23], v[148:151], v[212:215], v[20:23]
    ds_write_b128 v64, v[0:3] offset:0
    v_mfma_f32_16x16x32_bf16 v[24:27], v[152:155], v[212:215], v[24:27]
    ds_write_b128 v64, v[4:7] offset:1024
    v_mfma_f32_16x16x32_bf16 v[28:31], v[156:159], v[212:215], v[28:31]
    ds_write_b128 v64, v[8:11] offset:2048
    s_waitcnt vmcnt(0)
    v_mfma_f32_16x16x32_bf16 v[48:51], v[144:147], v[220:223], v[48:51]
    ds_write_b128 v64, v[12:15] offset:3072
    v_mfma_f32_16x16x32_bf16 v[52:55], v[148:151], v[220:223], v[52:55]
    ds_write_b128 v64, v[16:19] offset:4096
    v_mfma_f32_16x16x32_bf16 v[56:59], v[152:155], v[220:223], v[56:59]
    ds_write_b128 v64, v[20:23] offset:5120
    v_mfma_f32_16x16x32_bf16 v[60:63], v[156:159], v[220:223], v[60:63]
    ds_write_b128 v64, v[24:27] offset:6144
    v_mfma_f32_16x16x32_bf16 v[32:35], v[144:147], v[216:219], v[32:35]
    ds_write_b128 v64, v[28:31] offset:7168
    v_mfma_f32_16x16x32_bf16 v[36:39], v[148:151], v[216:219], v[36:39]
    ds_write_b128 v64, v[48:51] offset:12288
    v_mfma_f32_16x16x32_bf16 v[40:43], v[152:155], v[216:219], v[40:43]
    ds_write_b128 v64, v[52:55] offset:13312
    v_mfma_f32_16x16x32_bf16 v[44:47], v[156:159], v[216:219], v[44:47]
    ds_write_b128 v64, v[56:59] offset:14336
    ds_write_b128 v64, v[60:63] offset:15360
    s_waitcnt lgkmcnt(0)
    s_barrier
    ds_read_b128 v[96:99], v65 offset:8192
    ds_read_b128 v[100:103], v65 offset:49152
    ds_read_b128 v[104:107], v66 offset:49152
    ds_read_b128 v[108:111], v65 offset:9216
    ds_read_b128 v[112:115], v65 offset:50176
    ds_read_b128 v[116:119], v66 offset:50176
    ds_read_b128 v[120:123], v65 offset:10240
    ds_read_b128 v[124:127], v65 offset:51200
    ds_read_b128 v[128:131], v66 offset:51200
    ds_read_b128 v[132:135], v65 offset:11264
    ds_read_b128 v[136:139], v65 offset:52224
    ds_read_b128 v[140:143], v66 offset:52224
    s_waitcnt lgkmcnt(9)
    v_pk_add_f32 v[100:101], v[100:101], v[104:105]
    v_pk_add_f32 v[102:103], v[102:103], v[106:107]
    v_pk_add_f32 v[32:33], v[32:33], v[96:97]
    v_pk_add_f32 v[34:35], v[34:35], v[98:99]
    v_pk_add_f32 v[32:33], v[32:33], v[100:101]
    v_pk_add_f32 v[34:35], v[34:35], v[102:103]
    v_cvt_pk_bf16_f32 v72, v32, v33
    v_cvt_pk_bf16_f32 v73, v34, v35
    s_waitcnt lgkmcnt(6)
    v_pk_add_f32 v[112:113], v[112:113], v[116:117]
    v_pk_add_f32 v[114:115], v[114:115], v[118:119]
    v_pk_add_f32 v[36:37], v[36:37], v[108:109]
    v_pk_add_f32 v[38:39], v[38:39], v[110:111]
    v_pk_add_f32 v[36:37], v[36:37], v[112:113]
    v_pk_add_f32 v[38:39], v[38:39], v[114:115]
    v_cvt_pk_bf16_f32 v74, v36, v37
    v_cvt_pk_bf16_f32 v75, v38, v39
    s_nop 1
    v_permlane16_swap_b32 v72, v74
    v_permlane16_swap_b32 v73, v75
    s_nop 1
    buffer_store_dwordx4 v[72:75], v67, s[20:23], s50 offen offset:0
    s_waitcnt lgkmcnt(3)
    v_pk_add_f32 v[124:125], v[124:125], v[128:129]
    v_pk_add_f32 v[126:127], v[126:127], v[130:131]
    v_pk_add_f32 v[40:41], v[40:41], v[120:121]
    v_pk_add_f32 v[42:43], v[42:43], v[122:123]
    v_pk_add_f32 v[40:41], v[40:41], v[124:125]
    v_pk_add_f32 v[42:43], v[42:43], v[126:127]
    v_cvt_pk_bf16_f32 v76, v40, v41
    v_cvt_pk_bf16_f32 v77, v42, v43
    s_waitcnt lgkmcnt(0)
    v_pk_add_f32 v[136:137], v[136:137], v[140:141]
    v_pk_add_f32 v[138:139], v[138:139], v[142:143]
    v_pk_add_f32 v[44:45], v[44:45], v[132:133]
    v_pk_add_f32 v[46:47], v[46:47], v[134:135]
    v_pk_add_f32 v[44:45], v[44:45], v[136:137]
    v_pk_add_f32 v[46:47], v[46:47], v[138:139]
    v_cvt_pk_bf16_f32 v78, v44, v45
    v_cvt_pk_bf16_f32 v79, v46, v47
    s_nop 1
    v_permlane16_swap_b32 v76, v78
    v_permlane16_swap_b32 v77, v79
    s_nop 1
    buffer_store_dwordx4 v[76:79], v67, s[20:23], s50 offen offset:64
B_REDE:
    s_endpgm
CT_END:
A_SLOW:
    s_waitcnt vmcnt(0) lgkmcnt(0)
    s_barrier
    s_mov_b32 s48, 1
    v_and_b32 v243, 63, v242
    v_and_b32 v244, 15, v243
    v_lshrrev_b32 v245, 4, v243
    v_lshlrev_b32 v248, 1, v245
    v_xor_b32 v248, v248, v244
    v_lshlrev_b32 v248, 4, v248
    v_lshlrev_b32 v249, 8, v245
    v_add_u32 v249, s44, v249
    v_add_u32 v240, v248, v249
    v_xor_b32 v248, 128, v248
    v_add_u32 v241, v248, v249
    v_bfe_u32 v246, v243, 2, 2
    v_and_b32 v247, 3, v243
    s_lshl_b32 s49, s38, 13
    s_add_u32 s50, s49, 147456
    v_and_b32 v248, 7, v244
    v_lshlrev_b32 v248, 1, v248
    v_xor_b32 v248, v248, v245
    v_lshlrev_b32 v248, 4, v248
    v_lshlrev_b32 v249, 8, v244
    v_add_u32 v249, s50, v249
    v_xor_b32 v228, 0, v248
    v_add_u32 v228, v228, v249
    v_xor_b32 v229, 64, v248
    v_add_u32 v229, v229, v249
    v_xor_b32 v230, 128, v248
    v_add_u32 v230, v230, v249
    v_xor_b32 v231, 192, v248
    v_add_u32 v231, v231, v249
    s_add_u32 s50, s49, 131072
    v_lshlrev_b32 v249, 2, v245
    v_add_u32 v249, v249, v246
    v_and_b32 v248, 7, v249
    s_lshl_b32 s51, s38, 2
    v_xor_b32 v248, s51, v248
    v_lshlrev_b32 v248, 5, v248
    v_lshlrev_b32 v249, 8, v249
    v_add_u32 v249, s50, v249
    v_lshlrev_b32 v247, 3, v247
    v_add_u32 v249, v249, v247
    v_xor_b32 v232, 0, v248
    v_add_u32 v232, v232, v249
    v_xor_b32 v233, 32, v248
    v_add_u32 v233, v233, v249
    v_xor_b32 v234, 64, v248
    v_add_u32 v234, v234, v249
    v_xor_b32 v235, 96, v248
    v_add_u32 v235, v235, v249
    v_xor_b32 v236, 128, v248
    v_add_u32 v236, v236, v249
    v_xor_b32 v237, 160, v248
    v_add_u32 v237, v237, v249
    v_xor_b32 v238, 192, v248
    v_add_u32 v238, v238, v249
    v_xor_b32 v239, 224, v248
    v_add_u32 v239, v239, v249
    v_mov_b32 v200, 0xff800000
    v_mov_b32 v204, 0xff800000
    v_mov_b32 v208, 0xff800000
    v_mov_b32 v212, 0xff800000
    v_mov_b32 v216, 0xff800000
    v_mov_b32 v220, 0xff800000
    v_mov_b32 v224, 0xff800000
    v_subrev_u32 v144, 147456, v228
    v_subrev_u32 v145, 147456, v229
    v_subrev_u32 v146, 147456, v230
    v_subrev_u32 v147, 147456, v231
    s_mov_b32 s56, 0
A_MAXLOOP:
    s_add_u32 m0, s44, 0
    s_nop 0
    buffer_load_dwordx4 v240, s[24:27], s56 offen nt lds
    buffer_load_dwordx4 v241, s[24:27], s56 offen offset:1024 nt lds
    buffer_load_dwordx4 v240, s[24:27], s56 offen offset:2048 nt lds
    buffer_load_dwordx4 v241, s[24:27], s56 offen offset:3072 nt lds
    s_waitcnt vmcnt(0)
    s_barrier
    ds_read_b128 v[112:115], v144
    ds_read_b128 v[116:119], v145
    ds_read_b128 v[120:123], v146
    ds_read_b128 v[124:127], v147
    ds_read_b128 v[128:131], v144 offset:4096
    ds_read_b128 v[132:135], v145 offset:4096
    ds_read_b128 v[136:139], v146 offset:4096
    ds_read_b128 v[140:143], v147 offset:4096
    s_waitcnt lgkmcnt(0)
    v_mfma_f32_16x16x32_bf16 v[176:179], v[112:115], a[0:3], 0
    v_mfma_f32_16x16x32_bf16 v[176:179], v[116:119], a[4:7], v[176:179]
    v_mfma_f32_16x16x32_bf16 v[176:179], v[120:123], a[8:11], v[176:179]
    v_mfma_f32_16x16x32_bf16 v[176:179], v[124:127], a[12:15], v[176:179]
    v_mfma_f32_16x16x32_bf16 v[180:183], v[128:131], a[0:3], 0
    v_mfma_f32_16x16x32_bf16 v[180:183], v[132:135], a[4:7], v[180:183]
    v_mfma_f32_16x16x32_bf16 v[180:183], v[136:139], a[8:11], v[180:183]
    v_mfma_f32_16x16x32_bf16 v[180:183], v[140:143], a[12:15], v[180:183]
    s_nop 15
    v_max3_f32 v200, v200, v176, v177
    v_max3_f32 v200, v200, v178, v179
    v_max3_f32 v200, v200, v180, v181
    v_max3_f32 v200, v200, v182, v183
    s_nop 3
    v_mfma_f32_16x16x32_bf16 v[176:179], v[112:115], a[16:19], 0
    v_mfma_f32_16x16x32_bf16 v[176:179], v[116:119], a[20:23], v[176:179]
    v_mfma_f32_16x16x32_bf16 v[176:179], v[120:123], a[24:27], v[176:179]
    v_mfma_f32_16x16x32_bf16 v[176:179], v[124:127], a[28:31], v[176:179]
    v_mfma_f32_16x16x32_bf16 v[180:183], v[128:131], a[16:19], 0
    v_mfma_f32_16x16x32_bf16 v[180:183], v[132:135], a[20:23], v[180:183]
    v_mfma_f32_16x16x32_bf16 v[180:183], v[136:139], a[24:27], v[180:183]
    v_mfma_f32_16x16x32_bf16 v[180:183], v[140:143], a[28:31], v[180:183]
    s_nop 15
    v_max3_f32 v204, v204, v176, v177
    v_max3_f32 v204, v204, v178, v179
    v_max3_f32 v204, v204, v180, v181
    v_max3_f32 v204, v204, v182, v183
    s_nop 3
    v_mfma_f32_16x16x32_bf16 v[176:179], v[112:115], a[32:35], 0
    v_mfma_f32_16x16x32_bf16 v[176:179], v[116:119], a[36:39], v[176:179]
    v_mfma_f32_16x16x32_bf16 v[176:179], v[120:123], a[40:43], v[176:179]
    v_mfma_f32_16x16x32_bf16 v[176:179], v[124:127], a[44:47], v[176:179]
    v_mfma_f32_16x16x32_bf16 v[180:183], v[128:131], a[32:35], 0
    v_mfma_f32_16x16x32_bf16 v[180:183], v[132:135], a[36:39], v[180:183]
    v_mfma_f32_16x16x32_bf16 v[180:183], v[136:139], a[40:43], v[180:183]
    v_mfma_f32_16x16x32_bf16 v[180:183], v[140:143], a[44:47], v[180:183]
    s_nop 15
    v_max3_f32 v208, v208, v176, v177
    v_max3_f32 v208, v208, v178, v179
    v_max3_f32 v208, v208, v180, v181
    v_max3_f32 v208, v208, v182, v183
    s_nop 3
    v_mfma_f32_16x16x32_bf16 v[176:179], v[112:115], a[48:51], 0
    v_mfma_f32_16x16x32_bf16 v[176:179], v[116:119], a[52:55], v[176:179]
    v_mfma_f32_16x16x32_bf16 v[176:179], v[120:123], a[56:59], v[176:179]
    v_mfma_f32_16x16x32_bf16 v[176:179], v[124:127], a[60:63], v[176:179]
    v_mfma_f32_16x16x32_bf16 v[180:183], v[128:131], a[48:51], 0
    v_mfma_f32_16x16x32_bf16 v[180:183], v[132:135], a[52:55], v[180:183]
    v_mfma_f32_16x16x32_bf16 v[180:183], v[136:139], a[56:59], v[180:183]
    v_mfma_f32_16x16x32_bf16 v[180:183], v[140:143], a[60:63], v[180:183]
    s_nop 15
    v_max3_f32 v212, v212, v176, v177
    v_max3_f32 v212, v212, v178, v179
    v_max3_f32 v212, v212, v180, v181
    v_max3_f32 v212, v212, v182, v183
    s_nop 3
    v_mfma_f32_16x16x32_bf16 v[176:179], v[112:115], a[64:67], 0
    v_mfma_f32_16x16x32_bf16 v[176:179], v[116:119], a[68:71], v[176:179]
    v_mfma_f32_16x16x32_bf16 v[176:179], v[120:123], a[72:75], v[176:179]
    v_mfma_f32_16x16x32_bf16 v[176:179], v[124:127], a[76:79], v[176:179]
    v_mfma_f32_16x16x32_bf16 v[180:183], v[128:131], a[64:67], 0
    v_mfma_f32_16x16x32_bf16 v[180:183], v[132:135], a[68:71], v[180:183]
    v_mfma_f32_16x16x32_bf16 v[180:183], v[136:139], a[72:75], v[180:183]
    v_mfma_f32_16x16x32_bf16 v[180:183], v[140:143], a[76:79], v[180:183]
    s_nop 15
    v_max3_f32 v216, v216, v176, v177
    v_max3_f32 v216, v216, v178, v179
    v_max3_f32 v216, v216, v180, v181
    v_max3_f32 v216, v216, v182, v183
    s_nop 3
    v_mfma_f32_16x16x32_bf16 v[176:179], v[112:115], a[80:83], 0
    v_mfma_f32_16x16x32_bf16 v[176:179], v[116:119], a[84:87], v[176:179]
    v_mfma_f32_16x16x32_bf16 v[176:179], v[120:123], a[88:91], v[176:179]
    v_mfma_f32_16x16x32_bf16 v[176:179], v[124:127], a[92:95], v[176:179]
    v_mfma_f32_16x16x32_bf16 v[180:183], v[128:131], a[80:83], 0
    v_mfma_f32_16x16x32_bf16 v[180:183], v[132:135], a[84:87], v[180:183]
    v_mfma_f32_16x16x32_bf16 v[180:183], v[136:139], a[88:91], v[180:183]
    v_mfma_f32_16x16x32_bf16 v[180:183], v[140:143], a[92:95], v[180:183]
    s_nop 15
    v_max3_f32 v220, v220, v176, v177
    v_max3_f32 v220, v220, v178, v179
    v_max3_f32 v220, v220, v180, v181
    v_max3_f32 v220, v220, v182, v183
    s_nop 3
    v_mfma_f32_16x16x32_bf16 v[176:179], v[112:115], a[96:99], 0
    v_mfma_f32_16x16x32_bf16 v[176:179], v[116:119], a[100:103], v[176:179]
    v_mfma_f32_16x16x32_bf16 v[176:179], v[120:123], a[104:107], v[176:179]
    v_mfma_f32_16x16x32_bf16 v[176:179], v[124:127], a[108:111], v[176:179]
    v_mfma_f32_16x16x32_bf16 v[180:183], v[128:131], a[96:99], 0
    v_mfma_f32_16x16x32_bf16 v[180:183], v[132:135], a[100:103], v[180:183]
    v_mfma_f32_16x16x32_bf16 v[180:183], v[136:139], a[104:107], v[180:183]
    v_mfma_f32_16x16x32_bf16 v[180:183], v[140:143], a[108:111], v[180:183]
    s_nop 15
    v_max3_f32 v224, v224, v176, v177
    v_max3_f32 v224, v224, v178, v179
    v_max3_f32 v224, v224, v180, v181
    v_max3_f32 v224, v224, v182, v183
    s_nop 3
    s_barrier
    s_add_u32 s56, s56, 16384
    s_cmp_lt_u32 s56, 262144
    s_cbranch_scc1 A_MAXLOOP
    v_and_b32 v243, 63, v242
    v_lshlrev_b32 v244, 2, v243
    s_mul_i32 s49, s36, 1792
    s_add_u32 s49, s49, 16384
    v_add_u32 v244, s49, v244
    ds_write_b32 v244, v200 offset:0
    ds_write_b32 v244, v204 offset:256
    ds_write_b32 v244, v208 offset:512
    ds_write_b32 v244, v212 offset:768
    ds_write_b32 v244, v216 offset:1024
    ds_write_b32 v244, v220 offset:1280
    ds_write_b32 v244, v224 offset:1536
    s_waitcnt lgkmcnt(0)
    s_barrier
    v_and_b32 v245, 15, v243
    v_lshlrev_b32 v245, 2, v245
    s_mul_i32 s49, s37, 3584
    s_add_u32 s49, s49, 16384
    v_add_u32 v245, s49, v245
    ds_read_b32 v176, v245 offset:0
    ds_read_b32 v177, v245 offset:64
    ds_read_b32 v178, v245 offset:128
    ds_read_b32 v179, v245 offset:192
    ds_read_b32 v180, v245 offset:1792
    ds_read_b32 v181, v245 offset:1856
    ds_read_b32 v182, v245 offset:1920
    ds_read_b32 v183, v245 offset:1984
    s_waitcnt lgkmcnt(0)
    v_max3_f32 v200, v176, v177, v178
    v_max3_f32 v200, v200, v179, v180
    v_max3_f32 v200, v200, v181, v182
    v_max_f32 v200, v200, v183
    v_sub_f32 v200, 0, v200
    v_mov_b32 v201, v200
    v_mov_b32 v202, v200
    v_mov_b32 v203, v200
    ds_read_b32 v176, v245 offset:256
    ds_read_b32 v177, v245 offset:320
    ds_read_b32 v178, v245 offset:384
    ds_read_b32 v179, v245 offset:448
    ds_read_b32 v180, v245 offset:2048
    ds_read_b32 v181, v245 offset:2112
    ds_read_b32 v182, v245 offset:2176
    ds_read_b32 v183, v245 offset:2240
    s_waitcnt lgkmcnt(0)
    v_max3_f32 v204, v176, v177, v178
    v_max3_f32 v204, v204, v179, v180
    v_max3_f32 v204, v204, v181, v182
    v_max_f32 v204, v204, v183
    v_sub_f32 v204, 0, v204
    v_mov_b32 v205, v204
    v_mov_b32 v206, v204
    v_mov_b32 v207, v204
    ds_read_b32 v176, v245 offset:512
    ds_read_b32 v177, v245 offset:576
    ds_read_b32 v178, v245 offset:640
    ds_read_b32 v179, v245 offset:704
    ds_read_b32 v180, v245 offset:2304
    ds_read_b32 v181, v245 offset:2368
    ds_read_b32 v182, v245 offset:2432
    ds_read_b32 v183, v245 offset:2496
    s_waitcnt lgkmcnt(0)
    v_max3_f32 v208, v176, v177, v178
    v_max3_f32 v208, v208, v179, v180
    v_max3_f32 v208, v208, v181, v182
    v_max_f32 v208, v208, v183
    v_sub_f32 v208, 0, v208
    v_mov_b32 v209, v208
    v_mov_b32 v210, v208
    v_mov_b32 v211, v208
    ds_read_b32 v176, v245 offset:768
    ds_read_b32 v177, v245 offset:832
    ds_read_b32 v178, v245 offset:896
    ds_read_b32 v179, v245 offset:960
    ds_read_b32 v180, v245 offset:2560
    ds_read_b32 v181, v245 offset:2624
    ds_read_b32 v182, v245 offset:2688
    ds_read_b32 v183, v245 offset:2752
    s_waitcnt lgkmcnt(0)
    v_max3_f32 v212, v176, v177, v178
    v_max3_f32 v212, v212, v179, v180
    v_max3_f32 v212, v212, v181, v182
    v_max_f32 v212, v212, v183
    v_sub_f32 v212, 0, v212
    v_mov_b32 v213, v212
    v_mov_b32 v214, v212
    v_mov_b32 v215, v212
    ds_read_b32 v176, v245 offset:1024
    ds_read_b32 v177, v245 offset:1088
    ds_read_b32 v178, v245 offset:1152
    ds_read_b32 v179, v245 offset:1216
    ds_read_b32 v180, v245 offset:2816
    ds_read_b32 v181, v245 offset:2880
    ds_read_b32 v182, v245 offset:2944
    ds_read_b32 v183, v245 offset:3008
    s_waitcnt lgkmcnt(0)
    v_max3_f32 v216, v176, v177, v178
    v_max3_f32 v216, v216, v179, v180
    v_max3_f32 v216, v216, v181, v182
    v_max_f32 v216, v216, v183
    v_sub_f32 v216, 0, v216
    v_mov_b32 v217, v216
    v_mov_b32 v218, v216
    v_mov_b32 v219, v216
    ds_read_b32 v176, v245 offset:1280
    ds_read_b32 v177, v245 offset:1344
    ds_read_b32 v178, v245 offset:1408
    ds_read_b32 v179, v245 offset:1472
    ds_read_b32 v180, v245 offset:3072
    ds_read_b32 v181, v245 offset:3136
    ds_read_b32 v182, v245 offset:3200
    ds_read_b32 v183, v245 offset:3264
    s_waitcnt lgkmcnt(0)
    v_max3_f32 v220, v176, v177, v178
    v_max3_f32 v220, v220, v179, v180
    v_max3_f32 v220, v220, v181, v182
    v_max_f32 v220, v220, v183
    v_sub_f32 v220, 0, v220
    v_mov_b32 v221, v220
    v_mov_b32 v222, v220
    v_mov_b32 v223, v220
    ds_read_b32 v176, v245 offset:1536
    ds_read_b32 v177, v245 offset:1600
    ds_read_b32 v178, v245 offset:1664
    ds_read_b32 v179, v245 offset:1728
    ds_read_b32 v180, v245 offset:3328
    ds_read_b32 v181, v245 offset:3392
    ds_read_b32 v182, v245 offset:3456
    ds_read_b32 v183, v245 offset:3520
    s_waitcnt lgkmcnt(0)
    v_max3_f32 v224, v176, v177, v178
    v_max3_f32 v224, v224, v179, v180
    v_max3_f32 v224, v224, v181, v182
    v_max_f32 v224, v224, v183
    v_sub_f32 v224, 0, v224
    v_mov_b32 v225, v224
    v_mov_b32 v226, v224
    v_mov_b32 v227, v224
    s_barrier
    v_lshlrev_b32 v244, 4, v243
    s_mul_i32 s49, s37, 28672
    v_add_u32 v254, s49, v244
    ds_write_b128 v254, a[0:3] offset:0
    ds_write_b128 v254, a[16:19] offset:1024
    ds_write_b128 v254, a[32:35] offset:2048
    ds_write_b128 v254, a[48:51] offset:3072
    ds_write_b128 v254, a[64:67] offset:4096
    ds_write_b128 v254, a[80:83] offset:5120
    ds_write_b128 v254, a[96:99] offset:6144
    ds_write_b128 v254, a[4:7] offset:7168
    ds_write_b128 v254, a[20:23] offset:8192
    ds_write_b128 v254, a[36:39] offset:9216
    ds_write_b128 v254, a[52:55] offset:10240
    ds_write_b128 v254, a[68:71] offset:11264
    ds_write_b128 v254, a[84:87] offset:12288
    ds_write_b128 v254, a[100:103] offset:13312
    ds_write_b128 v254, a[8:11] offset:14336
    ds_write_b128 v254, a[24:27] offset:15360
    ds_write_b128 v254, a[40:43] offset:16384
    ds_write_b128 v254, a[56:59] offset:17408
    ds_write_b128 v254, a[72:75] offset:18432
    ds_write_b128 v254, a[88:91] offset:19456
    ds_write_b128 v254, a[104:107] offset:20480
    ds_write_b128 v254, a[12:15] offset:21504
    ds_write_b128 v254, a[28:31] offset:22528
    ds_write_b128 v254, a[44:47] offset:23552
    ds_write_b128 v254, a[60:63] offset:24576
    ds_write_b128 v254, a[76:79] offset:25600
    ds_write_b128 v254, a[92:95] offset:26624
    ds_write_b128 v254, a[108:111] offset:27648
    s_add_u32 m0, s44, 147456
    s_nop 0
    buffer_load_dwordx4 v240, s[24:27], 0 offen nt lds
    buffer_load_dwordx4 v241, s[24:27], 0 offen offset:1024 nt lds
    buffer_load_dwordx4 v240, s[24:27], 0 offen offset:2048 nt lds
    buffer_load_dwordx4 v241, s[24:27], 0 offen offset:3072 nt lds
    s_add_u32 m0, s44, 131072
    s_nop 0
    buffer_load_dwordx4 v240, s[28:31], 0 offen nt lds
    buffer_load_dwordx4 v241, s[28:31], 0 offen offset:1024 nt lds
    buffer_load_dwordx4 v240, s[28:31], 0 offen offset:2048 nt lds
    buffer_load_dwordx4 v241, s[28:31], 0 offen offset:3072 nt lds
    s_mov_b32 s56, 16384
    s_add_u32 m0, s44, 114688
    s_nop 0
    buffer_load_dwordx4 v240, s[24:27], s56 offen nt lds
    buffer_load_dwordx4 v241, s[24:27], s56 offen offset:1024 nt lds
    buffer_load_dwordx4 v240, s[24:27], s56 offen offset:2048 nt lds
    buffer_load_dwordx4 v241, s[24:27], s56 offen offset:3072 nt lds
    s_add_u32 m0, s44, 98304
    s_nop 0
    buffer_load_dwordx4 v240, s[28:31], s56 offen nt lds
    buffer_load_dwordx4 v241, s[28:31], s56 offen offset:1024 nt lds
    buffer_load_dwordx4 v240, s[28:31], s56 offen offset:2048 nt lds
    buffer_load_dwordx4 v241, s[28:31], s56 offen offset:3072 nt lds
    v_and_b32 v184, 63, v242
    v_lshrrev_b32 v185, 3, v184
    v_and_b32 v186, 7, v184
    v_bfe_u32 v187, v184, 4, 2
    v_lshlrev_b32 v187, 1, v187
    v_xor_b32 v186, v186, v187
    v_lshlrev_b32 v186, 4, v186
    v_mul_u32_u24 v185, 1152, v185
    v_add_u32 v245, v185, v186
    v_add_u32 v246, 8192, v245
    v_add_u32 v247, 16384, v245
    v_add_u32 v248, 24576, v245
    v_lshrrev_b32 v185, 2, v184
    v_bfe_u32 v186, v184, 3, 2
    v_lshlrev_b32 v186, 5, v186
    v_lshlrev_b32 v185, 7, v185
    v_and_b32 v187, 3, v184
    v_lshlrev_b32 v187, 3, v187
    v_add_u32 v185, v185, v187
    v_add_u32 v185, s100, v185
    v_xor_b32 v249, 0, v186
    v_add_u32 v249, v249, v185
    v_xor_b32 v250, 32, v186
    v_add_u32 v250, v250, v185
    v_xor_b32 v251, 64, v186
    v_add_u32 v251, v251, v185
    v_xor_b32 v252, 96, v186
    v_add_u32 v252, v252, v185
    v_mov_b32 v243, 0x40000000
    s_waitcnt vmcnt(0) lgkmcnt(0)
    s_barrier
    ds_read_b128 v[112:115], v228
    ds_read_b128 v[116:119], v229
    ds_read_b128 v[120:123], v230
    ds_read_b128 v[124:127], v231
    ds_read_b128 v[128:131], v228 offset:4096
    ds_read_b128 v[132:135], v229 offset:4096
    ds_read_b128 v[136:139], v230 offset:4096
    ds_read_b128 v[140:143], v231 offset:4096
    s_branch A_ATT
A_END:
    s_endpgm
.section .rodata,"a"
.p2align 6
.amdhsa_kernel standalone__mha_block_cached__near_ridge_kernel
  .amdhsa_next_free_vgpr 512
  .amdhsa_next_free_sgpr 102
  .amdhsa_accum_offset 256
  .amdhsa_group_segment_fixed_size 0
  .amdhsa_kernarg_size 64
  .amdhsa_user_sgpr_count 2
  .amdhsa_user_sgpr_kernarg_segment_ptr 1
  .amdhsa_system_sgpr_workgroup_id_x 1
.end_amdhsa_kernel
```
